```python
import torch

def _softmax(x, axis=-1):
    return torch.softmax(x, dim=axis)
def _gelu(x):
    return torch.nn.functional.gelu(x, approximate="tanh")
def _silu(x):
    return torch.nn.functional.silu(x)
def _sigmoid(x):
    return torch.sigmoid(x)
def _layernorm(x, axis=-1, eps=1e-5):
    m = x.mean(dim=axis, keepdim=True)
    v = x.var(dim=axis, keepdim=True, unbiased=False)
    return (x - m) / torch.sqrt(v + eps)
def _scatter_add(tgt, idx, src, axis=0):
    return tgt.clone().index_add_(axis, idx, src)
def _segment_sum(src, seg, n):
    out = torch.zeros((n,) + src.shape[1:], dtype=src.dtype)
    return out.index_add_(0, seg, src)
def _pad(x, pw):
    flat = tuple(v for pair in reversed(pw) for v in pair)
    return torch.nn.functional.pad(x, flat)

kernel_name = 'gated_mix__sliding_block__softmax_full_mha__prompt'

def setup_inputs():

    _w = (lambda a: (lambda t: t.to(torch.bfloat16) if t.is_floating_point() else t)(torch.as_tensor(a)))
    def _A_setup():
        B, S, D = 1, 2048, 448
        return {
            "x": _w((lambda *s: torch.randn(*s, dtype=torch.bfloat16) * 0.05)(B, S, D)),
            "wqkv": _w((lambda *s: torch.randn(*s, dtype=torch.bfloat16) * 1.6)(D, 3 * D)),
            "wo": _w((lambda *s: torch.randn(*s, dtype=torch.bfloat16) * 0.05)(D, D)),
        }
    _A_in = _A_setup()

    def _B_setup():
        B, S, D = 1, 2048, 448
        return {
            "x": _w((lambda *s: torch.randn(*s, dtype=torch.bfloat16) * 0.05)(B, S, D)),
            "wqkv": _w((lambda *s: torch.randn(*s, dtype=torch.bfloat16) * 1.6)(D, 3 * D)),
            "wo": _w((lambda *s: torch.randn(*s, dtype=torch.bfloat16) * 0.1)(D, D)),
        }
    _B_in = _B_setup()

    return {
        "A_x": _A_in["x"],
        "A_wqkv": _A_in["wqkv"],
        "A_wo": _A_in["wo"],
        "B_x": _B_in["x"],
        "B_wqkv": _B_in["wqkv"],
        "B_wo": _B_in["wo"],
        "gate_w": _w((lambda *s: torch.randn(*s, dtype=torch.bfloat16) * 0.05)(448) * 16.0),
    }

def reference(A_x, A_wqkv, A_wo, B_x, B_wqkv, B_wo, gate_w):
    def _A_ref(x, wqkv, wo):
        B, S, D = x.shape
        H = 16; Dh = D // H; W = 256
        qkv = (lambda x, *d: x.permute(*d))((x @ wqkv).reshape(B, S, 3, H, Dh), 2, 0, 3, 1, 4)
        q, k, v = qkv[0], qkv[1], qkv[2]
        scores = torch.einsum("bhqd,bhkd->bhqk", q, k) * (Dh ** -0.5)
        idx = torch.arange(S)
        mask = (idx[:, None] - idx[None, :] >= 0) & (idx[:, None] - idx[None, :] < W)
        scores = torch.where(mask[None, None], scores, -1e9)
        p = _softmax(scores, axis=-1)
        o = torch.einsum("bhqk,bhkd->bhqd", p, v)
        return (lambda x, *d: x.permute(*d))(o, 0, 2, 1, 3).reshape(B, S, D) @ wo

    def _B_ref(x, wqkv, wo):
        B, S, D = x.shape
        H = 16; Dh = D // H
        qkv = (lambda x, *d: x.permute(*d))((x @ wqkv).reshape(B, S, 3, H, Dh), 2, 0, 3, 1, 4)
        q, k, v = qkv[0], qkv[1], qkv[2]
        scale = Dh ** -0.5
        scores = torch.einsum("bhqd,bhkd->bhqk", q, k) * scale
        p = _softmax(scores, axis=-1)
        o = torch.einsum("bhqk,bhkd->bhqd", p, v)
        return (lambda x, *d: x.permute(*d))(o, 0, 2, 1, 3).reshape(B, S, D) @ wo

    x = A_x
    g = _sigmoid((x * gate_w).sum(-1, keepdims=True))
    a = _A_ref(x, A_wqkv, A_wo)
    b = _B_ref(x, B_wqkv, B_wo)
    return g * a + (1 - g) * b
```

```asm
; @launch grid=(256,1,1) block=(512,1,1) lds=163840
.amdgcn_target "amdgcn-amd-amdhsa--gfx950"
.text
.p2align 12
.globl gated_mix__sliding_block__softmax_full_mha__prompt_kernel
.p2align 8
.type gated_mix__sliding_block__softmax_full_mha__prompt_kernel,@function
gated_mix__sliding_block__softmax_full_mha__prompt_kernel:
    s_cmp_ge_u32 s2, 256
    s_cbranch_scc1 L_done
    s_load_dwordx16 s[4:19], s[0:1], 0
    s_load_dwordx4 s[20:23], s[0:1], 64
    v_lshrrev_b32 v2, 6, v0
    v_and_b32 v1, 63, v0
    v_readfirstlane_b32 s34, v2
    s_bfe_u32 s40, s2, 0x30003
    s_and_b32 s32, s2, 1
    s_lshl3_add_u32 s32, s32, s40
    s_lshr_b32 s38, s2, 6
    s_lshl1_add_u32 s63, s38, s40
    s_sub_u32 s40, s63, 7
    s_cselect_b32 s63, s63, s40
    s_and_b32 s35, s34, 3
    s_bfe_u32 s33, s2, 0x20001
    s_lshl2_add_u32 s33, s33, s38
    s_cmp_lt_u32 s34, 4
    s_cbranch_scc0 L_loader
    s_getpc_b64 s[46:47]
L_pc:
    s_lshr_b32 s48, s2, 3
    s_lshl2_add_u32 s48, s48, s34
    s_mul_i32 s48, s48, 5
    v_min_u32 v2, 4, v1
    v_add_lshl_u32 v2, s48, v2, 7
    v_min_u32 v2, L_done - L_pc, v2
    global_load_dword v78, v2, s[46:47]
    s_cmp_lt_u32 s33, 5
    s_cbranch_scc1 P1B_QQQ
    s_cmp_eq_u32 s33, 5
    s_cbranch_scc1 P1B_QKK
    s_cmp_lt_u32 s33, 10
    s_cbranch_scc1 P1B_KKK
    s_cmp_eq_u32 s33, 10
    s_cbranch_scc1 P1B_KKV
    s_branch P1B_VVV
L_loader:
    s_setprio 3
    v_lshrrev_b32 v3, 3, v1
    v_lshrrev_b32 v4, 4, v1
    v_and_b32 v5, 7, v1
    v_xor_b32 v5, v5, v4
    s_lshl2_add_u32 s40, s32, s35
    v_lshl_add_u32 v3, s40, 5, v3
    v_mul_u32_u24 v3, 896, v3
    v_lshl_add_u32 v240, v5, 4, v3
    v_xor_b32 v241, 64, v240
    v_add_u32 v241, 6144, v241
    v_add_u32 v242, 12288, v240
    v_add_u32 v243, 12288, v241
    s_mul_i32 s54, s33, 168
    s_and_b32 s37, s54, 15
    s_sub_u32 s54, s54, s37
    s_mul_i32 s40, s35, 192
    s_movk_i32 s41, 2688
    s_movk_i32 s42, -176
    v_add_u32 v3, s40, v1
    v_lshlrev_b32 v5, 4, v3
    v_mul_u32_u24 v3, 745, v3
    v_lshrrev_b32 v4, 13, v3
    v_and_b32 v6, 7, v4
    v_mul_u32_u24 v6, 9, v6
    v_lshrrev_b32 v6, 1, v6
    v_bfi_b32 v6, 7, v6, v4
    v_mad_i32_i24 v4, v4, s42, v5
    v_mad_u32_u24 v244, v6, s41, v4
    v_add_u32 v3, 47680, v3
    v_lshrrev_b32 v4, 13, v3
    v_and_b32 v6, 7, v4
    v_mul_u32_u24 v6, 9, v6
    v_lshrrev_b32 v6, 1, v6
    v_bfi_b32 v6, 7, v6, v4
    v_mad_i32_i24 v4, v4, s42, v5
    v_mad_u32_u24 v245, v6, s41, v4
    v_add_u32 v3, 47680, v3
    v_lshrrev_b32 v4, 13, v3
    v_and_b32 v6, 7, v4
    v_mul_u32_u24 v6, 9, v6
    v_lshrrev_b32 v6, 1, v6
    v_bfi_b32 v6, 7, v6, v4
    v_mad_i32_i24 v4, v4, s42, v5
    v_mad_u32_u24 v246, v6, s41, v4
    s_cmp_eq_u32 s35, 3
    s_cselect_b32 s40, 0x40000000, 0
    v_add_u32 v246, s40, v246
    s_mul_i32 s53, s63, 172032
    s_add_u32 s53, s54, s53
    s_lshl_b32 s58, s35, 12
    s_mul_i32 s59, s35, 3072
    s_lshl_b32 s52, s63, 7
    s_mov_b32 s26, 1835008
    s_mov_b32 s27, 0x20000
    s_mov_b32 s66, 1204224
    s_mov_b32 s67, s27
    s_mov_b32 m0, s58
    s_waitcnt lgkmcnt(0)
    s_mov_b64 s[24:25], s[4:5]
    buffer_load_dwordx4 v240, s[24:27], s52 offen offset:0  lds
    buffer_load_dwordx4 v241, s[24:27], s52 offen offset:1024  lds
    buffer_load_dwordx4 v242, s[24:27], s52 offen offset:2048  lds
    buffer_load_dwordx4 v243, s[24:27], s52 offen offset:3072  lds
    s_add_u32 m0, s59, 98304
    s_mov_b64 s[64:65], s[12:13]
    buffer_load_dwordx4 v244, s[64:67], s53 offen offset:0  lds
    buffer_load_dwordx4 v245, s[64:67], s53 offen offset:1024  lds
    buffer_load_dwordx4 v246, s[64:67], s53 offen offset:2048  lds
    s_cmp_lg_u32 s35, 3
    s_cbranch_scc1 L_nogate
    v_lshl_add_u32 v2, v1, 4, s52
    v_subrev_u32 v4, 896, v2
    v_min_u32 v2, v2, v4
    s_mov_b32 m0, 159744
    s_mov_b32 s96, s16
    s_and_b32 s97, s17, 0xffff
    s_mov_b32 s98, 896
    s_mov_b32 s99, 0x20000
    buffer_load_dwordx4 v2, s[96:99], 0 offen lds
L_nogate:
    s_mov_b32 s16, s63
    s_add_u32 m0, s59, 110592
    s_add_u32 s3, s16, 1
    s_sub_u32 s53, s3, 7
    s_cselect_b32 s3, s3, s53
    s_mul_i32 s53, s3, 172032
    s_add_u32 s53, s54, s53
    buffer_load_dwordx4 v244, s[64:67], s53 offen offset:0  lds
    buffer_load_dwordx4 v245, s[64:67], s53 offen offset:1024  lds
    buffer_load_dwordx4 v246, s[64:67], s53 offen offset:2048  lds
    s_add_u32 m0, s58, 16384
    s_lshl_b32 s52, s3, 7
    buffer_load_dwordx4 v240, s[24:27], s52 offen offset:0  lds
    buffer_load_dwordx4 v241, s[24:27], s52 offen offset:1024  lds
    buffer_load_dwordx4 v242, s[24:27], s52 offen offset:2048  lds
    buffer_load_dwordx4 v243, s[24:27], s52 offen offset:3072  lds
    s_setprio 0
    s_waitcnt vmcnt(7)
    s_barrier
    s_add_u32 m0, s59, 122880
    s_add_u32 s3, s16, 2
    s_sub_u32 s53, s3, 7
    s_cselect_b32 s3, s3, s53
    s_mul_i32 s53, s3, 172032
    s_add_u32 s53, s54, s53
    buffer_load_dwordx4 v244, s[64:67], s53 offen offset:0  lds
    buffer_load_dwordx4 v245, s[64:67], s53 offen offset:1024  lds
    buffer_load_dwordx4 v246, s[64:67], s53 offen offset:2048  lds
    s_add_u32 m0, s58, 32768
    s_lshl_b32 s52, s3, 7
    buffer_load_dwordx4 v240, s[24:27], s52 offen offset:0  lds
    buffer_load_dwordx4 v241, s[24:27], s52 offen offset:1024  lds
    buffer_load_dwordx4 v242, s[24:27], s52 offen offset:2048  lds
    buffer_load_dwordx4 v243, s[24:27], s52 offen offset:3072  lds
    s_xor_b32 s62, s33, 1
    s_lshr_b32 s40, s33, 1
    s_cmp_eq_u32 s40, 2
    s_cselect_b32 s62, s33, s62
    s_cmp_eq_u32 s40, 5
    s_cselect_b32 s62, s33, s62
    s_mul_i32 s55, s62, 168
    s_and_b32 s39, s55, 15
    s_sub_u32 s55, s55, s39
    s_mov_b32 s68, s6
    s_and_b32 s69, s7, 0xffff
    s_mov_b32 s70, 1204224
    s_mov_b32 s71, 0x20000
    s_mov_b32 s28, s22
    s_and_b32 s29, s23, 0xffff
    s_mov_b32 s30, 22020096
    s_mov_b32 s31, 0x20000
    s_mov_b32 s96, s20
    s_and_b32 s97, s21, 0xffff
    s_mov_b32 s98, 256
    s_mov_b32 s99, 0x20000
    s_lshl_b32 s39, s35, 12
    s_lshl_b32 s40, s32, 2
    s_add_u32 s40, s40, s35
    s_mov_b32 s60, 0
    s_lshl_b32 s41, s33, 6
    s_add_u32 s41, s41, s40
    s_lshl_b32 s41, s41, 11
    s_add_u32 s41, s41, 8388608
    s_add_u32 s42, s41, 2097152
    s_lshl_b32 s45, s40, 5
    s_add_u32 s45, s45, s33
    s_lshl_b32 s43, s45, 11
    s_add_u32 s43, s43, 12582912
    s_add_u32 s44, s43, 32768
    s_lshl_b32 s45, s45, 7
    s_add_u32 s45, s45, 21233664
    s_mov_b32 s56, 1400897536
    s_mov_b32 s57, 729808896
    s_lshr_b32 s38, s2, 3
    s_mul_i32 s36, s38, 37
    s_lshr_b32 s36, s36, 8
    s_mul_i32 s37, s36, 7
    s_sub_u32 s37, s38, s37
    s_and_b32 s46, s2, 1
    s_lshl_b32 s46, s46, 4
    s_add_u32 s36, s36, s46
    s_and_b32 s46, s2, 6
    s_lshl_b32 s46, s46, 1
    s_add_u32 s36, s36, s46
    s_cmp_eq_u32 s35, 3
    s_cselect_b32 s49, 4294952960, 0
    v_mov_b32 v32, 0
    v_mov_b32 v33, 0
    v_mov_b32 v34, 0
    v_mov_b32 v35, 0
    v_mov_b32 v36, 0
    v_mov_b32 v37, 0
    v_mov_b32 v38, 0
    v_mov_b32 v39, 0
    v_mov_b32 v40, 0
    v_mov_b32 v41, 0
    v_mov_b32 v42, 0
    v_mov_b32 v43, 0
    v_mov_b32 v44, 0
    v_mov_b32 v45, 0
    v_mov_b32 v46, 0
    v_mov_b32 v47, 0
    v_mov_b32 v48, 0
    v_mov_b32 v49, 0
    v_mov_b32 v50, 0
    v_mov_b32 v51, 0
    v_mov_b32 v52, 0
    v_mov_b32 v53, 0
    v_mov_b32 v54, 0
    v_mov_b32 v55, 0
    v_mov_b32 v56, 0
    v_mov_b32 v57, 0
    v_mov_b32 v58, 0
    v_mov_b32 v59, 0
    v_mov_b32 v60, 0
    v_mov_b32 v61, 0
    v_mov_b32 v62, 0
    v_mov_b32 v63, 0
    v_mov_b32 v208, 0
    v_mov_b32 v209, 0
    v_mov_b32 v210, 0
    v_mov_b32 v211, 0
    v_mov_b32 v212, 0
    v_mov_b32 v213, 0
    v_mov_b32 v214, 0
    v_mov_b32 v215, 0
    v_mov_b32 v216, 0
    v_mov_b32 v217, 0
    v_mov_b32 v218, 0
    v_mov_b32 v219, 0
    v_mov_b32 v220, 0
    v_mov_b32 v221, 0
    v_mov_b32 v222, 0
    v_mov_b32 v223, 0
    s_waitcnt vmcnt(7)
    s_barrier
    s_add_u32 m0, s59, 135168
    s_add_u32 s3, s16, 3
    s_sub_u32 s53, s3, 7
    s_cselect_b32 s3, s3, s53
    s_mul_i32 s53, s3, 172032
    s_add_u32 s53, s54, s53
    buffer_load_dwordx4 v244, s[64:67], s53 offen offset:0  lds
    buffer_load_dwordx4 v245, s[64:67], s53 offen offset:1024  lds
    buffer_load_dwordx4 v246, s[64:67], s53 offen offset:2048  lds
    s_add_u32 m0, s58, 49152
    s_lshl_b32 s52, s3, 7
    buffer_load_dwordx4 v240, s[24:27], s52 offen offset:0  lds
    buffer_load_dwordx4 v241, s[24:27], s52 offen offset:1024  lds
    buffer_load_dwordx4 v242, s[24:27], s52 offen offset:2048  lds
    buffer_load_dwordx4 v243, s[24:27], s52 offen offset:3072  lds
    s_waitcnt vmcnt(7)
    s_barrier
    s_add_u32 m0, s59, 147456
    s_add_u32 s3, s16, 4
    s_sub_u32 s53, s3, 7
    s_cselect_b32 s3, s3, s53
    s_mul_i32 s53, s3, 172032
    s_add_u32 s53, s54, s53
    buffer_load_dwordx4 v244, s[64:67], s53 offen offset:0  lds
    buffer_load_dwordx4 v245, s[64:67], s53 offen offset:1024  lds
    buffer_load_dwordx4 v246, s[64:67], s53 offen offset:2048  lds
    s_add_u32 m0, s58, 0
    s_lshl_b32 s52, s3, 7
    buffer_load_dwordx4 v240, s[24:27], s52 offen offset:0  lds
    buffer_load_dwordx4 v241, s[24:27], s52 offen offset:1024  lds
    buffer_load_dwordx4 v242, s[24:27], s52 offen offset:2048  lds
    buffer_load_dwordx4 v243, s[24:27], s52 offen offset:3072  lds
    s_waitcnt vmcnt(7)
    s_barrier
    s_add_u32 m0, s59, 98304
    s_add_u32 s3, s16, 5
    s_sub_u32 s53, s3, 7
    s_cselect_b32 s3, s3, s53
    s_mul_i32 s53, s3, 172032
    s_add_u32 s53, s54, s53
    buffer_load_dwordx4 v244, s[64:67], s53 offen offset:0  lds
    buffer_load_dwordx4 v245, s[64:67], s53 offen offset:1024  lds
    buffer_load_dwordx4 v246, s[64:67], s53 offen offset:2048  lds
    s_add_u32 m0, s58, 16384
    s_lshl_b32 s52, s3, 7
    buffer_load_dwordx4 v240, s[24:27], s52 offen offset:0  lds
    buffer_load_dwordx4 v241, s[24:27], s52 offen offset:1024  lds
    buffer_load_dwordx4 v242, s[24:27], s52 offen offset:2048  lds
    buffer_load_dwordx4 v243, s[24:27], s52 offen offset:3072  lds
    buffer_load_dwordx2 v[238:239], off, s[96:99], 0 sc1
    s_waitcnt vmcnt(8)
    s_barrier
    s_add_u32 m0, s59, 110592
    s_add_u32 s3, s16, 6
    s_sub_u32 s53, s3, 7
    s_cselect_b32 s3, s3, s53
    s_mul_i32 s53, s3, 172032
    s_add_u32 s53, s54, s53
    buffer_load_dwordx4 v244, s[64:67], s53 offen offset:0  lds
    buffer_load_dwordx4 v245, s[64:67], s53 offen offset:1024  lds
    buffer_load_dwordx4 v246, s[64:67], s53 offen offset:2048  lds
    s_add_u32 m0, s58, 32768
    s_lshl_b32 s52, s3, 7
    buffer_load_dwordx4 v240, s[24:27], s52 offen offset:0  lds
    buffer_load_dwordx4 v241, s[24:27], s52 offen offset:1024  lds
    buffer_load_dwordx4 v242, s[24:27], s52 offen offset:2048  lds
    buffer_load_dwordx4 v243, s[24:27], s52 offen offset:3072  lds
    s_waitcnt vmcnt(8)
    s_barrier
    s_add_u32 m0, s59, 65536
    s_add_u32 s3, s16, 0
    s_sub_u32 s53, s3, 7
    s_cselect_b32 s3, s3, s53
    s_mul_i32 s53, s3, 172032
    s_add_u32 s53, s55, s53
    buffer_load_dwordx4 v244, s[68:71], s53 offen offset:0  lds
    buffer_load_dwordx4 v245, s[68:71], s53 offen offset:1024  lds
    buffer_load_dwordx4 v246, s[68:71], s53 offen offset:2048  lds
    s_add_u32 m0, s59, 77824
    s_add_u32 s3, s16, 1
    s_sub_u32 s53, s3, 7
    s_cselect_b32 s3, s3, s53
    s_mul_i32 s53, s3, 172032
    s_add_u32 s53, s55, s53
    buffer_load_dwordx4 v244, s[68:71], s53 offen offset:0  lds
    buffer_load_dwordx4 v245, s[68:71], s53 offen offset:1024  lds
    buffer_load_dwordx4 v246, s[68:71], s53 offen offset:2048  lds
    s_waitcnt vmcnt(6)
    s_barrier
    s_add_u32 m0, s59, 122880
    s_add_u32 s3, s16, 2
    s_sub_u32 s53, s3, 7
    s_cselect_b32 s3, s3, s53
    s_mul_i32 s53, s3, 172032
    s_add_u32 s53, s55, s53
    buffer_load_dwordx4 v244, s[68:71], s53 offen offset:0  lds
    buffer_load_dwordx4 v245, s[68:71], s53 offen offset:1024  lds
    buffer_load_dwordx4 v246, s[68:71], s53 offen offset:2048  lds
    s_and_b32 s4, s34, 1
    s_lshr_b32 s5, s34, 1
    s_lshl_b32 s46, s36, 1
    s_add_u32 s46, s46, s4
    s_lshl_b32 s47, s46, 5
    s_xor_b32 s48, s5, 2
    s_lshl_b32 s48, s48, 3
    s_add_u32 s47, s47, s48
    s_lshl_b32 s6, s47, 11
    s_add_u32 s6, s6, 12582912
    s_lshl_b32 s7, s47, 7
    s_add_u32 s7, s7, 21233664
    s_min_u32 s62, s39, 10240
    v_lshlrev_b32 v8, 4, v1
    v_mov_b32 v13, 0xdddddddd
    v_add_u32 v12, s39, v8
    v_mov_b32 v237, 0
    v_mov_b32 v227, 1
    v_and_b32 v2, 0x23, v1
    v_bfe_u32 v3, v1, 2, 1
    v_lshl_add_u32 v2, v3, 4, v2
    v_bfe_u32 v3, v1, 3, 2
    v_lshl_add_u32 v2, v3, 2, v2
    v_lshlrev_b32 v248, 4, v2
    s_and_b32 s46, s35, 1
    s_lshl_b32 s46, s46, 13
    s_and_b32 s46, s46, 0x2000
    v_add_u32 v10, s46, v8
    v_add_u32 v250, s46, v248
    v_lshrrev_b32 v3, 3, v1
    s_lshl_b32 s46, s35, 5
    v_add_u32 v3, s46, v3
    v_mul_u32_u24 v3, 896, v3
    v_and_b32 v4, 7, v1
    v_bfe_u32 v5, v1, 4, 1
    v_lshlrev_b32 v5, 2, v5
    v_xor_b32 v4, v4, v5
    v_lshl_add_u32 v3, v4, 4, v3
    s_lshl_b32 s46, s37, 7
    v_add_u32 v15, s46, v3
    s_mov_b32 s63, 0
    s_add_u32 s46, s33, 16
    s_mul_i32 s46, s46, 43
    s_lshr_b32 s46, s46, 7
    s_add_u32 s47, s33, 32
    s_mul_i32 s47, s47, 43
    s_lshr_b32 s47, s47, 7
    s_mul_i32 s48, s33, 43
    s_lshr_b32 s48, s48, 7
    s_lshl_b32 s46, s46, 6
    s_lshl_b32 s47, s47, 6
    s_lshl_b32 s48, s48, 6
    s_add_u32 s48, s48, s40
    v_and_b32 v2, 15, v1
    v_lshl_add_u32 v2, v2, 2, s35
    v_add_u32 v3, s46, v2
    v_add_u32 v4, s47, v2
    v_mov_b32 v5, s48
    v_cmp_gt_u32 vcc, 16, v1
    v_cmp_gt_u32 s[12:13], 32, v1
    s_nop 0
    v_cndmask_b32 v3, v4, v3, vcc
    v_cndmask_b32 v235, v5, v3, s[12:13]
    v_lshlrev_b32 v235, 7, v235
    v_add_u32 v235, 21102592, v235
    v_and_b32 v2, 3, v1
    v_min_u32 v2, 2, v2
    v_sub_u32 v2, s32, v2
    v_max_i32 v2, 0, v2
    s_sub_u32 s50, 3, s35
    v_lshl_add_u32 v2, v2, 2, s50
    v_add_u32 v3, s46, v2
    v_add_u32 v4, s47, v2
    v_cmp_gt_u32 vcc, 4, v1
    v_cmp_gt_u32 s[12:13], 8, v1
    s_nop 0
    v_cndmask_b32 v3, v4, v3, vcc
    v_cndmask_b32 v236, v5, v3, s[12:13]
    v_lshlrev_b32 v236, 7, v236
    v_add_u32 v236, 20971520, v236
    s_add_u32 s47, s39, 65536
    s_lshl_b32 s46, s32, 2
    s_add_u32 s46, s46, 3
    s_sub_u32 s46, s46, s35
    s_lshl_b32 s46, s46, 12
    v_add_u32 v224, s46, v8
    v_subrev_u32 v225, 16384, v224
    v_subrev_u32 v226, 32768, v224
    s_sub_u32 s46, 65536 + 32768 + 3*4096, s39
    v_add_u32 v9, s46, v8
    v_add_u32 v249, s46, v248
    v_add_u32 v11, 131072, v10
    v_add_u32 v251, 131072, v250
    v_add_u32 v10, 65536, v10
    v_add_u32 v250, 65536, v250
    s_waitcnt vmcnt(0)
    s_barrier
    s_add_u32 m0, s59, 0
    s_add_u32 s3, s16, 3
    s_sub_u32 s53, s3, 7
    s_cselect_b32 s3, s3, s53
    s_mul_i32 s53, s3, 172032
    s_add_u32 s53, s55, s53
    buffer_load_dwordx4 v244, s[68:71], s53 offen offset:0  lds
    buffer_load_dwordx4 v245, s[68:71], s53 offen offset:1024  lds
    buffer_load_dwordx4 v246, s[68:71], s53 offen offset:2048  lds
    s_add_u32 m0, s59, 135168
    s_add_u32 s3, s16, 4
    s_sub_u32 s53, s3, 7
    s_cselect_b32 s3, s3, s53
    s_mul_i32 s53, s3, 172032
    s_add_u32 s53, s55, s53
    buffer_load_dwordx4 v244, s[68:71], s53 offen offset:0  lds
    buffer_load_dwordx4 v245, s[68:71], s53 offen offset:1024  lds
    buffer_load_dwordx4 v246, s[68:71], s53 offen offset:2048  lds
    s_add_u32 m0, s59, 32768
    s_add_u32 s3, s16, 5
    s_sub_u32 s53, s3, 7
    s_cselect_b32 s3, s3, s53
    s_mul_i32 s53, s3, 172032
    s_add_u32 s53, s55, s53
    buffer_load_dwordx4 v244, s[68:71], s53 offen offset:0  lds
    buffer_load_dwordx4 v245, s[68:71], s53 offen offset:1024  lds
    buffer_load_dwordx4 v246, s[68:71], s53 offen offset:2048  lds
    s_add_u32 m0, s59, 147456
    s_add_u32 s3, s16, 6
    s_sub_u32 s53, s3, 7
    s_cselect_b32 s3, s3, s53
    s_mul_i32 s53, s3, 172032
    s_add_u32 s53, s55, s53
    buffer_load_dwordx4 v244, s[68:71], s53 offen offset:0  lds
    buffer_load_dwordx4 v245, s[68:71], s53 offen offset:1024  lds
    buffer_load_dwordx4 v246, s[68:71], s53 offen offset:2048  lds
    s_waitcnt vmcnt(6)
    s_barrier
    v_and_b32 v3, 31, v1
    v_lshrrev_b32 v2, 5, v1
    v_lshlrev_b32 v2, 4, v2
    v_sub_u32 v3, v3, v2
    v_mov_b32 v2, 4278190080
    v_cmp_le_i32 s[10:11], 0, v3
    v_cmp_le_i32 s[12:13], 1, v3
    s_nop 0
    v_cndmask_b32 v192, v2, 0, s[10:11]
    v_cndmask_b32 v193, v2, 0, s[12:13]
    v_cmp_le_i32 s[10:11], 2, v3
    v_cmp_le_i32 s[12:13], 3, v3
    s_nop 0
    v_cndmask_b32 v194, v2, 0, s[10:11]
    v_cndmask_b32 v195, v2, 0, s[12:13]
    v_cmp_le_i32 s[10:11], 4, v3
    v_cmp_le_i32 s[12:13], 5, v3
    s_nop 0
    v_cndmask_b32 v196, v2, 0, s[10:11]
    v_cndmask_b32 v197, v2, 0, s[12:13]
    v_cmp_le_i32 s[10:11], 6, v3
    v_cmp_le_i32 s[12:13], 7, v3
    s_nop 0
    v_cndmask_b32 v198, v2, 0, s[10:11]
    v_cndmask_b32 v199, v2, 0, s[12:13]
    v_cmp_le_i32 s[10:11], 8, v3
    v_cmp_le_i32 s[12:13], 9, v3
    s_nop 0
    v_cndmask_b32 v200, v2, 0, s[10:11]
    v_cndmask_b32 v201, v2, 0, s[12:13]
    v_cmp_le_i32 s[10:11], 10, v3
    v_cmp_le_i32 s[12:13], 11, v3
    s_nop 0
    v_cndmask_b32 v202, v2, 0, s[10:11]
    v_cndmask_b32 v203, v2, 0, s[12:13]
    v_cmp_le_i32 s[10:11], 12, v3
    v_cmp_le_i32 s[12:13], 13, v3
    s_nop 0
    v_cndmask_b32 v204, v2, 0, s[10:11]
    v_cndmask_b32 v205, v2, 0, s[12:13]
    v_cmp_le_i32 s[10:11], 14, v3
    v_cmp_le_i32 s[12:13], 15, v3
    s_nop 0
    v_cndmask_b32 v206, v2, 0, s[10:11]
    v_cndmask_b32 v207, v2, 0, s[12:13]
    s_waitcnt vmcnt(0)
    s_mov_b32 s61, 65536
go_b_lp_2:
    v_cmp_eq_u32 vcc, 0, v238
    s_sub_u32 s61, s61, 1
    s_cselect_b64 vcc, 0, vcc
    s_cbranch_vccz go_b_ok_1
    s_sleep 8
    buffer_load_dwordx2 v[238:239], off, s[96:99], 0 sc1
    s_waitcnt vmcnt(0)
    s_branch go_b_lp_2
go_b_ok_1:
    v_readfirstlane_b32 s100, v238
    v_readfirstlane_b32 s101, v239
    s_nop 1
    s_waitcnt lgkmcnt(0)
    s_lshl_b32 s46, s33, 18
    s_add_u32 s10, s22, s46
    s_addc_u32 s11, s23, 0
    s_mov_b32 s64, s10
    s_and_b32 s65, s11, 0xffff
    s_mov_b32 s66, 262144
    s_mov_b32 s67, 0x20000
    s_add_u32 s10, s10, 4194304
    s_addc_u32 s11, s11, 0
    s_mov_b32 s68, s10
    s_and_b32 s69, s11, 0xffff
    s_mov_b32 s70, 262144
    s_mov_b32 s71, 0x20000
    s_mov_b32 s24, s14
    s_and_b32 s25, s15, 0xffff
    s_mov_b32 s26, 401408
    s_mov_b32 s27, 0x20000
    s_setprio 3
    s_barrier
    v_mov_b64 v[232:233], 0
    s_mov_b32 exec_lo, 33620481
    s_mov_b32 exec_hi, 1
    s_mov_b32 s61, 65536
    buffer_load_dwordx2 v[232:233], v235, s[28:31], 0 offen sc1
    s_waitcnt vmcnt(0)
f1b_lp_4:
    v_cmp_ne_u64 vcc, s[100:101], v[232:233]
    s_sub_u32 s61, s61, 1
    s_cselect_b64 vcc, 0, vcc
    s_cbranch_vccz f1b_ok_3
    s_mov_b64 exec, vcc
    s_sleep 1
    buffer_load_dwordx2 v[232:233], v235, s[28:31], 0 offen sc1
    s_waitcnt vmcnt(0)
    s_branch f1b_lp_4
f1b_ok_3:
    s_mov_b64 exec, -1
L_b_restart:
    buffer_load_dwordx4 v[16:19], v8, s[28:31], s42 offen sc1
    buffer_load_dwordx4 v[20:23], v8, s[28:31], s42 offen offset:1024 sc1
    s_add_u32 m0, s39, 0
    s_mov_b32 s48, 0
    buffer_load_dwordx4 v12, s[68:71], s48 offen offset:0 sc1 lds
    buffer_load_dwordx4 v12, s[68:71], s48 offen offset:1024 sc1 lds
    buffer_load_dwordx4 v12, s[68:71], s48 offen offset:2048 sc1 lds
    buffer_load_dwordx4 v12, s[68:71], s48 offen offset:3072 sc1 lds
    s_add_u32 m0, s47, 0
    s_mov_b32 s48, 147456
    buffer_load_dwordx4 v12, s[68:71], s48 offen offset:0 sc1 lds
    buffer_load_dwordx4 v12, s[68:71], s48 offen offset:1024 sc1 lds
    buffer_load_dwordx4 v12, s[68:71], s48 offen offset:2048 sc1 lds
    buffer_load_dwordx4 v12, s[68:71], s48 offen offset:3072 sc1 lds
    s_mov_b32 exec_lo, 4294967295
    buffer_load_dwordx2 v[232:233], v235, s[28:31], 0 offen sc1
    s_mov_b32 exec_lo, -1
    s_waitcnt vmcnt(7)
    ds_read_b128 v[152:155], v12
    ds_read_b128 v[156:159], v12 offset:1024
    s_waitcnt lgkmcnt(0)
    s_cmp_lg_u32 s60, 0
    s_cbranch_scc1 fbq_5
    v_mfma_f32_32x32x16_bf16 v[64:79], v[152:155], v[16:19], 0
    v_mfma_f32_32x32x16_bf16 v[64:79], v[156:159], v[20:23], v[64:79]
    s_nop 11
    v_max3_f32 v2, v64, v65, v66
    v_max3_f32 v3, v67, v68, v69
    v_max3_f32 v2, v2, v70, v71
    v_max3_f32 v3, v3, v72, v73
    v_max3_f32 v2, v2, v74, v75
    v_max3_f32 v3, v3, v76, v77
    v_max3_f32 v2, v2, v78, v79
    v_max_f32 v3, v2, v3
    v_mov_b32 v4, v3
    s_nop 1
    v_permlane32_swap_b32 v3, v4
    s_nop 1
    v_max_f32 v2, v3, v4
    s_mov_b32 exec_lo, 0
    v_cvt_pk_bf16_f32 v22, -v2, 0
    s_mov_b32 exec_lo, -1
    s_branch fbq_e_6
fbq_5:
    s_mov_b32 exec_lo, 0
    v_mov_b64 v[22:23], v[228:229]
    s_mov_b32 exec_lo, -1
fbq_e_6:
    s_nop 1
    ds_write_b128 v12, v[16:19] offset:49152
    ds_write_b128 v12, v[20:23] offset:50176
    s_waitcnt vmcnt(0) lgkmcnt(0)
    s_mov_b32 exec_lo, 4294967295
    s_mov_b32 s61, 65536
f1c_lp_8:
    v_cmp_ne_u64 vcc, s[100:101], v[232:233]
    s_sub_u32 s61, s61, 1
    s_cselect_b64 vcc, 0, vcc
    s_cbranch_vccz f1c_ok_7
    s_mov_b64 exec, vcc
    s_sleep 1
    buffer_load_dwordx2 v[232:233], v235, s[28:31], 0 offen sc1
    s_waitcnt vmcnt(0)
    s_branch f1c_lp_8
f1c_ok_7:
    s_mov_b64 exec, -1
    s_add_u32 m0, s39, 16384
    s_mov_b32 s48, 16384
    buffer_load_dwordx4 v12, s[68:71], s48 offen offset:0 sc1 lds
    buffer_load_dwordx4 v12, s[68:71], s48 offen offset:1024 sc1 lds
    buffer_load_dwordx4 v12, s[68:71], s48 offen offset:2048 sc1 lds
    buffer_load_dwordx4 v12, s[68:71], s48 offen offset:3072 sc1 lds
    s_add_u32 m0, s47, 16384
    s_mov_b32 s48, 163840
    buffer_load_dwordx4 v12, s[68:71], s48 offen offset:0 sc1 lds
    buffer_load_dwordx4 v12, s[68:71], s48 offen offset:1024 sc1 lds
    buffer_load_dwordx4 v12, s[68:71], s48 offen offset:2048 sc1 lds
    buffer_load_dwordx4 v12, s[68:71], s48 offen offset:3072 sc1 lds
    s_barrier
    v_xor_b32 v2, 4096, v12
    ds_read_b128 v[240:243], v2 offset:49152
    ds_read_b128 v[244:247], v2 offset:50176
    ds_read_b128 v[128:131], v250 offset:0
    ds_read_b128 v[132:135], v250 offset:1024
    ds_read_b128 v[136:139], v250 offset:4096
    ds_read_b128 v[140:143], v250 offset:5120
    ds_read_b128 v[160:163], v10 offset:2048
    ds_read_b128 v[164:167], v10 offset:3072
    s_waitcnt lgkmcnt(4)
    v_mfma_f32_32x32x16_bf16 v[64:79], v[128:131], v[240:243], 0
    v_mfma_f32_32x32x16_bf16 v[64:79], v[132:135], v[244:247], v[64:79]
    v_and_b32 v3, 31, v1
    s_lshl_b32 s46, s35, 7
    s_add_u32 s46, s46, 161792
    v_lshl_add_u32 v3, v3, 2, s46
    ds_read_b32 v14, v3
    s_nop 0
    s_nop 2
    v_mfma_f32_32x32x16_bf16 v[80:95], v[128:131], v[16:19], 0
    s_add_u32 m0, s47, 32768
    s_nop 3
    v_exp_f32 v64, v64
    v_exp_f32 v65, v65
    v_exp_f32 v66, v66
    v_exp_f32 v67, v67
    v_mfma_f32_32x32x16_bf16 v[80:95], v[132:135], v[20:23], v[80:95]
    s_mov_b32 s48, 180224
    v_exp_f32 v68, v68
    v_exp_f32 v69, v69
    v_exp_f32 v70, v70
    v_exp_f32 v71, v71
    s_waitcnt lgkmcnt(0)
    ds_read_b128 v[168:171], v10 offset:6144
    v_exp_f32 v72, v72
    v_exp_f32 v73, v73
    v_exp_f32 v74, v74
    v_exp_f32 v75, v75
    v_smfmac_f32_32x32x32_bf16 v[208:223], v[160:163], v[64:71], v13
    s_setprio 0
    ds_read_b128 v[172:175], v10 offset:7168
    buffer_load_dwordx4 v12, s[68:71], s48 offen offset:0 sc1 lds
    buffer_load_dwordx4 v12, s[68:71], s48 offen offset:1024 sc1 lds
    v_exp_f32 v76, v76
    v_exp_f32 v77, v77
    v_exp_f32 v78, v78
    v_exp_f32 v79, v79
    s_waitcnt vmcnt(2)
    s_barrier
    v_mfma_f32_32x32x16_bf16 v[96:111], v[136:139], v[240:243], 0
    s_setprio 3
    v_exp_f32 v80, v80
    v_exp_f32 v81, v81
    v_exp_f32 v82, v82
    v_exp_f32 v83, v83
    v_mfma_f32_32x32x16_bf16 v[96:111], v[140:143], v[244:247], v[96:111]
    v_exp_f32 v84, v84
    v_exp_f32 v85, v85
    v_exp_f32 v86, v86
    v_exp_f32 v87, v87
    v_smfmac_f32_32x32x32_bf16 v[208:223], v[164:167], v[72:79], v13
    ds_read_b128 v[144:147], v250 offset:16384
    v_exp_f32 v88, v88
    v_exp_f32 v89, v89
    v_exp_f32 v90, v90
    v_exp_f32 v91, v91
    v_smfmac_f32_32x32x32_bf16 v[32:47], v[160:163], v[80:87], v13
    ds_read_b128 v[148:151], v250 offset:17408
    buffer_load_dwordx4 v12, s[68:71], s48 offen offset:2048 sc1 lds
    buffer_load_dwordx4 v12, s[68:71], s48 offen offset:3072 sc1 lds
    v_exp_f32 v92, v92
    v_exp_f32 v93, v93
    v_exp_f32 v94, v94
    v_exp_f32 v95, v95
    v_mfma_f32_32x32x16_bf16 v[112:127], v[136:139], v[16:19], 0
    s_add_u32 m0, s47, 49152
    v_exp_f32 v96, v96
    v_exp_f32 v97, v97
    v_exp_f32 v98, v98
    v_exp_f32 v99, v99
    v_mfma_f32_32x32x16_bf16 v[112:127], v[140:143], v[20:23], v[112:127]
    s_mov_b32 s48, 196608
    v_exp_f32 v100, v100
    v_exp_f32 v101, v101
    v_exp_f32 v102, v102
    v_exp_f32 v103, v103
    v_smfmac_f32_32x32x32_bf16 v[32:47], v[164:167], v[88:95], v13
    s_waitcnt lgkmcnt(0)
    ds_read_b128 v[176:179], v10 offset:18432
    v_exp_f32 v104, v104
    v_exp_f32 v105, v105
    v_exp_f32 v106, v106
    v_exp_f32 v107, v107
    v_smfmac_f32_32x32x32_bf16 v[208:223], v[168:171], v[96:103], v13
    s_setprio 2
    ds_read_b128 v[180:183], v10 offset:19456
    buffer_load_dwordx4 v12, s[68:71], s48 offen offset:0 sc1 lds
    buffer_load_dwordx4 v12, s[68:71], s48 offen offset:1024 sc1 lds
    v_exp_f32 v108, v108
    v_exp_f32 v109, v109
    v_exp_f32 v110, v110
    v_exp_f32 v111, v111
    v_mfma_f32_32x32x16_bf16 v[64:79], v[144:147], v[240:243], 0
    v_exp_f32 v112, v112
    v_exp_f32 v113, v113
    v_exp_f32 v114, v114
    v_exp_f32 v115, v115
    v_mfma_f32_32x32x16_bf16 v[64:79], v[148:151], v[244:247], v[64:79]
    v_exp_f32 v116, v116
    v_exp_f32 v117, v117
    v_exp_f32 v118, v118
    v_exp_f32 v119, v119
    v_smfmac_f32_32x32x32_bf16 v[208:223], v[172:175], v[104:111], v13
    ds_read_b128 v[152:155], v250 offset:20480
    v_exp_f32 v120, v120
    v_exp_f32 v121, v121
    v_exp_f32 v122, v122
    v_exp_f32 v123, v123
    v_smfmac_f32_32x32x32_bf16 v[32:47], v[168:171], v[112:119], v13
    s_setprio 1
    ds_read_b128 v[156:159], v250 offset:21504
    buffer_load_dwordx4 v12, s[68:71], s48 offen offset:2048 sc1 lds
    v_exp_f32 v124, v124
    v_exp_f32 v125, v125
    v_exp_f32 v126, v126
    v_exp_f32 v127, v127
    v_mfma_f32_32x32x16_bf16 v[80:95], v[144:147], v[16:19], 0
    v_exp_f32 v64, v64
    v_exp_f32 v65, v65
    v_exp_f32 v66, v66
    v_exp_f32 v67, v67
    v_mfma_f32_32x32x16_bf16 v[80:95], v[148:151], v[20:23], v[80:95]
    v_exp_f32 v68, v68
    v_exp_f32 v69, v69
    v_exp_f32 v70, v70
    v_exp_f32 v71, v71
    v_smfmac_f32_32x32x32_bf16 v[32:47], v[172:175], v[120:127], v13
    s_waitcnt lgkmcnt(0)
    ds_read_b128 v[184:187], v10 offset:22528
    v_exp_f32 v72, v72
    v_exp_f32 v73, v73
    v_exp_f32 v74, v74
    v_exp_f32 v75, v75
    v_smfmac_f32_32x32x32_bf16 v[208:223], v[176:179], v[64:71], v13
    s_setprio 0
    ds_read_b128 v[188:191], v10 offset:23552
    buffer_load_dwordx4 v12, s[68:71], s48 offen offset:3072 sc1 lds
    v_exp_f32 v76, v76
    v_exp_f32 v77, v77
    v_exp_f32 v78, v78
    v_exp_f32 v79, v79
    s_waitcnt vmcnt(4)
    s_barrier
    v_mfma_f32_32x32x16_bf16 v[96:111], v[152:155], v[240:243], 0
    s_setprio 3
    s_add_u32 m0, s47, 65536
    v_exp_f32 v80, v80
    v_exp_f32 v81, v81
    v_exp_f32 v82, v82
    v_exp_f32 v83, v83
    v_mfma_f32_32x32x16_bf16 v[96:111], v[156:159], v[244:247], v[96:111]
    s_mov_b32 s48, 212992
    v_exp_f32 v84, v84
    v_exp_f32 v85, v85
    v_exp_f32 v86, v86
    v_exp_f32 v87, v87
    v_smfmac_f32_32x32x32_bf16 v[208:223], v[180:183], v[72:79], v13
    ds_read_b128 v[128:131], v250 offset:32768
    v_exp_f32 v88, v88
    v_exp_f32 v89, v89
    v_exp_f32 v90, v90
    v_exp_f32 v91, v91
    v_smfmac_f32_32x32x32_bf16 v[32:47], v[176:179], v[80:87], v13
    ds_read_b128 v[132:135], v250 offset:33792
    buffer_load_dwordx4 v12, s[68:71], s48 offen offset:0 sc1 lds
    v_exp_f32 v92, v92
    v_exp_f32 v93, v93
    v_exp_f32 v94, v94
    v_exp_f32 v95, v95
    v_mfma_f32_32x32x16_bf16 v[112:127], v[152:155], v[16:19], 0
    v_exp_f32 v96, v96
    v_exp_f32 v97, v97
    v_exp_f32 v98, v98
    v_exp_f32 v99, v99
    v_mfma_f32_32x32x16_bf16 v[112:127], v[156:159], v[20:23], v[112:127]
    v_exp_f32 v100, v100
    v_exp_f32 v101, v101
    v_exp_f32 v102, v102
    v_exp_f32 v103, v103
    v_smfmac_f32_32x32x32_bf16 v[32:47], v[180:183], v[88:95], v13
    s_waitcnt lgkmcnt(0)
    ds_read_b128 v[160:163], v10 offset:34816
    v_exp_f32 v104, v104
    v_exp_f32 v105, v105
    v_exp_f32 v106, v106
    v_exp_f32 v107, v107
    v_smfmac_f32_32x32x32_bf16 v[208:223], v[184:187], v[96:103], v13
    s_setprio 2
    ds_read_b128 v[164:167], v10 offset:35840
    buffer_load_dwordx4 v12, s[68:71], s48 offen offset:1024 sc1 lds
    v_exp_f32 v108, v108
    v_exp_f32 v109, v109
    v_exp_f32 v110, v110
    v_exp_f32 v111, v111
    v_mfma_f32_32x32x16_bf16 v[64:79], v[128:131], v[240:243], 0
    v_exp_f32 v112, v112
    v_exp_f32 v113, v113
    v_exp_f32 v114, v114
    v_exp_f32 v115, v115
    v_mfma_f32_32x32x16_bf16 v[64:79], v[132:135], v[244:247], v[64:79]
    v_exp_f32 v116, v116
    v_exp_f32 v117, v117
    v_exp_f32 v118, v118
    v_exp_f32 v119, v119
    v_smfmac_f32_32x32x32_bf16 v[208:223], v[188:191], v[104:111], v13
    ds_read_b128 v[136:139], v250 offset:36864
    v_exp_f32 v120, v120
    v_exp_f32 v121, v121
    v_exp_f32 v122, v122
    v_exp_f32 v123, v123
    v_smfmac_f32_32x32x32_bf16 v[32:47], v[184:187], v[112:119], v13
    s_setprio 1
    ds_read_b128 v[140:143], v250 offset:37888
    buffer_load_dwordx4 v12, s[68:71], s48 offen offset:2048 sc1 lds
    v_exp_f32 v124, v124
    v_exp_f32 v125, v125
    v_exp_f32 v126, v126
    v_exp_f32 v127, v127
    v_mfma_f32_32x32x16_bf16 v[80:95], v[128:131], v[16:19], 0
    v_exp_f32 v64, v64
    v_exp_f32 v65, v65
    v_exp_f32 v66, v66
    v_exp_f32 v67, v67
    v_mfma_f32_32x32x16_bf16 v[80:95], v[132:135], v[20:23], v[80:95]
    v_exp_f32 v68, v68
    v_exp_f32 v69, v69
    v_exp_f32 v70, v70
    v_exp_f32 v71, v71
    v_smfmac_f32_32x32x32_bf16 v[32:47], v[188:191], v[120:127], v13
    s_waitcnt lgkmcnt(0)
    ds_read_b128 v[168:171], v10 offset:38912
    v_exp_f32 v72, v72
    v_exp_f32 v73, v73
    v_exp_f32 v74, v74
    v_exp_f32 v75, v75
    v_smfmac_f32_32x32x32_bf16 v[208:223], v[160:163], v[64:71], v13
    s_setprio 0
    ds_read_b128 v[172:175], v10 offset:39936
    buffer_load_dwordx4 v12, s[68:71], s48 offen offset:3072 sc1 lds
    v_exp_f32 v76, v76
    v_exp_f32 v77, v77
    v_exp_f32 v78, v78
    v_exp_f32 v79, v79
    s_waitcnt vmcnt(4)
    s_barrier
    v_mfma_f32_32x32x16_bf16 v[96:111], v[136:139], v[240:243], 0
    s_setprio 3
    s_add_u32 m0, s47, 0
    v_exp_f32 v80, v80
    v_exp_f32 v81, v81
    v_exp_f32 v82, v82
    v_exp_f32 v83, v83
    v_mfma_f32_32x32x16_bf16 v[96:111], v[140:143], v[244:247], v[96:111]
    s_mov_b32 s48, 229376
    v_exp_f32 v84, v84
    v_exp_f32 v85, v85
    v_exp_f32 v86, v86
    v_exp_f32 v87, v87
    v_smfmac_f32_32x32x32_bf16 v[208:223], v[164:167], v[72:79], v13
    ds_read_b128 v[144:147], v250 offset:49152
    v_exp_f32 v88, v88
    v_exp_f32 v89, v89
    v_exp_f32 v90, v90
    v_exp_f32 v91, v91
    v_smfmac_f32_32x32x32_bf16 v[32:47], v[160:163], v[80:87], v13
    ds_read_b128 v[148:151], v250 offset:50176
    buffer_load_dwordx4 v12, s[68:71], s48 offen offset:0 sc1 lds
    v_exp_f32 v92, v92
    v_exp_f32 v93, v93
    v_exp_f32 v94, v94
    v_exp_f32 v95, v95
    v_mfma_f32_32x32x16_bf16 v[112:127], v[136:139], v[16:19], 0
    v_exp_f32 v96, v96
    v_exp_f32 v97, v97
    v_exp_f32 v98, v98
    v_exp_f32 v99, v99
    v_mfma_f32_32x32x16_bf16 v[112:127], v[140:143], v[20:23], v[112:127]
    v_exp_f32 v100, v100
    v_exp_f32 v101, v101
    v_exp_f32 v102, v102
    v_exp_f32 v103, v103
    v_smfmac_f32_32x32x32_bf16 v[32:47], v[164:167], v[88:95], v13
    s_waitcnt lgkmcnt(0)
    ds_read_b128 v[176:179], v10 offset:51200
    v_exp_f32 v104, v104
    v_exp_f32 v105, v105
    v_exp_f32 v106, v106
    v_exp_f32 v107, v107
    v_smfmac_f32_32x32x32_bf16 v[208:223], v[168:171], v[96:103], v13
    s_setprio 2
    ds_read_b128 v[180:183], v10 offset:52224
    buffer_load_dwordx4 v12, s[68:71], s48 offen offset:1024 sc1 lds
    v_exp_f32 v108, v108
    v_exp_f32 v109, v109
    v_exp_f32 v110, v110
    v_exp_f32 v111, v111
    v_mfma_f32_32x32x16_bf16 v[64:79], v[144:147], v[240:243], 0
    v_exp_f32 v112, v112
    v_exp_f32 v113, v113
    v_exp_f32 v114, v114
    v_exp_f32 v115, v115
    v_mfma_f32_32x32x16_bf16 v[64:79], v[148:151], v[244:247], v[64:79]
    v_exp_f32 v116, v116
    v_exp_f32 v117, v117
    v_exp_f32 v118, v118
    v_exp_f32 v119, v119
    v_smfmac_f32_32x32x32_bf16 v[208:223], v[172:175], v[104:111], v13
    ds_read_b128 v[152:155], v250 offset:53248
    v_exp_f32 v120, v120
    v_exp_f32 v121, v121
    v_exp_f32 v122, v122
    v_exp_f32 v123, v123
    v_smfmac_f32_32x32x32_bf16 v[32:47], v[168:171], v[112:119], v13
    s_setprio 1
    ds_read_b128 v[156:159], v250 offset:54272
    buffer_load_dwordx4 v12, s[68:71], s48 offen offset:2048 sc1 lds
    v_exp_f32 v124, v124
    v_exp_f32 v125, v125
    v_exp_f32 v126, v126
    v_exp_f32 v127, v127
    v_mfma_f32_32x32x16_bf16 v[80:95], v[144:147], v[16:19], 0
    v_exp_f32 v64, v64
    v_exp_f32 v65, v65
    v_exp_f32 v66, v66
    v_exp_f32 v67, v67
    v_mfma_f32_32x32x16_bf16 v[80:95], v[148:151], v[20:23], v[80:95]
    v_exp_f32 v68, v68
    v_exp_f32 v69, v69
    v_exp_f32 v70, v70
    v_exp_f32 v71, v71
    v_smfmac_f32_32x32x32_bf16 v[32:47], v[172:175], v[120:127], v13
    s_waitcnt lgkmcnt(0)
    ds_read_b128 v[184:187], v10 offset:55296
    v_exp_f32 v72, v72
    v_exp_f32 v73, v73
    v_exp_f32 v74, v74
    v_exp_f32 v75, v75
    v_smfmac_f32_32x32x32_bf16 v[208:223], v[176:179], v[64:71], v13
    s_setprio 0
    ds_read_b128 v[188:191], v10 offset:56320
    buffer_load_dwordx4 v12, s[68:71], s48 offen offset:3072 sc1 lds
    v_exp_f32 v76, v76
    v_exp_f32 v77, v77
    v_exp_f32 v78, v78
    v_exp_f32 v79, v79
    s_waitcnt vmcnt(4)
    s_barrier
    v_mfma_f32_32x32x16_bf16 v[96:111], v[152:155], v[240:243], 0
    s_setprio 3
    s_add_u32 m0, s47, 16384
    v_exp_f32 v80, v80
    v_exp_f32 v81, v81
    v_exp_f32 v82, v82
    v_exp_f32 v83, v83
    v_mfma_f32_32x32x16_bf16 v[96:111], v[156:159], v[244:247], v[96:111]
    s_mov_b32 s48, 245760
    v_exp_f32 v84, v84
    v_exp_f32 v85, v85
    v_exp_f32 v86, v86
    v_exp_f32 v87, v87
    v_smfmac_f32_32x32x32_bf16 v[208:223], v[180:183], v[72:79], v13
    ds_read_b128 v[128:131], v251 offset:0
    v_exp_f32 v88, v88
    v_exp_f32 v89, v89
    v_exp_f32 v90, v90
    v_exp_f32 v91, v91
    v_smfmac_f32_32x32x32_bf16 v[32:47], v[176:179], v[80:87], v13
    ds_read_b128 v[132:135], v251 offset:1024
    buffer_load_dwordx4 v12, s[68:71], s48 offen offset:0 sc1 lds
    v_exp_f32 v92, v92
    v_exp_f32 v93, v93
    v_exp_f32 v94, v94
    v_exp_f32 v95, v95
    v_mfma_f32_32x32x16_bf16 v[112:127], v[152:155], v[16:19], 0
    v_exp_f32 v96, v96
    v_exp_f32 v97, v97
    v_exp_f32 v98, v98
    v_exp_f32 v99, v99
    v_mfma_f32_32x32x16_bf16 v[112:127], v[156:159], v[20:23], v[112:127]
    v_exp_f32 v100, v100
    v_exp_f32 v101, v101
    v_exp_f32 v102, v102
    v_exp_f32 v103, v103
    v_smfmac_f32_32x32x32_bf16 v[32:47], v[180:183], v[88:95], v13
    s_waitcnt lgkmcnt(0)
    ds_read_b128 v[160:163], v11 offset:2048
    v_exp_f32 v104, v104
    v_exp_f32 v105, v105
    v_exp_f32 v106, v106
    v_exp_f32 v107, v107
    v_smfmac_f32_32x32x32_bf16 v[208:223], v[184:187], v[96:103], v13
    s_setprio 2
    ds_read_b128 v[164:167], v11 offset:3072
    buffer_load_dwordx2 v[232:233], v236, s[28:31], 0 offen sc1
    buffer_load_dwordx4 v12, s[68:71], s48 offen offset:1024 sc1 lds
    v_exp_f32 v108, v108
    v_exp_f32 v109, v109
    v_exp_f32 v110, v110
    v_exp_f32 v111, v111
    v_mfma_f32_32x32x16_bf16 v[64:79], v[128:131], v[240:243], 0
    v_exp_f32 v112, v112
    v_exp_f32 v113, v113
    v_exp_f32 v114, v114
    v_exp_f32 v115, v115
    v_mfma_f32_32x32x16_bf16 v[64:79], v[132:135], v[244:247], v[64:79]
    v_exp_f32 v116, v116
    v_exp_f32 v117, v117
    v_exp_f32 v118, v118
    v_exp_f32 v119, v119
    v_smfmac_f32_32x32x32_bf16 v[208:223], v[188:191], v[104:111], v13
    ds_read_b128 v[136:139], v251 offset:4096
    v_exp_f32 v120, v120
    v_exp_f32 v121, v121
    v_exp_f32 v122, v122
    v_exp_f32 v123, v123
    v_smfmac_f32_32x32x32_bf16 v[32:47], v[184:187], v[112:119], v13
    s_setprio 1
    ds_read_b128 v[140:143], v251 offset:5120
    buffer_load_dwordx4 v12, s[68:71], s48 offen offset:2048 sc1 lds
    v_exp_f32 v124, v124
    v_exp_f32 v125, v125
    v_exp_f32 v126, v126
    v_exp_f32 v127, v127
    v_mfma_f32_32x32x16_bf16 v[80:95], v[128:131], v[16:19], 0
    v_exp_f32 v64, v64
    v_exp_f32 v65, v65
    v_exp_f32 v66, v66
    v_exp_f32 v67, v67
    v_mfma_f32_32x32x16_bf16 v[80:95], v[132:135], v[20:23], v[80:95]
    v_exp_f32 v68, v68
    v_exp_f32 v69, v69
    v_exp_f32 v70, v70
    v_exp_f32 v71, v71
    v_smfmac_f32_32x32x32_bf16 v[32:47], v[188:191], v[120:127], v13
    s_waitcnt lgkmcnt(0)
    ds_read_b128 v[168:171], v11 offset:6144
    v_exp_f32 v72, v72
    v_exp_f32 v73, v73
    v_exp_f32 v74, v74
    v_exp_f32 v75, v75
    v_smfmac_f32_32x32x32_bf16 v[208:223], v[160:163], v[64:71], v13
    s_setprio 0
    ds_read_b128 v[172:175], v11 offset:7168
    buffer_load_dwordx4 v12, s[68:71], s48 offen offset:3072 sc1 lds
    v_exp_f32 v76, v76
    v_exp_f32 v77, v77
    v_exp_f32 v78, v78
    v_exp_f32 v79, v79
    s_waitcnt vmcnt(3)
    s_mov_b32 s61, 65536
f1a_lp_10:
    v_cmp_ne_u64 vcc, s[100:101], v[232:233]
    s_sub_u32 s61, s61, 1
    s_cselect_b64 vcc, 0, vcc
    s_cbranch_vccz f1a_ok_9
    s_mov_b64 exec, vcc
    s_sleep 2
    buffer_load_dwordx2 v[232:233], v236, s[28:31], 0 offen sc1
    s_waitcnt vmcnt(0)
    s_branch f1a_lp_10
f1a_ok_9:
    s_mov_b64 exec, -1
    s_barrier
    buffer_load_dwordx4 v[24:27], v8, s[28:31], s41 offen sc1
    buffer_load_dwordx4 v[28:31], v8, s[28:31], s41 offen offset:1024 sc1
    v_mfma_f32_32x32x16_bf16 v[96:111], v[136:139], v[240:243], 0
    s_setprio 3
    s_add_u32 m0, s47, 32768
    v_exp_f32 v80, v80
    v_exp_f32 v81, v81
    v_exp_f32 v82, v82
    v_exp_f32 v83, v83
    v_mfma_f32_32x32x16_bf16 v[96:111], v[140:143], v[244:247], v[96:111]
    s_nop 0
    v_exp_f32 v84, v84
    v_exp_f32 v85, v85
    v_exp_f32 v86, v86
    v_exp_f32 v87, v87
    v_smfmac_f32_32x32x32_bf16 v[208:223], v[164:167], v[72:79], v13
    ds_read_b128 v[144:147], v250 offset:0
    v_exp_f32 v88, v88
    v_exp_f32 v89, v89
    v_exp_f32 v90, v90
    v_exp_f32 v91, v91
    v_smfmac_f32_32x32x32_bf16 v[32:47], v[160:163], v[80:87], v13
    ds_read_b128 v[148:151], v250 offset:1024
    buffer_load_dwordx4 v224, s[64:67], 0 offen offset:0 sc1 lds
    buffer_load_dwordx4 v224, s[64:67], 0 offen offset:1024 sc1 lds
    v_exp_f32 v92, v92
    v_exp_f32 v93, v93
    v_exp_f32 v94, v94
    v_exp_f32 v95, v95
    v_mfma_f32_32x32x16_bf16 v[112:127], v[136:139], v[16:19], 0
    v_exp_f32 v96, v96
    v_exp_f32 v97, v97
    v_exp_f32 v98, v98
    v_exp_f32 v99, v99
    v_mfma_f32_32x32x16_bf16 v[112:127], v[140:143], v[20:23], v[112:127]
    v_exp_f32 v100, v100
    v_exp_f32 v101, v101
    v_exp_f32 v102, v102
    v_exp_f32 v103, v103
    v_smfmac_f32_32x32x32_bf16 v[32:47], v[164:167], v[88:95], v13
    s_waitcnt lgkmcnt(0)
    ds_read_b128 v[176:179], v10 offset:2048
    v_exp_f32 v104, v104
    v_exp_f32 v105, v105
    v_exp_f32 v106, v106
    v_exp_f32 v107, v107
    v_smfmac_f32_32x32x32_bf16 v[208:223], v[168:171], v[96:103], v13
    s_setprio 2
    ds_read_b128 v[180:183], v10 offset:3072
    buffer_load_dwordx4 v224, s[64:67], 0 offen offset:2048 sc1 lds
    buffer_load_dwordx4 v224, s[64:67], 0 offen offset:3072 sc1 lds
    v_exp_f32 v108, v108
    v_exp_f32 v109, v109
    v_exp_f32 v110, v110
    v_exp_f32 v111, v111
    v_mfma_f32_32x32x16_bf16 v[64:79], v[144:147], v[240:243], 0
    s_add_u32 m0, s47, 49152
    v_exp_f32 v112, v112
    v_exp_f32 v113, v113
    v_exp_f32 v114, v114
    v_exp_f32 v115, v115
    v_mfma_f32_32x32x16_bf16 v[64:79], v[148:151], v[244:247], v[64:79]
    s_nop 0
    v_exp_f32 v116, v116
    v_exp_f32 v117, v117
    v_exp_f32 v118, v118
    v_exp_f32 v119, v119
    v_smfmac_f32_32x32x32_bf16 v[208:223], v[172:175], v[104:111], v13
    ds_read_b128 v[152:155], v250 offset:4096
    v_exp_f32 v120, v120
    v_exp_f32 v121, v121
    v_exp_f32 v122, v122
    v_exp_f32 v123, v123
    v_smfmac_f32_32x32x32_bf16 v[32:47], v[168:171], v[112:119], v13
    s_setprio 1
    ds_read_b128 v[156:159], v250 offset:5120
    buffer_load_dwordx4 v225, s[64:67], 0 offen offset:0 sc1 lds
    buffer_load_dwordx4 v225, s[64:67], 0 offen offset:1024 sc1 lds
    v_exp_f32 v124, v124
    v_exp_f32 v125, v125
    v_exp_f32 v126, v126
    v_exp_f32 v127, v127
    v_mfma_f32_32x32x16_bf16 v[80:95], v[144:147], v[16:19], 0
    v_exp_f32 v64, v64
    v_exp_f32 v65, v65
    v_exp_f32 v66, v66
    v_exp_f32 v67, v67
    v_mfma_f32_32x32x16_bf16 v[80:95], v[148:151], v[20:23], v[80:95]
    v_exp_f32 v68, v68
    v_exp_f32 v69, v69
    v_exp_f32 v70, v70
    v_exp_f32 v71, v71
    v_smfmac_f32_32x32x32_bf16 v[32:47], v[172:175], v[120:127], v13
    s_waitcnt lgkmcnt(0)
    ds_read_b128 v[184:187], v10 offset:6144
    v_exp_f32 v72, v72
    v_exp_f32 v73, v73
    v_exp_f32 v74, v74
    v_exp_f32 v75, v75
    v_smfmac_f32_32x32x32_bf16 v[208:223], v[176:179], v[64:71], v13
    s_setprio 0
    ds_read_b128 v[188:191], v10 offset:7168
    buffer_load_dwordx4 v225, s[64:67], 0 offen offset:2048 sc1 lds
    buffer_load_dwordx4 v225, s[64:67], 0 offen offset:3072 sc1 lds
    v_exp_f32 v76, v76
    v_exp_f32 v77, v77
    v_exp_f32 v78, v78
    v_exp_f32 v79, v79
    s_waitcnt vmcnt(10)
    s_barrier
    v_mfma_f32_32x32x16_bf16 v[96:111], v[152:155], v[240:243], 0
    s_setprio 3
    s_add_u32 m0, s47, 65536
    v_exp_f32 v80, v80
    v_exp_f32 v81, v81
    v_exp_f32 v82, v82
    v_exp_f32 v83, v83
    v_mfma_f32_32x32x16_bf16 v[96:111], v[156:159], v[244:247], v[96:111]
    s_nop 0
    v_exp_f32 v84, v84
    v_exp_f32 v85, v85
    v_exp_f32 v86, v86
    v_exp_f32 v87, v87
    v_smfmac_f32_32x32x32_bf16 v[208:223], v[180:183], v[72:79], v13
    ds_read_b128 v[128:131], v250 offset:16384
    v_exp_f32 v88, v88
    v_exp_f32 v89, v89
    v_exp_f32 v90, v90
    v_exp_f32 v91, v91
    v_smfmac_f32_32x32x32_bf16 v[32:47], v[176:179], v[80:87], v13
    ds_read_b128 v[132:135], v250 offset:17408
    buffer_load_dwordx4 v226, s[64:67], 0 offen offset:0 sc1 lds
    buffer_load_dwordx4 v226, s[64:67], 0 offen offset:1024 sc1 lds
    v_exp_f32 v92, v92
    v_exp_f32 v93, v93
    v_exp_f32 v94, v94
    v_exp_f32 v95, v95
    v_mfma_f32_32x32x16_bf16 v[112:127], v[152:155], v[16:19], 0
    v_exp_f32 v96, v96
    v_exp_f32 v97, v97
    v_exp_f32 v98, v98
    v_exp_f32 v99, v99
    v_mfma_f32_32x32x16_bf16 v[112:127], v[156:159], v[20:23], v[112:127]
    v_exp_f32 v100, v100
    v_exp_f32 v101, v101
    v_exp_f32 v102, v102
    v_exp_f32 v103, v103
    v_smfmac_f32_32x32x32_bf16 v[32:47], v[180:183], v[88:95], v13
    s_waitcnt lgkmcnt(0)
    ds_read_b128 v[160:163], v10 offset:18432
    v_exp_f32 v104, v104
    v_exp_f32 v105, v105
    v_exp_f32 v106, v106
    v_exp_f32 v107, v107
    v_smfmac_f32_32x32x32_bf16 v[208:223], v[184:187], v[96:103], v13
    s_setprio 2
    ds_read_b128 v[164:167], v10 offset:19456
    buffer_load_dwordx4 v226, s[64:67], 0 offen offset:2048 sc1 lds
    buffer_load_dwordx4 v226, s[64:67], 0 offen offset:3072 sc1 lds
    v_exp_f32 v108, v108
    v_exp_f32 v109, v109
    v_exp_f32 v110, v110
    v_exp_f32 v111, v111
    v_mfma_f32_32x32x16_bf16 v[64:79], v[128:131], v[240:243], 0
    s_add_u32 m0, s39, 147456
    v_exp_f32 v112, v112
    v_exp_f32 v113, v113
    v_exp_f32 v114, v114
    v_exp_f32 v115, v115
    v_mfma_f32_32x32x16_bf16 v[64:79], v[132:135], v[244:247], v[64:79]
    s_mov_b32 s48, 0
    v_exp_f32 v116, v116
    v_exp_f32 v117, v117
    v_exp_f32 v118, v118
    v_exp_f32 v119, v119
    v_smfmac_f32_32x32x32_bf16 v[208:223], v[188:191], v[104:111], v13
    ds_read_b128 v[136:139], v250 offset:20480
    v_exp_f32 v120, v120
    v_exp_f32 v121, v121
    v_exp_f32 v122, v122
    v_exp_f32 v123, v123
    v_smfmac_f32_32x32x32_bf16 v[32:47], v[184:187], v[112:119], v13
    s_setprio 1
    ds_read_b128 v[140:143], v250 offset:21504
    buffer_load_dwordx4 v15, s[24:27], s48 offen lds
    s_add_u32 m0, s39, 148480
    s_mov_b32 s48, 7168
    buffer_load_dwordx4 v15, s[24:27], s48 offen lds
    v_exp_f32 v124, v124
    v_exp_f32 v125, v125
    v_exp_f32 v126, v126
    v_exp_f32 v127, v127
    v_mfma_f32_32x32x16_bf16 v[80:95], v[128:131], v[16:19], 0
    s_add_u32 m0, s62, 149504
    v_exp_f32 v64, v64
    v_exp_f32 v65, v65
    v_exp_f32 v66, v66
    v_exp_f32 v67, v67
    v_mfma_f32_32x32x16_bf16 v[80:95], v[132:135], v[20:23], v[80:95]
    s_add_u32 s48, s49, 14336
    v_exp_f32 v68, v68
    v_exp_f32 v69, v69
    v_exp_f32 v70, v70
    v_exp_f32 v71, v71
    v_smfmac_f32_32x32x32_bf16 v[32:47], v[188:191], v[120:127], v13
    s_waitcnt lgkmcnt(0)
    ds_read_b128 v[168:171], v10 offset:22528
    ds_read_b128 v[172:175], v10 offset:23552
    v_exp_f32 v72, v72
    v_exp_f32 v73, v73
    v_exp_f32 v74, v74
    v_exp_f32 v75, v75
    v_smfmac_f32_32x32x32_bf16 v[208:223], v[160:163], v[64:71], v13
    s_setprio 0
    buffer_load_dwordx4 v15, s[24:27], s48 offen lds
    s_add_u32 m0, s62, 150528
    s_add_u32 s48, s49, 21504
    buffer_load_dwordx4 v15, s[24:27], s48 offen lds
    v_exp_f32 v76, v76
    v_exp_f32 v77, v77
    v_exp_f32 v78, v78
    v_exp_f32 v79, v79
    s_waitcnt vmcnt(8) lgkmcnt(0)
    s_barrier
    v_mfma_f32_32x32x16_bf16 v[96:111], v[136:139], v[240:243], 0
    s_setprio 3
    ds_read_b128 v[144:147], v249 offset:0
    s_add_u32 m0, s39, 81920
    v_exp_f32 v80, v80
    v_exp_f32 v81, v81
    v_exp_f32 v82, v82
    v_exp_f32 v83, v83
    v_mfma_f32_32x32x16_bf16 v[96:111], v[140:143], v[244:247], v[96:111]
    ds_read_b128 v[148:151], v249 offset:1024
    s_mov_b32 s48, 301056
    v_exp_f32 v84, v84
    v_exp_f32 v85, v85
    v_exp_f32 v86, v86
    v_exp_f32 v87, v87
    v_smfmac_f32_32x32x32_bf16 v[208:223], v[164:167], v[72:79], v13
    ds_read_b128 v[176:179], v9 offset:2048
    v_exp_f32 v88, v88
    v_exp_f32 v89, v89
    v_exp_f32 v90, v90
    v_exp_f32 v91, v91
    v_smfmac_f32_32x32x32_bf16 v[32:47], v[160:163], v[80:87], v13
    ds_read_b128 v[180:183], v9 offset:3072
    buffer_load_dwordx4 v15, s[24:27], s48 offen lds
    v_exp_f32 v92, v92
    v_exp_f32 v93, v93
    v_exp_f32 v94, v94
    v_exp_f32 v95, v95
    v_mfma_f32_32x32x16_bf16 v[112:127], v[136:139], v[16:19], 0
    ds_read_b128 v[152:155], v249 offset:4096
    s_add_u32 m0, s39, 82944
    v_exp_f32 v96, v96
    v_exp_f32 v97, v97
    v_exp_f32 v98, v98
    v_exp_f32 v99, v99
    v_mfma_f32_32x32x16_bf16 v[112:127], v[140:143], v[20:23], v[112:127]
    ds_read_b128 v[156:159], v249 offset:5120
    s_mov_b32 s48, 308224
    v_exp_f32 v100, v100
    v_exp_f32 v101, v101
    v_exp_f32 v102, v102
    v_exp_f32 v103, v103
    v_smfmac_f32_32x32x32_bf16 v[32:47], v[164:167], v[88:95], v13
    s_waitcnt lgkmcnt(4)
    ds_read_b128 v[184:187], v9 offset:6144
    v_exp_f32 v104, v104
    v_exp_f32 v105, v105
    v_exp_f32 v106, v106
    v_exp_f32 v107, v107
    v_smfmac_f32_32x32x32_bf16 v[208:223], v[168:171], v[96:103], v13
    s_setprio 3
    ds_read_b128 v[188:191], v9 offset:7168
    buffer_load_dwordx4 v15, s[24:27], s48 offen lds
    v_exp_f32 v108, v108
    v_exp_f32 v109, v109
    v_exp_f32 v110, v110
    v_exp_f32 v111, v111
    s_cmp_lg_u32 s60, 0
    s_cbranch_scc1 fbq_11
    v_mfma_f32_32x32x16_bf16 v[64:79], v[144:147], v[24:27], v[192:207]
    v_mfma_f32_32x32x16_bf16 v[64:79], v[148:151], v[28:31], v[64:79]
    s_nop 11
    v_max3_f32 v2, v64, v65, v66
    v_max3_f32 v3, v67, v68, v69
    v_max3_f32 v2, v2, v70, v71
    v_max3_f32 v3, v3, v72, v73
    v_max3_f32 v2, v2, v74, v75
    v_max3_f32 v3, v3, v76, v77
    v_max3_f32 v2, v2, v78, v79
    v_max_f32 v3, v2, v3
    v_mov_b32 v4, v3
    s_nop 1
    v_permlane32_swap_b32 v3, v4
    s_nop 1
    v_max_f32 v2, v3, v4
    s_mov_b32 exec_lo, 0
    v_cvt_pk_bf16_f32 v30, -v2, 0
    s_mov_b32 exec_lo, -1
    s_branch fbq_e_12
fbq_11:
    s_mov_b32 exec_lo, 0
    v_mov_b64 v[30:31], v[230:231]
    s_mov_b32 exec_lo, -1
fbq_e_12:
    s_nop 1
    v_mfma_f32_32x32x16_bf16 v[64:79], v[144:147], v[24:27], v[192:207]
    ds_read_b128 v[128:131], v249 offset:8192
    s_add_u32 m0, s62, 83968
    v_exp_f32 v112, v112
    v_exp_f32 v113, v113
    v_exp_f32 v114, v114
    v_exp_f32 v115, v115
    v_mfma_f32_32x32x16_bf16 v[64:79], v[148:151], v[28:31], v[64:79]
    ds_read_b128 v[132:135], v249 offset:9216
    s_add_u32 s48, s49, 315392
    v_exp_f32 v116, v116
    v_exp_f32 v117, v117
    v_exp_f32 v118, v118
    v_exp_f32 v119, v119
    v_smfmac_f32_32x32x32_bf16 v[208:223], v[172:175], v[104:111], v13
    s_waitcnt lgkmcnt(4)
    ds_read_b128 v[160:163], v9 offset:10240
    v_exp_f32 v120, v120
    v_exp_f32 v121, v121
    v_exp_f32 v122, v122
    v_exp_f32 v123, v123
    v_smfmac_f32_32x32x32_bf16 v[32:47], v[168:171], v[112:119], v13
    s_setprio 2
    ds_read_b128 v[164:167], v9 offset:11264
    buffer_load_dwordx4 v15, s[24:27], s48 offen lds
    v_exp_f32 v124, v124
    v_exp_f32 v125, v125
    v_exp_f32 v126, v126
    v_exp_f32 v127, v127
    v_xor_b32 v7, 4096, v12
    v_add_u32 v7, 65536, v7
    v_mfma_f32_32x32x16_bf16 v[80:95], v[152:155], v[24:27], 0
    ds_read_b128 v[136:139], v249 offset:12288
    ds_write_b128 v7, v[208:211] offset:0
    ds_write_b128 v7, v[212:215] offset:1024
    s_add_u32 m0, s62, 84992
    v_exp_f32 v64, v64
    v_exp_f32 v65, v65
    v_exp_f32 v66, v66
    v_exp_f32 v67, v67
    v_mfma_f32_32x32x16_bf16 v[80:95], v[156:159], v[28:31], v[80:95]
    ds_read_b128 v[140:143], v249 offset:13312
    ds_write_b128 v7, v[216:219] offset:2048
    s_add_u32 s48, s49, 322560
    v_exp_f32 v68, v68
    v_exp_f32 v69, v69
    v_exp_f32 v70, v70
    v_exp_f32 v71, v71
    v_smfmac_f32_32x32x32_bf16 v[32:47], v[172:175], v[120:127], v13
    s_waitcnt lgkmcnt(7)
    ds_read_b128 v[168:171], v9 offset:14336
    ds_read_b128 v[172:175], v9 offset:15360
    ds_write_b128 v7, v[220:223] offset:3072
    v_exp_f32 v72, v72
    v_exp_f32 v73, v73
    v_exp_f32 v74, v74
    v_exp_f32 v75, v75
    v_smfmac_f32_32x32x32_bf16 v[48:63], v[176:179], v[64:71], v13
    s_setprio 1
    buffer_load_dwordx4 v15, s[24:27], s48 offen lds
    v_exp_f32 v76, v76
    v_exp_f32 v77, v77
    v_exp_f32 v78, v78
    v_exp_f32 v79, v79
    s_waitcnt vmcnt(8) lgkmcnt(0)
    s_barrier
    v_add_u32 v7, 65536, v12
    ds_read_b128 v[208:211], v7 offset:0
    ds_read_b128 v[212:215], v7 offset:1024
    ds_read_b128 v[216:219], v7 offset:2048
    ds_read_b128 v[220:223], v7 offset:3072
    v_mfma_f32_32x32x16_bf16 v[96:111], v[128:131], v[24:27], 0
    s_setprio 0
    ds_read_b128 v[144:147], v249 offset:16384
    v_exp_f32 v80, v80
    v_exp_f32 v81, v81
    v_exp_f32 v82, v82
    v_exp_f32 v83, v83
    v_mfma_f32_32x32x16_bf16 v[96:111], v[132:135], v[28:31], v[96:111]
    ds_read_b128 v[148:151], v249 offset:17408
    v_exp_f32 v84, v84
    v_exp_f32 v85, v85
    v_exp_f32 v86, v86
    v_exp_f32 v87, v87
    v_smfmac_f32_32x32x32_bf16 v[48:63], v[180:183], v[72:79], v13
    s_waitcnt lgkmcnt(6)
    ds_read_b128 v[176:179], v9 offset:18432
    v_exp_f32 v88, v88
    v_exp_f32 v89, v89
    v_exp_f32 v90, v90
    v_exp_f32 v91, v91
    v_smfmac_f32_32x32x32_bf16 v[48:63], v[184:187], v[80:87], v13
    ds_read_b128 v[180:183], v9 offset:19456
    v_exp_f32 v92, v92
    v_exp_f32 v93, v93
    v_exp_f32 v94, v94
    v_exp_f32 v95, v95
    s_waitcnt lgkmcnt(4)
    v_add_f32 v32, v32, v208
    v_add_f32 v33, v33, v209
    v_add_f32 v34, v34, v210
    v_add_f32 v35, v35, v211
    v_add_f32 v36, v36, v212
    v_add_f32 v37, v37, v213
    v_add_f32 v38, v38, v214
    v_add_f32 v39, v39, v215
    v_add_f32 v40, v40, v216
    v_add_f32 v41, v41, v217
    v_add_f32 v42, v42, v218
    v_add_f32 v43, v43, v219
    v_add_f32 v44, v44, v220
    v_add_f32 v45, v45, v221
    v_add_f32 v46, v46, v222
    v_add_f32 v47, v47, v223
    v_add_u32 v7, 65536, v12
    s_nop 1
    ds_write_b128 v7, v[32:35] offset:0
    ds_write_b128 v7, v[36:39] offset:1024
    ds_write_b128 v7, v[40:43] offset:2048
    ds_write_b128 v7, v[44:47] offset:3072
    s_lshl_b32 s46, s35, 2
    s_add_u32 s46, s46, 162352
    v_mov_b32 v2, s46
    v_mov_b32 v7, 1
    ds_write_b32 v2, v7
    v_mul_f32 v234, 3216550459, v14
    v_exp_f32 v234, v234
    v_mov_b32 v246, 0
    v_mov_b32 v247, 0
    v_add_f32 v234, 1.0, v234
    v_mfma_f32_32x32x16_bf16 v[112:127], v[136:139], v[24:27], 0
    ds_read_b128 v[152:155], v249 offset:20480
    v_exp_f32 v96, v96
    v_exp_f32 v97, v97
    v_exp_f32 v98, v98
    v_exp_f32 v99, v99
    v_mfma_f32_32x32x16_bf16 v[112:127], v[140:143], v[28:31], v[112:127]
    ds_read_b128 v[156:159], v249 offset:21504
    v_exp_f32 v100, v100
    v_exp_f32 v101, v101
    v_exp_f32 v102, v102
    v_exp_f32 v103, v103
    v_smfmac_f32_32x32x32_bf16 v[48:63], v[188:191], v[88:95], v13
    s_waitcnt lgkmcnt(4)
    ds_read_b128 v[184:187], v9 offset:22528
    v_exp_f32 v104, v104
    v_exp_f32 v105, v105
    v_exp_f32 v106, v106
    v_exp_f32 v107, v107
    v_smfmac_f32_32x32x32_bf16 v[48:63], v[160:163], v[96:103], v13
    ds_read_b128 v[188:191], v9 offset:23552
    v_exp_f32 v108, v108
    v_exp_f32 v109, v109
    v_exp_f32 v110, v110
    v_exp_f32 v111, v111
    v_xor_b32 v192, 4278190080, v192
    v_xor_b32 v193, 4278190080, v193
    v_xor_b32 v194, 4278190080, v194
    v_xor_b32 v195, 4278190080, v195
    v_xor_b32 v196, 4278190080, v196
    v_xor_b32 v197, 4278190080, v197
    v_xor_b32 v198, 4278190080, v198
    v_xor_b32 v199, 4278190080, v199
    v_xor_b32 v200, 4278190080, v200
    v_xor_b32 v201, 4278190080, v201
    v_xor_b32 v202, 4278190080, v202
    v_xor_b32 v203, 4278190080, v203
    v_xor_b32 v204, 4278190080, v204
    v_xor_b32 v205, 4278190080, v205
    v_xor_b32 v206, 4278190080, v206
    v_xor_b32 v207, 4278190080, v207
    s_waitcnt vmcnt(0)
    s_barrier
    v_mfma_f32_32x32x16_bf16 v[64:79], v[144:147], v[24:27], 0
    ds_read_b128 v[128:131], v249 offset:24576
    v_exp_f32 v112, v112
    v_exp_f32 v113, v113
    v_exp_f32 v114, v114
    v_exp_f32 v115, v115
    v_mfma_f32_32x32x16_bf16 v[64:79], v[148:151], v[28:31], v[64:79]
    ds_read_b128 v[132:135], v249 offset:25600
    v_exp_f32 v116, v116
    v_exp_f32 v117, v117
    v_exp_f32 v118, v118
    v_exp_f32 v119, v119
    v_smfmac_f32_32x32x32_bf16 v[48:63], v[164:167], v[104:111], v13
    s_waitcnt lgkmcnt(4)
    ds_read_b128 v[160:163], v9 offset:26624
    v_exp_f32 v120, v120
    v_exp_f32 v121, v121
    v_exp_f32 v122, v122
    v_exp_f32 v123, v123
    v_smfmac_f32_32x32x32_bf16 v[48:63], v[168:171], v[112:119], v13
    ds_read_b128 v[164:167], v9 offset:27648
    v_exp_f32 v124, v124
    v_exp_f32 v125, v125
    v_exp_f32 v126, v126
    v_exp_f32 v127, v127
    v_mfma_f32_32x32x16_bf16 v[80:95], v[152:155], v[24:27], 0
    ds_read_b128 v[136:139], v249 offset:28672
    v_exp_f32 v64, v64
    v_exp_f32 v65, v65
    v_exp_f32 v66, v66
    v_exp_f32 v67, v67
    v_mfma_f32_32x32x16_bf16 v[80:95], v[156:159], v[28:31], v[80:95]
    ds_read_b128 v[140:143], v249 offset:29696
    v_exp_f32 v68, v68
    v_exp_f32 v69, v69
    v_exp_f32 v70, v70
    v_exp_f32 v71, v71
    v_smfmac_f32_32x32x32_bf16 v[48:63], v[172:175], v[120:127], v13
    s_waitcnt lgkmcnt(4)
    ds_read_b128 v[168:171], v9 offset:30720
    v_exp_f32 v72, v72
    v_exp_f32 v73, v73
    v_exp_f32 v74, v74
    v_exp_f32 v75, v75
    v_smfmac_f32_32x32x32_bf16 v[48:63], v[176:179], v[64:71], v13
    ds_read_b128 v[172:175], v9 offset:31744
    v_exp_f32 v76, v76
    v_exp_f32 v77, v77
    v_exp_f32 v78, v78
    v_exp_f32 v79, v79
    s_setprio 2
    v_mfma_f32_32x32x16_bf16 v[96:111], v[128:131], v[24:27], 0
    ds_read_b128 v[144:147], v249 offset:32768
    v_exp_f32 v80, v80
    v_exp_f32 v81, v81
    v_exp_f32 v82, v82
    v_exp_f32 v83, v83
    v_mfma_f32_32x32x16_bf16 v[96:111], v[132:135], v[28:31], v[96:111]
    ds_read_b128 v[148:151], v249 offset:33792
    v_exp_f32 v84, v84
    v_exp_f32 v85, v85
    v_exp_f32 v86, v86
    v_exp_f32 v87, v87
    v_smfmac_f32_32x32x32_bf16 v[48:63], v[180:183], v[72:79], v13
    s_waitcnt lgkmcnt(4)
    ds_read_b128 v[176:179], v9 offset:34816
    v_exp_f32 v88, v88
    v_exp_f32 v89, v89
    v_exp_f32 v90, v90
    v_exp_f32 v91, v91
    v_smfmac_f32_32x32x32_bf16 v[48:63], v[184:187], v[80:87], v13
    ds_read_b128 v[180:183], v9 offset:35840
    v_exp_f32 v92, v92
    v_exp_f32 v93, v93
    v_exp_f32 v94, v94
    v_exp_f32 v95, v95
    v_mfma_f32_32x32x16_bf16 v[112:127], v[136:139], v[24:27], 0
    v_exp_f32 v96, v96
    v_exp_f32 v97, v97
    v_exp_f32 v98, v98
    v_exp_f32 v99, v99
    v_mfma_f32_32x32x16_bf16 v[112:127], v[140:143], v[28:31], v[112:127]
    v_exp_f32 v100, v100
    v_exp_f32 v101, v101
    v_exp_f32 v102, v102
    v_exp_f32 v103, v103
    v_smfmac_f32_32x32x32_bf16 v[48:63], v[188:191], v[88:95], v13
    s_waitcnt lgkmcnt(2)
    v_exp_f32 v104, v104
    v_exp_f32 v105, v105
    v_exp_f32 v106, v106
    v_exp_f32 v107, v107
    v_smfmac_f32_32x32x32_bf16 v[48:63], v[160:163], v[96:103], v13
    v_exp_f32 v108, v108
    v_exp_f32 v109, v109
    v_exp_f32 v110, v110
    v_exp_f32 v111, v111
    v_lshrrev_b32 v3, 5, v1
    v_bfe_u32 v4, v1, 2, 2
    v_bfe_u32 v5, v1, 4, 1
    v_and_b32 v6, 3, v1
    v_lshlrev_b32 v6, 3, v6
    v_lshl_add_u32 v6, v5, 5, v6
    v_lshl_add_u32 v6, v4, 7, v6
    v_lshrrev_b32 v4, 1, v4
    v_lshl_add_u32 v6, v4, 6, v6
    s_bitcmp1_b32 s5, 0
    s_mov_b32 s12, 98304
    s_cselect_b32 s12, 0, s12
    s_mov_b32 s13, 4294918144
    s_cselect_b32 s13, 65536, s13
    v_add_u32 v11, s12, v6
    v_xor_b32 v12, 64, v11
    v_lshl_add_u32 v9, v3, 9, v11
    v_xor_b32 v10, 64, v9
    v_mfma_f32_32x32x16_bf16 v[64:79], v[144:147], v[24:27], v[192:207]
    v_exp_f32 v112, v112
    v_exp_f32 v113, v113
    v_exp_f32 v114, v114
    v_exp_f32 v115, v115
    v_mfma_f32_32x32x16_bf16 v[64:79], v[148:151], v[28:31], v[64:79]
    v_exp_f32 v116, v116
    v_exp_f32 v117, v117
    v_exp_f32 v118, v118
    v_exp_f32 v119, v119
    v_smfmac_f32_32x32x32_bf16 v[48:63], v[164:167], v[104:111], v13
    s_waitcnt lgkmcnt(0)
    v_exp_f32 v120, v120
    v_exp_f32 v121, v121
    v_exp_f32 v122, v122
    v_exp_f32 v123, v123
    v_smfmac_f32_32x32x32_bf16 v[48:63], v[168:171], v[112:119], v13
    v_exp_f32 v124, v124
    v_exp_f32 v125, v125
    v_exp_f32 v126, v126
    v_exp_f32 v127, v127
    s_lshl_b32 s46, s35, 2
    s_add_u32 s46, s46, 162336
    v_mov_b32 v2, s46
    v_mov_b32 v7, 1
    ds_write_b32 v2, v7
    v_exp_f32 v64, v64
    v_exp_f32 v65, v65
    v_exp_f32 v66, v66
    v_exp_f32 v67, v67
    v_exp_f32 v68, v68
    v_exp_f32 v69, v69
    v_exp_f32 v70, v70
    v_exp_f32 v71, v71
    v_smfmac_f32_32x32x32_bf16 v[48:63], v[172:175], v[120:127], v13
    v_exp_f32 v72, v72
    v_exp_f32 v73, v73
    v_exp_f32 v74, v74
    v_exp_f32 v75, v75
    v_smfmac_f32_32x32x32_bf16 v[48:63], v[176:179], v[64:71], v13
    v_exp_f32 v76, v76
    v_exp_f32 v77, v77
    v_exp_f32 v78, v78
    v_exp_f32 v79, v79
    s_nop 1
    v_smfmac_f32_32x32x32_bf16 v[48:63], v[180:183], v[72:79], v13
    s_nop 11
    v_mul_f32 v2, v60, v234
    v_cmp_nle_f32 s[52:53], v60, s56
    v_rcp_f32 v2, v2
    v_cmp_nge_f32 s[54:55], v60, s57
    v_mov_b32 v4, v2
    s_or_b32 s58, s53, s55
    s_cmp_lg_u32 s60, 0
    v_permlane32_swap_b32 v2, v4
    s_cselect_b32 s58, 0, s58
    s_or_b32 s46, s58, s63
    v_mul_f32 v48, v48, v4
    v_mul_f32 v49, v49, v4
    v_mul_f32 v50, v50, v4
    v_mul_f32 v51, v51, v4
    v_mul_f32 v52, v52, v4
    v_mul_f32 v53, v53, v4
    v_mul_f32 v54, v54, v4
    v_mul_f32 v55, v55, v4
    s_cselect_b32 s50, 0x40000000, s43
    s_cselect_b32 s51, 0x40000000, s45
    s_cselect_b32 s63, s63, 1
    v_cvt_pk_bf16_f32 v240, v48, v49
    v_cvt_pk_bf16_f32 v241, v50, v51
    v_cvt_pk_bf16_f32 v242, v52, v53
    v_cvt_pk_bf16_f32 v243, v54, v55
    buffer_store_dwordx4 v[240:243], v8, s[28:31], s50 offen offset:0 sc1
    v_mul_f32 v56, v56, v4
    v_mul_f32 v57, v57, v4
    v_mul_f32 v58, v58, v4
    v_mul_f32 v59, v59, v4
    v_mul_f32 v60, v60, v4
    v_mul_f32 v61, v61, v4
    v_mul_f32 v62, v62, v4
    v_mul_f32 v63, v63, v4
    v_cvt_pk_bf16_f32 v244, v56, v57
    v_cvt_pk_bf16_f32 v245, v58, v59
    s_mov_b32 exec_hi, 0
    v_cvt_pk_bf16_f32 v246, v60, v61
    v_cvt_pk_bf16_f32 v247, v62, v63
    s_mov_b32 exec_hi, -1
    buffer_store_dwordx4 v[244:247], v8, s[28:31], s50 offen offset:1024 sc1
    s_cmp_eq_u32 s58, 0
    s_cbranch_scc1 noflag_13
    v_mov_b32 v2, 162304
    ds_write_b32 v2, v227
noflag_13:
    v_mov_b32 v2, 162320
w2ok_14:
    ds_read_b128 v[32:35], v2
    s_waitcnt lgkmcnt(0)
    v_and_b32 v32, v32, v33
    v_and_b32 v34, v34, v35
    v_and_b32 v32, v32, v34
    v_cmp_eq_u32 vcc, 0, v32
    s_cbranch_vccnz w2ok_14
    v_lshrrev_b32 v190, 5, v1
    v_mul_u32_u24 v184, 9728, v190
    v_add_u32 v184, v184, v11
    v_xor_b32 v185, 64, v184
    v_mul_u32_u24 v186, 7168, v190
    v_add_u32 v186, v186, v11
    v_xor_b32 v187, 64, v186
    v_mul_u32_u24 v188, 3072, v190
    v_add_u32 v188, v188, v11
    v_xor_b32 v189, 64, v188
    s_waitcnt lgkmcnt(11)
    ds_read_b64_tr_b16 v[128:129], v9 offset:0
    ds_read_b64_tr_b16 v[130:131], v9 offset:1024
    ds_read_b64_tr_b16 v[132:133], v10 offset:0
    ds_read_b64_tr_b16 v[134:135], v10 offset:1024
    s_waitcnt lgkmcnt(11)
    ds_read_b64_tr_b16 v[136:137], v9 offset:3584
    ds_read_b64_tr_b16 v[138:139], v9 offset:4608
    ds_read_b64_tr_b16 v[140:141], v10 offset:3584
    ds_read_b64_tr_b16 v[142:143], v10 offset:4608
    s_waitcnt lgkmcnt(11)
    ds_read_b64_tr_b16 v[144:145], v9 offset:7168
    ds_read_b64_tr_b16 v[146:147], v9 offset:8192
    ds_read_b64_tr_b16 v[148:149], v10 offset:7168
    ds_read_b64_tr_b16 v[150:151], v10 offset:8192
    s_waitcnt lgkmcnt(11)
    ds_read_b64_tr_b16 v[152:153], v9 offset:10752
    ds_read_b64_tr_b16 v[154:155], v9 offset:11776
    ds_read_b64_tr_b16 v[156:157], v10 offset:10752
    ds_read_b64_tr_b16 v[158:159], v10 offset:11776
    s_waitcnt lgkmcnt(11)
    ds_read_b64_tr_b16 v[160:161], v9 offset:2048
    ds_read_b64_tr_b16 v[162:163], v184 offset:3072
    ds_read_b64_tr_b16 v[164:165], v10 offset:2048
    ds_read_b64_tr_b16 v[166:167], v185 offset:3072
    s_waitcnt lgkmcnt(11)
    ds_read_b64_tr_b16 v[168:169], v9 offset:5632
    ds_read_b64_tr_b16 v[170:171], v186 offset:6656
    ds_read_b64_tr_b16 v[172:173], v10 offset:5632
    ds_read_b64_tr_b16 v[174:175], v187 offset:6656
    s_waitcnt lgkmcnt(11)
    ds_read_b64_tr_b16 v[176:177], v9 offset:9216
    ds_read_b64_tr_b16 v[178:179], v188 offset:10240
    ds_read_b64_tr_b16 v[180:181], v10 offset:9216
    ds_read_b64_tr_b16 v[182:183], v189 offset:10240
    s_add_u32 s52, s6, 0
    s_add_u32 s53, s6, 4096
    s_add_u32 s54, s6, 8192
    s_add_u32 s55, s6, 12288
    s_add_u32 s10, s22, s7
    s_addc_u32 s11, s23, 0
    s_lshl_b32 s46, s4, 12
    s_lshl_b32 s47, s5, 10
    s_add_u32 s47, s47, s46
    s_add_u32 s47, s47, 114560
    v_add_u32 v3, s47, v8
    v_lshrrev_b32 v5, 3, v1
    s_lshl_b32 s47, s5, 3
    v_add_u32 v5, s47, v5
    v_bfe_u32 v6, v1, 1, 2
    v_mul_u32_u24 v4, 8224, v6
    v_lshl_add_u32 v4, v5, 4, v4
    v_and_b32 v6, 1, v1
    v_lshl_add_u32 v4, v6, 3, v4
    s_add_u32 s47, s46, 114560
    v_add_u32 v4, s47, v4
    s_lshl1_add_u32 s46, s36, s4
    s_lshl_b32 s46, s46, 5
    v_add_u32 v5, s46, v5
    v_mul_u32_u24 v5, 896, v5
    v_and_b32 v6, 7, v1
    v_lshl_add_u32 v5, v6, 4, v5
    s_lshl_b32 s50, s37, 7
    v_mov_b32 v13, 162304
    v_lshlrev_b32 v2, 3, v1
    v_mov_b32 v6, s100
    v_mov_b32 v7, s101
    s_waitcnt lgkmcnt(7)
    s_load_dwordx2 s[64:65], s[10:11], 0 glc
    s_load_dwordx2 s[66:67], s[10:11], 128 glc
    s_load_dwordx2 s[68:69], s[10:11], 256 glc
    s_load_dwordx2 s[70:71], s[10:11], 384 glc
    s_waitcnt vmcnt(0)
    s_mov_b64 exec, 0xffff
    buffer_store_dwordx2 v[6:7], v2, s[28:31], s51 offen sc1
    s_mov_b64 exec, -1
    s_setprio 0
L_p3:
    s_cmp_ge_u32 s38, 28
    s_cbranch_scc1 L_p3_x
    s_waitcnt lgkmcnt(0)
    s_load_dwordx2 s[24:25], s[10:11], 512 glc
    s_load_dwordx2 s[26:27], s[10:11], 640 glc
    s_load_dwordx2 s[96:97], s[10:11], 768 glc
    s_load_dwordx2 s[98:99], s[10:11], 896 glc
    s_cmp_eq_u64 s[64:65], s[100:101]
    s_cbranch_scc0 L_p3_notyet
    s_cmp_eq_u64 s[66:67], s[100:101]
    s_cbranch_scc0 L_p3_notyet
    s_cmp_eq_u64 s[68:69], s[100:101]
    s_cbranch_scc0 L_p3_notyet
    s_cmp_eq_u64 s[70:71], s[100:101]
    s_cbranch_scc0 L_p3_notyet
    buffer_load_dwordx4 v[64:67], v8, s[28:31], s52 offen offset:0 sc1
    buffer_load_dwordx4 v[72:75], v8, s[28:31], s52 offen offset:2048 sc1
    buffer_load_dwordx4 v[80:83], v8, s[28:31], s53 offen offset:0 sc1
    buffer_load_dwordx4 v[88:91], v8, s[28:31], s53 offen offset:2048 sc1
    buffer_load_dwordx4 v[92:95], v8, s[28:31], s53 offen offset:3072 sc1
    buffer_load_dwordx4 v[68:71], v8, s[28:31], s52 offen offset:1024 sc1
    buffer_load_dwordx4 v[76:79], v8, s[28:31], s52 offen offset:3072 sc1
    buffer_load_dwordx4 v[84:87], v8, s[28:31], s53 offen offset:1024 sc1
    v_add_u32 v9, s13, v9
    v_add_u32 v10, s13, v10
    v_add_u32 v11, s13, v11
    v_add_u32 v12, s13, v12
    v_lshrrev_b32 v254, 5, v1
    v_mul_u32_u24 v248, 9728, v254
    v_add_u32 v248, v248, v11
    v_xor_b32 v249, 64, v248
    v_mul_u32_u24 v250, 7168, v254
    v_add_u32 v250, v250, v11
    v_xor_b32 v251, 64, v250
    v_mul_u32_u24 v252, 3072, v254
    v_add_u32 v252, v252, v11
    v_xor_b32 v253, 64, v252
    s_waitcnt lgkmcnt(11)
    ds_read_b64_tr_b16 v[192:193], v9 offset:0
    ds_read_b64_tr_b16 v[194:195], v9 offset:1024
    ds_read_b64_tr_b16 v[196:197], v10 offset:0
    ds_read_b64_tr_b16 v[198:199], v10 offset:1024
    s_waitcnt lgkmcnt(11)
    ds_read_b64_tr_b16 v[200:201], v9 offset:3584
    ds_read_b64_tr_b16 v[202:203], v9 offset:4608
    ds_read_b64_tr_b16 v[204:205], v10 offset:3584
    ds_read_b64_tr_b16 v[206:207], v10 offset:4608
    s_waitcnt lgkmcnt(11)
    ds_read_b64_tr_b16 v[208:209], v9 offset:7168
    ds_read_b64_tr_b16 v[210:211], v9 offset:8192
    ds_read_b64_tr_b16 v[212:213], v10 offset:7168
    ds_read_b64_tr_b16 v[214:215], v10 offset:8192
    s_waitcnt lgkmcnt(11)
    ds_read_b64_tr_b16 v[216:217], v9 offset:10752
    ds_read_b64_tr_b16 v[218:219], v9 offset:11776
    ds_read_b64_tr_b16 v[220:221], v10 offset:10752
    ds_read_b64_tr_b16 v[222:223], v10 offset:11776
    s_waitcnt lgkmcnt(11)
    ds_read_b64_tr_b16 v[224:225], v9 offset:2048
    ds_read_b64_tr_b16 v[226:227], v248 offset:3072
    ds_read_b64_tr_b16 v[228:229], v10 offset:2048
    ds_read_b64_tr_b16 v[230:231], v249 offset:3072
    s_waitcnt lgkmcnt(11)
    ds_read_b64_tr_b16 v[232:233], v9 offset:5632
    ds_read_b64_tr_b16 v[234:235], v250 offset:6656
    ds_read_b64_tr_b16 v[236:237], v10 offset:5632
    ds_read_b64_tr_b16 v[238:239], v251 offset:6656
    s_waitcnt lgkmcnt(11)
    ds_read_b64_tr_b16 v[240:241], v9 offset:9216
    ds_read_b64_tr_b16 v[242:243], v252 offset:10240
    ds_read_b64_tr_b16 v[244:245], v10 offset:9216
    ds_read_b64_tr_b16 v[246:247], v253 offset:10240
    s_branch L_p3_hi
L_p3_notyet:
    v_add_u32 v9, s13, v9
    v_add_u32 v10, s13, v10
    v_add_u32 v11, s13, v11
    v_add_u32 v12, s13, v12
    v_lshrrev_b32 v254, 5, v1
    v_mul_u32_u24 v248, 9728, v254
    v_add_u32 v248, v248, v11
    v_xor_b32 v249, 64, v248
    v_mul_u32_u24 v250, 7168, v254
    v_add_u32 v250, v250, v11
    v_xor_b32 v251, 64, v250
    v_mul_u32_u24 v252, 3072, v254
    v_add_u32 v252, v252, v11
    v_xor_b32 v253, 64, v252
    s_waitcnt lgkmcnt(11)
    ds_read_b64_tr_b16 v[192:193], v9 offset:0
    ds_read_b64_tr_b16 v[194:195], v9 offset:1024
    ds_read_b64_tr_b16 v[196:197], v10 offset:0
    ds_read_b64_tr_b16 v[198:199], v10 offset:1024
    s_waitcnt lgkmcnt(11)
    ds_read_b64_tr_b16 v[200:201], v9 offset:3584
    ds_read_b64_tr_b16 v[202:203], v9 offset:4608
    ds_read_b64_tr_b16 v[204:205], v10 offset:3584
    ds_read_b64_tr_b16 v[206:207], v10 offset:4608
    s_waitcnt lgkmcnt(11)
    ds_read_b64_tr_b16 v[208:209], v9 offset:7168
    ds_read_b64_tr_b16 v[210:211], v9 offset:8192
    ds_read_b64_tr_b16 v[212:213], v10 offset:7168
    ds_read_b64_tr_b16 v[214:215], v10 offset:8192
    s_waitcnt lgkmcnt(11)
    ds_read_b64_tr_b16 v[216:217], v9 offset:10752
    ds_read_b64_tr_b16 v[218:219], v9 offset:11776
    ds_read_b64_tr_b16 v[220:221], v10 offset:10752
    ds_read_b64_tr_b16 v[222:223], v10 offset:11776
    s_waitcnt lgkmcnt(11)
    ds_read_b64_tr_b16 v[224:225], v9 offset:2048
    ds_read_b64_tr_b16 v[226:227], v248 offset:3072
    ds_read_b64_tr_b16 v[228:229], v10 offset:2048
    ds_read_b64_tr_b16 v[230:231], v249 offset:3072
    s_waitcnt lgkmcnt(11)
    ds_read_b64_tr_b16 v[232:233], v9 offset:5632
    ds_read_b64_tr_b16 v[234:235], v250 offset:6656
    ds_read_b64_tr_b16 v[236:237], v10 offset:5632
    ds_read_b64_tr_b16 v[238:239], v251 offset:6656
    s_waitcnt lgkmcnt(11)
    ds_read_b64_tr_b16 v[240:241], v9 offset:9216
    ds_read_b64_tr_b16 v[242:243], v252 offset:10240
    ds_read_b64_tr_b16 v[244:245], v10 offset:9216
    ds_read_b64_tr_b16 v[246:247], v253 offset:10240
    s_mov_b32 s61, 65536
    s_waitcnt lgkmcnt(0)
f2b_lp_16:
    s_mov_b32 s58, 0
    s_cmp_eq_u64 s[64:65], s[100:101]
    s_cbranch_scc1 f2b_k_17
f2b_d_18:
    s_load_dwordx2 s[64:65], s[10:11], 0 glc
    s_mov_b32 s58, 1
f2b_k_17:
    s_cmp_eq_u64 s[66:67], s[100:101]
    s_cbranch_scc1 f2b_k_19
f2b_d_20:
    s_load_dwordx2 s[66:67], s[10:11], 128 glc
    s_mov_b32 s58, 1
f2b_k_19:
    s_cmp_eq_u64 s[68:69], s[100:101]
    s_cbranch_scc1 f2b_k_21
f2b_d_22:
    s_load_dwordx2 s[68:69], s[10:11], 256 glc
    s_mov_b32 s58, 1
f2b_k_21:
    s_cmp_eq_u64 s[70:71], s[100:101]
    s_cbranch_scc1 f2b_k_23
f2b_d_24:
    s_load_dwordx2 s[70:71], s[10:11], 384 glc
    s_mov_b32 s58, 1
f2b_k_23:
    s_cmp_eq_u64 s[24:25], s[100:101]
    s_cbranch_scc1 f2b_k_25
f2b_d_26:
    s_load_dwordx2 s[24:25], s[10:11], 512 glc
f2b_k_25:
    s_cmp_eq_u64 s[26:27], s[100:101]
    s_cbranch_scc1 f2b_k_27
f2b_d_28:
    s_load_dwordx2 s[26:27], s[10:11], 640 glc
f2b_k_27:
    s_cmp_eq_u64 s[96:97], s[100:101]
    s_cbranch_scc1 f2b_k_29
f2b_d_30:
    s_load_dwordx2 s[96:97], s[10:11], 768 glc
f2b_k_29:
    s_cmp_eq_u64 s[98:99], s[100:101]
    s_cbranch_scc1 f2b_k_31
f2b_d_32:
    s_load_dwordx2 s[98:99], s[10:11], 896 glc
f2b_k_31:
    s_cmp_eq_u32 s58, 0
    s_cbranch_scc1 f2b_ok_15
    ds_read_b32 v6, v13
    s_sleep 3
    s_waitcnt lgkmcnt(0)
    v_cmp_ne_u32 vcc, 0, v6
    s_cbranch_vccnz L_p3_x
    s_sub_u32 s61, s61, 1
    s_cbranch_scc0 f2b_lp_16
f2b_ok_15:
    buffer_load_dwordx4 v[64:67], v8, s[28:31], s52 offen offset:0 sc1
    buffer_load_dwordx4 v[72:75], v8, s[28:31], s52 offen offset:2048 sc1
    buffer_load_dwordx4 v[80:83], v8, s[28:31], s53 offen offset:0 sc1
    buffer_load_dwordx4 v[88:91], v8, s[28:31], s53 offen offset:2048 sc1
    buffer_load_dwordx4 v[92:95], v8, s[28:31], s53 offen offset:3072 sc1
    buffer_load_dwordx4 v[68:71], v8, s[28:31], s52 offen offset:1024 sc1
    buffer_load_dwordx4 v[76:79], v8, s[28:31], s52 offen offset:3072 sc1
    buffer_load_dwordx4 v[84:87], v8, s[28:31], s53 offen offset:1024 sc1
L_p3_hi:
    s_mov_b32 s61, 65536
    s_waitcnt lgkmcnt(0)
f2a_lp_34:
    s_mov_b32 s58, 0
    s_cmp_eq_u64 s[24:25], s[100:101]
    s_cbranch_scc1 f2a_k_35
f2a_d_36:
    s_load_dwordx2 s[24:25], s[10:11], 512 glc
    s_mov_b32 s58, 1
f2a_k_35:
    s_cmp_eq_u64 s[26:27], s[100:101]
    s_cbranch_scc1 f2a_k_37
f2a_d_38:
    s_load_dwordx2 s[26:27], s[10:11], 640 glc
    s_mov_b32 s58, 1
f2a_k_37:
    s_cmp_eq_u64 s[96:97], s[100:101]
    s_cbranch_scc1 f2a_k_39
f2a_d_40:
    s_load_dwordx2 s[96:97], s[10:11], 768 glc
    s_mov_b32 s58, 1
f2a_k_39:
    s_cmp_eq_u64 s[98:99], s[100:101]
    s_cbranch_scc1 f2a_k_41
f2a_d_42:
    s_load_dwordx2 s[98:99], s[10:11], 896 glc
    s_mov_b32 s58, 1
f2a_k_41:
    s_cmp_eq_u32 s58, 0
    s_cbranch_scc1 f2a_ok_33
    ds_read_b32 v6, v13
    s_sleep 3
    s_waitcnt lgkmcnt(0)
    v_cmp_ne_u32 vcc, 0, v6
    s_cbranch_vccnz L_p3_x
    s_sub_u32 s61, s61, 1
    s_cbranch_scc0 f2a_lp_34
f2a_ok_33:
L_p3_l1:
    buffer_load_dwordx4 v[96:99], v8, s[28:31], s54 offen offset:0 sc1
    buffer_load_dwordx4 v[104:107], v8, s[28:31], s54 offen offset:2048 sc1
    buffer_load_dwordx4 v[112:115], v8, s[28:31], s55 offen offset:0 sc1
    buffer_load_dwordx4 v[120:123], v8, s[28:31], s55 offen offset:2048 sc1
    buffer_load_dwordx4 v[124:127], v8, s[28:31], s55 offen offset:3072 sc1
    buffer_load_dwordx4 v[100:103], v8, s[28:31], s54 offen offset:1024 sc1
    buffer_load_dwordx4 v[108:111], v8, s[28:31], s54 offen offset:3072 sc1
    buffer_load_dwordx4 v[116:119], v8, s[28:31], s55 offen offset:1024 sc1
    s_cmp_lt_u32 s34, 4
    s_cbranch_scc1 L_p3_m
    v_mov_b32 v2, 162336
rdok_43:
    ds_read_b128 v[32:35], v2
    s_waitcnt lgkmcnt(0)
    v_and_b32 v32, v32, v33
    v_and_b32 v34, v34, v35
    v_and_b32 v32, v32, v34
    v_cmp_eq_u32 vcc, 0, v32
    s_cbranch_vccnz rdok_43
L_p3_m:
    s_setprio 0
    s_waitcnt vmcnt(15)
    v_mfma_f32_32x32x16_bf16 v[32:47], v[128:131], v[64:67], 0
    v_mfma_f32_32x32x16_bf16 v[48:63], v[132:135], v[64:67], 0
    s_waitcnt vmcnt(14)
    v_mfma_f32_32x32x16_bf16 v[32:47], v[136:139], v[72:75], v[32:47]
    v_mfma_f32_32x32x16_bf16 v[48:63], v[140:143], v[72:75], v[48:63]
    s_waitcnt vmcnt(13)
    v_mfma_f32_32x32x16_bf16 v[32:47], v[144:147], v[80:83], v[32:47]
    v_mfma_f32_32x32x16_bf16 v[48:63], v[148:151], v[80:83], v[48:63]
    s_waitcnt vmcnt(10)
    v_permlane32_swap_b32 v70, v92
    v_permlane32_swap_b32 v71, v93
    v_mfma_f32_32x32x16_bf16 v[32:47], v[152:155], v[88:91], v[32:47]
    v_mfma_f32_32x32x16_bf16 v[48:63], v[156:159], v[88:91], v[48:63]
    s_waitcnt vmcnt(9)
    v_permlane32_swap_b32 v78, v94
    v_permlane32_swap_b32 v79, v95
    v_mfma_f32_32x32x16_bf16 v[32:47], v[160:163], v[68:71], v[32:47]
    v_mfma_f32_32x32x16_bf16 v[48:63], v[164:167], v[68:71], v[48:63]
    s_waitcnt vmcnt(8)
    s_mov_b32 exec_lo, 0
    v_mov_b32 v86, v92
    v_mov_b32 v87, v93
    s_mov_b32 exec_lo, -1
    v_mfma_f32_32x32x16_bf16 v[32:47], v[168:171], v[76:79], v[32:47]
    v_mfma_f32_32x32x16_bf16 v[48:63], v[172:175], v[76:79], v[48:63]
    v_mfma_f32_32x32x16_bf16 v[32:47], v[176:179], v[84:87], v[32:47]
    v_mfma_f32_32x32x16_bf16 v[48:63], v[180:183], v[84:87], v[48:63]
    s_waitcnt vmcnt(7)
    v_mfma_f32_32x32x16_bf16 v[32:47], v[192:195], v[96:99], v[32:47]
    v_mfma_f32_32x32x16_bf16 v[48:63], v[196:199], v[96:99], v[48:63]
    s_waitcnt vmcnt(6)
    v_mfma_f32_32x32x16_bf16 v[32:47], v[200:203], v[104:107], v[32:47]
    v_mfma_f32_32x32x16_bf16 v[48:63], v[204:207], v[104:107], v[48:63]
    s_waitcnt vmcnt(5)
    v_mfma_f32_32x32x16_bf16 v[32:47], v[208:211], v[112:115], v[32:47]
    v_mfma_f32_32x32x16_bf16 v[48:63], v[212:215], v[112:115], v[48:63]
    s_waitcnt vmcnt(2)
    v_permlane32_swap_b32 v102, v124
    v_permlane32_swap_b32 v103, v125
    v_mfma_f32_32x32x16_bf16 v[32:47], v[216:219], v[120:123], v[32:47]
    v_mfma_f32_32x32x16_bf16 v[48:63], v[220:223], v[120:123], v[48:63]
    s_waitcnt vmcnt(1)
    v_permlane32_swap_b32 v110, v126
    v_permlane32_swap_b32 v111, v127
    v_mfma_f32_32x32x16_bf16 v[32:47], v[224:227], v[100:103], v[32:47]
    v_mfma_f32_32x32x16_bf16 v[48:63], v[228:231], v[100:103], v[48:63]
    s_waitcnt vmcnt(0)
    s_mov_b32 exec_lo, 0
    v_mov_b32 v118, v124
    v_mov_b32 v119, v125
    s_mov_b32 exec_lo, -1
    v_mfma_f32_32x32x16_bf16 v[32:47], v[232:235], v[108:111], v[32:47]
    v_mfma_f32_32x32x16_bf16 v[48:63], v[236:239], v[108:111], v[48:63]
    v_mfma_f32_32x32x16_bf16 v[32:47], v[240:243], v[116:119], v[32:47]
    v_mfma_f32_32x32x16_bf16 v[48:63], v[244:247], v[116:119], v[48:63]
    s_cmp_ge_u32 s34, 4
    s_cbranch_scc1 L_p3_w
    v_mov_b32 v2, 162336
rdok_44:
    ds_read_b128 v[64:67], v2
    s_waitcnt lgkmcnt(0)
    v_and_b32 v64, v64, v65
    v_and_b32 v66, v66, v67
    v_and_b32 v64, v64, v66
    v_cmp_eq_u32 vcc, 0, v64
    s_cbranch_vccnz rdok_44
L_p3_w:
    s_nop 8
L_p3_pack:
    v_cvt_pk_bf16_f32 v96, v32, v33
    v_cvt_pk_bf16_f32 v97, v34, v35
    v_cvt_pk_bf16_f32 v98, v36, v37
    v_cvt_pk_bf16_f32 v99, v38, v39
    ds_write_b128 v3, v[96:99] offset:0
    v_cvt_pk_bf16_f32 v100, v40, v41
    v_cvt_pk_bf16_f32 v101, v42, v43
    v_cvt_pk_bf16_f32 v102, v44, v45
    v_cvt_pk_bf16_f32 v103, v46, v47
    ds_write_b128 v3, v[100:103] offset:8224
    v_cvt_pk_bf16_f32 v104, v48, v49
    v_cvt_pk_bf16_f32 v105, v50, v51
    v_cvt_pk_bf16_f32 v106, v52, v53
    v_cvt_pk_bf16_f32 v107, v54, v55
    ds_write_b128 v3, v[104:107] offset:16448
    v_cvt_pk_bf16_f32 v108, v56, v57
    v_cvt_pk_bf16_f32 v109, v58, v59
    v_cvt_pk_bf16_f32 v110, v60, v61
    v_cvt_pk_bf16_f32 v111, v62, v63
    ds_write_b128 v3, v[108:111] offset:24672
L_p3_x:
    s_waitcnt lgkmcnt(0)
    s_mov_b32 s64, s18
    s_and_b32 s65, s19, 0xffff
    s_mov_b32 s66, 1835008
    s_mov_b32 s67, 0x20000
    s_barrier
    ds_read_b32 v6, v13
    ds_read2st64_b64 v[128:131], v4 offset0:0 offset1:1
    ds_read2st64_b64 v[132:135], v4 offset0:2 offset1:3
    ds_read2st64_b64 v[136:139], v4 offset0:4 offset1:5
    ds_read2st64_b64 v[140:143], v4 offset0:6 offset1:7
    s_mov_b32 s47, 0xffff0000
    s_waitcnt lgkmcnt(3)
    v_cmp_ne_u32 vcc, 0, v6
    s_cmp_ge_u32 s38, 28
    s_cbranch_vccnz L_p3_fb
    s_cbranch_scc1 L_exit
    v_lshlrev_b32 v96, 16, v128
    v_and_b32 v97, s47, v128
    v_lshlrev_b32 v98, 16, v129
    v_and_b32 v99, s47, v129
    v_lshlrev_b32 v100, 16, v130
    v_and_b32 v101, s47, v130
    v_lshlrev_b32 v102, 16, v131
    v_and_b32 v103, s47, v131
    s_waitcnt lgkmcnt(2)
    v_lshlrev_b32 v104, 16, v132
    v_and_b32 v105, s47, v132
    v_lshlrev_b32 v106, 16, v133
    v_and_b32 v107, s47, v133
    v_lshlrev_b32 v108, 16, v134
    v_and_b32 v109, s47, v134
    v_lshlrev_b32 v110, 16, v135
    v_and_b32 v111, s47, v135
    v_pk_add_f32 v[96:97], v[96:97], v[104:105]
    v_pk_add_f32 v[98:99], v[98:99], v[106:107]
    v_pk_add_f32 v[100:101], v[100:101], v[108:109]
    v_pk_add_f32 v[102:103], v[102:103], v[110:111]
    s_waitcnt lgkmcnt(1)
    v_lshlrev_b32 v112, 16, v136
    v_and_b32 v113, s47, v136
    v_lshlrev_b32 v114, 16, v137
    v_and_b32 v115, s47, v137
    v_lshlrev_b32 v116, 16, v138
    v_and_b32 v117, s47, v138
    v_lshlrev_b32 v118, 16, v139
    v_and_b32 v119, s47, v139
    s_waitcnt lgkmcnt(0)
    v_lshlrev_b32 v120, 16, v140
    v_and_b32 v121, s47, v140
    v_lshlrev_b32 v122, 16, v141
    v_and_b32 v123, s47, v141
    v_lshlrev_b32 v124, 16, v142
    v_and_b32 v125, s47, v142
    v_lshlrev_b32 v126, 16, v143
    v_and_b32 v127, s47, v143
    v_pk_add_f32 v[112:113], v[112:113], v[120:121]
    v_pk_add_f32 v[114:115], v[114:115], v[122:123]
    v_pk_add_f32 v[116:117], v[116:117], v[124:125]
    v_pk_add_f32 v[118:119], v[118:119], v[126:127]
    v_pk_add_f32 v[96:97], v[96:97], v[112:113]
    v_pk_add_f32 v[98:99], v[98:99], v[114:115]
    v_pk_add_f32 v[100:101], v[100:101], v[116:117]
    v_pk_add_f32 v[102:103], v[102:103], v[118:119]
    v_cvt_pk_bf16_f32 v28, v96, v97
    v_cvt_pk_bf16_f32 v29, v98, v99
    v_cvt_pk_bf16_f32 v30, v100, v101
    v_cvt_pk_bf16_f32 v31, v102, v103
    buffer_store_dwordx4 v[28:31], v5, s[64:67], s50 offen sc1
    s_endpgm
L_p3_fb:
    s_setprio 0
    s_waitcnt vmcnt(0) lgkmcnt(0)
    s_mov_b32 s60, 1
    s_lshl_b32 s46, s33, 18
    s_add_u32 s10, s22, s46
    s_addc_u32 s11, s23, 0
    s_mov_b32 s64, s10
    s_and_b32 s65, s11, 0xffff
    s_mov_b32 s66, 262144
    s_mov_b32 s67, 0x20000
    s_add_u32 s10, s10, 4194304
    s_addc_u32 s11, s11, 0
    s_mov_b32 s68, s10
    s_and_b32 s69, s11, 0xffff
    s_mov_b32 s70, 262144
    s_mov_b32 s71, 0x20000
    s_mov_b32 s24, s14
    s_and_b32 s25, s15, 0xffff
    s_mov_b32 s26, 401408
    s_mov_b32 s27, 0x20000
    s_min_u32 s62, s39, 10240
    v_lshlrev_b32 v8, 4, v1
    v_mov_b32 v13, 0xdddddddd
    v_add_u32 v12, s39, v8
    v_mov_b32 v237, 0
    v_mov_b32 v227, 1
    v_and_b32 v2, 0x23, v1
    v_bfe_u32 v3, v1, 2, 1
    v_lshl_add_u32 v2, v3, 4, v2
    v_bfe_u32 v3, v1, 3, 2
    v_lshl_add_u32 v2, v3, 2, v2
    v_lshlrev_b32 v248, 4, v2
    s_and_b32 s46, s35, 1
    s_lshl_b32 s46, s46, 13
    s_and_b32 s46, s46, 0x2000
    v_add_u32 v10, s46, v8
    v_add_u32 v250, s46, v248
    s_cmp_lt_u32 s34, 4
    s_cbranch_scc1 L_a_fallback
    s_branch L_b_fallback
L_b_fallback:
    s_add_u32 s46, s33, 16
    s_mul_i32 s46, s46, 43
    s_lshr_b32 s46, s46, 7
    s_add_u32 s47, s33, 32
    s_mul_i32 s47, s47, 43
    s_lshr_b32 s47, s47, 7
    s_mul_i32 s48, s33, 43
    s_lshr_b32 s48, s48, 7
    s_lshl_b32 s46, s46, 6
    s_lshl_b32 s47, s47, 6
    s_lshl_b32 s48, s48, 6
    s_add_u32 s48, s48, s40
    v_and_b32 v2, 15, v1
    v_lshl_add_u32 v2, v2, 2, s35
    v_add_u32 v3, s46, v2
    v_add_u32 v4, s47, v2
    v_mov_b32 v5, s48
    v_cmp_gt_u32 vcc, 16, v1
    v_cmp_gt_u32 s[12:13], 32, v1
    s_nop 0
    v_cndmask_b32 v3, v4, v3, vcc
    v_cndmask_b32 v235, v5, v3, s[12:13]
    v_lshlrev_b32 v235, 7, v235
    v_add_u32 v235, 21102592, v235
    v_and_b32 v2, 3, v1
    v_min_u32 v2, 2, v2
    v_sub_u32 v2, s32, v2
    v_max_i32 v2, 0, v2
    s_sub_u32 s50, 3, s35
    v_lshl_add_u32 v2, v2, 2, s50
    v_add_u32 v3, s46, v2
    v_add_u32 v4, s47, v2
    v_cmp_gt_u32 vcc, 4, v1
    v_cmp_gt_u32 s[12:13], 8, v1
    s_nop 0
    v_cndmask_b32 v3, v4, v3, vcc
    v_cndmask_b32 v236, v5, v3, s[12:13]
    v_lshlrev_b32 v236, 7, v236
    v_add_u32 v236, 20971520, v236
    s_add_u32 s47, s39, 65536
    s_lshl_b32 s46, s32, 2
    s_add_u32 s46, s46, 3
    s_sub_u32 s46, s46, s35
    s_lshl_b32 s46, s46, 12
    v_add_u32 v224, s46, v8
    v_subrev_u32 v225, 16384, v224
    v_subrev_u32 v226, 32768, v224
    s_sub_u32 s46, 65536 + 32768 + 3*4096, s39
    v_add_u32 v9, s46, v8
    v_add_u32 v249, s46, v248
    v_add_u32 v11, 131072, v10
    v_add_u32 v251, 131072, v250
    v_add_u32 v10, 65536, v10
    v_add_u32 v250, 65536, v250
    v_and_b32 v3, 31, v1
    v_lshrrev_b32 v2, 5, v1
    v_lshlrev_b32 v2, 4, v2
    v_sub_u32 v3, v3, v2
    v_mov_b32 v2, 4278190080
    v_cmp_le_i32 s[10:11], 0, v3
    v_cmp_le_i32 s[12:13], 1, v3
    s_nop 0
    v_cndmask_b32 v192, v2, 0, s[10:11]
    v_cndmask_b32 v208, 0, v2, s[10:11]
    v_cndmask_b32 v193, v2, 0, s[12:13]
    v_cndmask_b32 v209, 0, v2, s[12:13]
    v_cmp_le_i32 s[10:11], 2, v3
    v_cmp_le_i32 s[12:13], 3, v3
    s_nop 0
    v_cndmask_b32 v194, v2, 0, s[10:11]
    v_cndmask_b32 v210, 0, v2, s[10:11]
    v_cndmask_b32 v195, v2, 0, s[12:13]
    v_cndmask_b32 v211, 0, v2, s[12:13]
    v_cmp_le_i32 s[10:11], 4, v3
    v_cmp_le_i32 s[12:13], 5, v3
    s_nop 0
    v_cndmask_b32 v196, v2, 0, s[10:11]
    v_cndmask_b32 v212, 0, v2, s[10:11]
    v_cndmask_b32 v197, v2, 0, s[12:13]
    v_cndmask_b32 v213, 0, v2, s[12:13]
    v_cmp_le_i32 s[10:11], 6, v3
    v_cmp_le_i32 s[12:13], 7, v3
    s_nop 0
    v_cndmask_b32 v198, v2, 0, s[10:11]
    v_cndmask_b32 v214, 0, v2, s[10:11]
    v_cndmask_b32 v199, v2, 0, s[12:13]
    v_cndmask_b32 v215, 0, v2, s[12:13]
    v_cmp_le_i32 s[10:11], 8, v3
    v_cmp_le_i32 s[12:13], 9, v3
    s_nop 0
    v_cndmask_b32 v200, v2, 0, s[10:11]
    v_cndmask_b32 v216, 0, v2, s[10:11]
    v_cndmask_b32 v201, v2, 0, s[12:13]
    v_cndmask_b32 v217, 0, v2, s[12:13]
    v_cmp_le_i32 s[10:11], 10, v3
    v_cmp_le_i32 s[12:13], 11, v3
    s_nop 0
    v_cndmask_b32 v202, v2, 0, s[10:11]
    v_cndmask_b32 v218, 0, v2, s[10:11]
    v_cndmask_b32 v203, v2, 0, s[12:13]
    v_cndmask_b32 v219, 0, v2, s[12:13]
    v_cmp_le_i32 s[10:11], 12, v3
    v_cmp_le_i32 s[12:13], 13, v3
    s_nop 0
    v_cndmask_b32 v204, v2, 0, s[10:11]
    v_cndmask_b32 v220, 0, v2, s[10:11]
    v_cndmask_b32 v205, v2, 0, s[12:13]
    v_cndmask_b32 v221, 0, v2, s[12:13]
    v_cmp_le_i32 s[10:11], 14, v3
    v_cmp_le_i32 s[12:13], 15, v3
    s_nop 0
    v_cndmask_b32 v206, v2, 0, s[10:11]
    v_cndmask_b32 v222, 0, v2, s[10:11]
    v_cndmask_b32 v207, v2, 0, s[12:13]
    v_cndmask_b32 v223, 0, v2, s[12:13]
    s_mov_b32 exec_lo, 0
    v_mov_b64 v[22:23], 0
    s_mov_b32 exec_lo, -1
    v_mov_b32 v80, 4278190080
    v_mov_b32 v81, 4278190080
    v_mov_b32 v82, 4278190080
    v_mov_b32 v83, 4278190080
    v_mov_b32 v84, 4278190080
    v_mov_b32 v85, 4278190080
    v_mov_b32 v86, 4278190080
    v_mov_b32 v87, 4278190080
    v_mov_b32 v88, 4278190080
    v_mov_b32 v89, 4278190080
    v_mov_b32 v90, 4278190080
    v_mov_b32 v91, 4278190080
    v_mov_b32 v92, 4278190080
    v_mov_b32 v93, 4278190080
    v_mov_b32 v94, 4278190080
    v_mov_b32 v95, 4278190080
    s_mov_b32 s48, 0
fbB_45:
    buffer_load_dwordx4 v[128:131], v8, s[68:71], s48 offen sc1
    buffer_load_dwordx4 v[132:135], v8, s[68:71], s48 offen offset:1024 sc1
    s_waitcnt vmcnt(0)
    v_mfma_f32_32x32x16_bf16 v[64:79], v[128:131], v[16:19], 0
    v_mfma_f32_32x32x16_bf16 v[64:79], v[132:135], v[20:23], v[64:79]
    s_nop 15
    v_max_f32 v80, v80, v64
    v_max_f32 v81, v81, v65
    v_max_f32 v82, v82, v66
    v_max_f32 v83, v83, v67
    v_max_f32 v84, v84, v68
    v_max_f32 v85, v85, v69
    v_max_f32 v86, v86, v70
    v_max_f32 v87, v87, v71
    v_max_f32 v88, v88, v72
    v_max_f32 v89, v89, v73
    v_max_f32 v90, v90, v74
    v_max_f32 v91, v91, v75
    v_max_f32 v92, v92, v76
    v_max_f32 v93, v93, v77
    v_max_f32 v94, v94, v78
    v_max_f32 v95, v95, v79
    s_add_u32 s48, s48, 4096
    s_cmp_lt_u32 s48, 262144
    s_cbranch_scc1 fbB_45
    v_max3_f32 v2, v80, v81, v82
    v_max3_f32 v3, v83, v84, v85
    v_max3_f32 v2, v2, v86, v87
    v_max3_f32 v3, v3, v88, v89
    v_max3_f32 v2, v2, v90, v91
    v_max3_f32 v3, v3, v92, v93
    v_max3_f32 v2, v2, v94, v95
    v_max_f32 v3, v2, v3
    v_mov_b32 v4, v3
    s_nop 1
    v_permlane32_swap_b32 v3, v4
    s_nop 1
    v_max_f32 v2, v3, v4
    v_cvt_pk_bf16_f32 v3, -v2, 0
    v_lshlrev_b32 v4, 16, v3
    v_sub_f32 v2, -v2, v4
    v_cvt_pk_bf16_f32 v5, v2, 0
    v_lshlrev_b32 v4, 16, v5
    v_sub_f32 v2, v2, v4
    v_or_b32 v228, v3, v4
    v_cvt_pk_bf16_f32 v229, v2, 0
    s_mov_b32 exec_lo, 0
    v_mov_b64 v[30:31], 0
    s_mov_b32 exec_lo, -1
    v_mov_b32 v80, 4278190080
    v_mov_b32 v81, 4278190080
    v_mov_b32 v82, 4278190080
    v_mov_b32 v83, 4278190080
    v_mov_b32 v84, 4278190080
    v_mov_b32 v85, 4278190080
    v_mov_b32 v86, 4278190080
    v_mov_b32 v87, 4278190080
    v_mov_b32 v88, 4278190080
    v_mov_b32 v89, 4278190080
    v_mov_b32 v90, 4278190080
    v_mov_b32 v91, 4278190080
    v_mov_b32 v92, 4278190080
    v_mov_b32 v93, 4278190080
    v_mov_b32 v94, 4278190080
    v_mov_b32 v95, 4278190080
    s_cmp_lt_u32 s40, 0
    s_cbranch_scc1 fbA_46
    s_sub_u32 s48, s40, 0
    s_lshl_b32 s48, s48, 12
    buffer_load_dwordx4 v[128:131], v248, s[64:67], s48 offen sc1
    buffer_load_dwordx4 v[132:135], v248, s[64:67], s48 offen offset:1024 sc1
    s_waitcnt vmcnt(0)
    v_mfma_f32_32x32x16_bf16 v[64:79], v[128:131], v[24:27], v[192:207]
    v_mfma_f32_32x32x16_bf16 v[64:79], v[132:135], v[28:31], v[64:79]
    s_nop 15
    v_max_f32 v80, v80, v64
    v_max_f32 v81, v81, v65
    v_max_f32 v82, v82, v66
    v_max_f32 v83, v83, v67
    v_max_f32 v84, v84, v68
    v_max_f32 v85, v85, v69
    v_max_f32 v86, v86, v70
    v_max_f32 v87, v87, v71
    v_max_f32 v88, v88, v72
    v_max_f32 v89, v89, v73
    v_max_f32 v90, v90, v74
    v_max_f32 v91, v91, v75
    v_max_f32 v92, v92, v76
    v_max_f32 v93, v93, v77
    v_max_f32 v94, v94, v78
    v_max_f32 v95, v95, v79
fbA_46:
    s_cmp_lt_u32 s40, 1
    s_cbranch_scc1 fbA_47
    s_sub_u32 s48, s40, 1
    s_lshl_b32 s48, s48, 12
    buffer_load_dwordx4 v[128:131], v248, s[64:67], s48 offen sc1
    buffer_load_dwordx4 v[132:135], v248, s[64:67], s48 offen offset:1024 sc1
    s_waitcnt vmcnt(0)
    v_mfma_f32_32x32x16_bf16 v[64:79], v[128:131], v[24:27], 0
    v_mfma_f32_32x32x16_bf16 v[64:79], v[132:135], v[28:31], v[64:79]
    s_nop 15
    v_max_f32 v80, v80, v64
    v_max_f32 v81, v81, v65
    v_max_f32 v82, v82, v66
    v_max_f32 v83, v83, v67
    v_max_f32 v84, v84, v68
    v_max_f32 v85, v85, v69
    v_max_f32 v86, v86, v70
    v_max_f32 v87, v87, v71
    v_max_f32 v88, v88, v72
    v_max_f32 v89, v89, v73
    v_max_f32 v90, v90, v74
    v_max_f32 v91, v91, v75
    v_max_f32 v92, v92, v76
    v_max_f32 v93, v93, v77
    v_max_f32 v94, v94, v78
    v_max_f32 v95, v95, v79
fbA_47:
    s_cmp_lt_u32 s40, 2
    s_cbranch_scc1 fbA_48
    s_sub_u32 s48, s40, 2
    s_lshl_b32 s48, s48, 12
    buffer_load_dwordx4 v[128:131], v248, s[64:67], s48 offen sc1
    buffer_load_dwordx4 v[132:135], v248, s[64:67], s48 offen offset:1024 sc1
    s_waitcnt vmcnt(0)
    v_mfma_f32_32x32x16_bf16 v[64:79], v[128:131], v[24:27], 0
    v_mfma_f32_32x32x16_bf16 v[64:79], v[132:135], v[28:31], v[64:79]
    s_nop 15
    v_max_f32 v80, v80, v64
    v_max_f32 v81, v81, v65
    v_max_f32 v82, v82, v66
    v_max_f32 v83, v83, v67
    v_max_f32 v84, v84, v68
    v_max_f32 v85, v85, v69
    v_max_f32 v86, v86, v70
    v_max_f32 v87, v87, v71
    v_max_f32 v88, v88, v72
    v_max_f32 v89, v89, v73
    v_max_f32 v90, v90, v74
    v_max_f32 v91, v91, v75
    v_max_f32 v92, v92, v76
    v_max_f32 v93, v93, v77
    v_max_f32 v94, v94, v78
    v_max_f32 v95, v95, v79
fbA_48:
    s_cmp_lt_u32 s40, 3
    s_cbranch_scc1 fbA_49
    s_sub_u32 s48, s40, 3
    s_lshl_b32 s48, s48, 12
    buffer_load_dwordx4 v[128:131], v248, s[64:67], s48 offen sc1
    buffer_load_dwordx4 v[132:135], v248, s[64:67], s48 offen offset:1024 sc1
    s_waitcnt vmcnt(0)
    v_mfma_f32_32x32x16_bf16 v[64:79], v[128:131], v[24:27], 0
    v_mfma_f32_32x32x16_bf16 v[64:79], v[132:135], v[28:31], v[64:79]
    s_nop 15
    v_max_f32 v80, v80, v64
    v_max_f32 v81, v81, v65
    v_max_f32 v82, v82, v66
    v_max_f32 v83, v83, v67
    v_max_f32 v84, v84, v68
    v_max_f32 v85, v85, v69
    v_max_f32 v86, v86, v70
    v_max_f32 v87, v87, v71
    v_max_f32 v88, v88, v72
    v_max_f32 v89, v89, v73
    v_max_f32 v90, v90, v74
    v_max_f32 v91, v91, v75
    v_max_f32 v92, v92, v76
    v_max_f32 v93, v93, v77
    v_max_f32 v94, v94, v78
    v_max_f32 v95, v95, v79
fbA_49:
    s_cmp_lt_u32 s40, 4
    s_cbranch_scc1 fbA_50
    s_sub_u32 s48, s40, 4
    s_lshl_b32 s48, s48, 12
    buffer_load_dwordx4 v[128:131], v248, s[64:67], s48 offen sc1
    buffer_load_dwordx4 v[132:135], v248, s[64:67], s48 offen offset:1024 sc1
    s_waitcnt vmcnt(0)
    v_mfma_f32_32x32x16_bf16 v[64:79], v[128:131], v[24:27], 0
    v_mfma_f32_32x32x16_bf16 v[64:79], v[132:135], v[28:31], v[64:79]
    s_nop 15
    v_max_f32 v80, v80, v64
    v_max_f32 v81, v81, v65
    v_max_f32 v82, v82, v66
    v_max_f32 v83, v83, v67
    v_max_f32 v84, v84, v68
    v_max_f32 v85, v85, v69
    v_max_f32 v86, v86, v70
    v_max_f32 v87, v87, v71
    v_max_f32 v88, v88, v72
    v_max_f32 v89, v89, v73
    v_max_f32 v90, v90, v74
    v_max_f32 v91, v91, v75
    v_max_f32 v92, v92, v76
    v_max_f32 v93, v93, v77
    v_max_f32 v94, v94, v78
    v_max_f32 v95, v95, v79
fbA_50:
    s_cmp_lt_u32 s40, 5
    s_cbranch_scc1 fbA_51
    s_sub_u32 s48, s40, 5
    s_lshl_b32 s48, s48, 12
    buffer_load_dwordx4 v[128:131], v248, s[64:67], s48 offen sc1
    buffer_load_dwordx4 v[132:135], v248, s[64:67], s48 offen offset:1024 sc1
    s_waitcnt vmcnt(0)
    v_mfma_f32_32x32x16_bf16 v[64:79], v[128:131], v[24:27], 0
    v_mfma_f32_32x32x16_bf16 v[64:79], v[132:135], v[28:31], v[64:79]
    s_nop 15
    v_max_f32 v80, v80, v64
    v_max_f32 v81, v81, v65
    v_max_f32 v82, v82, v66
    v_max_f32 v83, v83, v67
    v_max_f32 v84, v84, v68
    v_max_f32 v85, v85, v69
    v_max_f32 v86, v86, v70
    v_max_f32 v87, v87, v71
    v_max_f32 v88, v88, v72
    v_max_f32 v89, v89, v73
    v_max_f32 v90, v90, v74
    v_max_f32 v91, v91, v75
    v_max_f32 v92, v92, v76
    v_max_f32 v93, v93, v77
    v_max_f32 v94, v94, v78
    v_max_f32 v95, v95, v79
fbA_51:
    s_cmp_lt_u32 s40, 6
    s_cbranch_scc1 fbA_52
    s_sub_u32 s48, s40, 6
    s_lshl_b32 s48, s48, 12
    buffer_load_dwordx4 v[128:131], v248, s[64:67], s48 offen sc1
    buffer_load_dwordx4 v[132:135], v248, s[64:67], s48 offen offset:1024 sc1
    s_waitcnt vmcnt(0)
    v_mfma_f32_32x32x16_bf16 v[64:79], v[128:131], v[24:27], 0
    v_mfma_f32_32x32x16_bf16 v[64:79], v[132:135], v[28:31], v[64:79]
    s_nop 15
    v_max_f32 v80, v80, v64
    v_max_f32 v81, v81, v65
    v_max_f32 v82, v82, v66
    v_max_f32 v83, v83, v67
    v_max_f32 v84, v84, v68
    v_max_f32 v85, v85, v69
    v_max_f32 v86, v86, v70
    v_max_f32 v87, v87, v71
    v_max_f32 v88, v88, v72
    v_max_f32 v89, v89, v73
    v_max_f32 v90, v90, v74
    v_max_f32 v91, v91, v75
    v_max_f32 v92, v92, v76
    v_max_f32 v93, v93, v77
    v_max_f32 v94, v94, v78
    v_max_f32 v95, v95, v79
fbA_52:
    s_cmp_lt_u32 s40, 7
    s_cbranch_scc1 fbA_53
    s_sub_u32 s48, s40, 7
    s_lshl_b32 s48, s48, 12
    buffer_load_dwordx4 v[128:131], v248, s[64:67], s48 offen sc1
    buffer_load_dwordx4 v[132:135], v248, s[64:67], s48 offen offset:1024 sc1
    s_waitcnt vmcnt(0)
    v_mfma_f32_32x32x16_bf16 v[64:79], v[128:131], v[24:27], 0
    v_mfma_f32_32x32x16_bf16 v[64:79], v[132:135], v[28:31], v[64:79]
    s_nop 15
    v_max_f32 v80, v80, v64
    v_max_f32 v81, v81, v65
    v_max_f32 v82, v82, v66
    v_max_f32 v83, v83, v67
    v_max_f32 v84, v84, v68
    v_max_f32 v85, v85, v69
    v_max_f32 v86, v86, v70
    v_max_f32 v87, v87, v71
    v_max_f32 v88, v88, v72
    v_max_f32 v89, v89, v73
    v_max_f32 v90, v90, v74
    v_max_f32 v91, v91, v75
    v_max_f32 v92, v92, v76
    v_max_f32 v93, v93, v77
    v_max_f32 v94, v94, v78
    v_max_f32 v95, v95, v79
fbA_53:
    s_cmp_lt_u32 s40, 8
    s_cbranch_scc1 fbA_54
    s_sub_u32 s48, s40, 8
    s_lshl_b32 s48, s48, 12
    buffer_load_dwordx4 v[128:131], v248, s[64:67], s48 offen sc1
    buffer_load_dwordx4 v[132:135], v248, s[64:67], s48 offen offset:1024 sc1
    s_waitcnt vmcnt(0)
    v_mfma_f32_32x32x16_bf16 v[64:79], v[128:131], v[24:27], v[208:223]
    v_mfma_f32_32x32x16_bf16 v[64:79], v[132:135], v[28:31], v[64:79]
    s_nop 15
    v_max_f32 v80, v80, v64
    v_max_f32 v81, v81, v65
    v_max_f32 v82, v82, v66
    v_max_f32 v83, v83, v67
    v_max_f32 v84, v84, v68
    v_max_f32 v85, v85, v69
    v_max_f32 v86, v86, v70
    v_max_f32 v87, v87, v71
    v_max_f32 v88, v88, v72
    v_max_f32 v89, v89, v73
    v_max_f32 v90, v90, v74
    v_max_f32 v91, v91, v75
    v_max_f32 v92, v92, v76
    v_max_f32 v93, v93, v77
    v_max_f32 v94, v94, v78
    v_max_f32 v95, v95, v79
fbA_54:
    v_max3_f32 v2, v80, v81, v82
    v_max3_f32 v3, v83, v84, v85
    v_max3_f32 v2, v2, v86, v87
    v_max3_f32 v3, v3, v88, v89
    v_max3_f32 v2, v2, v90, v91
    v_max3_f32 v3, v3, v92, v93
    v_max3_f32 v2, v2, v94, v95
    v_max_f32 v3, v2, v3
    v_mov_b32 v4, v3
    s_nop 1
    v_permlane32_swap_b32 v3, v4
    s_nop 1
    v_max_f32 v2, v3, v4
    v_cvt_pk_bf16_f32 v3, -v2, 0
    v_lshlrev_b32 v4, 16, v3
    v_sub_f32 v2, -v2, v4
    v_cvt_pk_bf16_f32 v5, v2, 0
    v_lshlrev_b32 v4, 16, v5
    v_sub_f32 v2, v2, v4
    v_or_b32 v230, v3, v4
    v_cvt_pk_bf16_f32 v231, v2, 0
    v_mov_b32 v32, 0
    v_mov_b32 v33, 0
    v_mov_b32 v34, 0
    v_mov_b32 v35, 0
    v_mov_b32 v36, 0
    v_mov_b32 v37, 0
    v_mov_b32 v38, 0
    v_mov_b32 v39, 0
    v_mov_b32 v40, 0
    v_mov_b32 v41, 0
    v_mov_b32 v42, 0
    v_mov_b32 v43, 0
    v_mov_b32 v44, 0
    v_mov_b32 v45, 0
    v_mov_b32 v46, 0
    v_mov_b32 v47, 0
    v_mov_b32 v48, 0
    v_mov_b32 v49, 0
    v_mov_b32 v50, 0
    v_mov_b32 v51, 0
    v_mov_b32 v52, 0
    v_mov_b32 v53, 0
    v_mov_b32 v54, 0
    v_mov_b32 v55, 0
    v_mov_b32 v56, 0
    v_mov_b32 v57, 0
    v_mov_b32 v58, 0
    v_mov_b32 v59, 0
    v_mov_b32 v60, 0
    v_mov_b32 v61, 0
    v_mov_b32 v62, 0
    v_mov_b32 v63, 0
    v_mov_b32 v208, 0
    v_mov_b32 v209, 0
    v_mov_b32 v210, 0
    v_mov_b32 v211, 0
    v_mov_b32 v212, 0
    v_mov_b32 v213, 0
    v_mov_b32 v214, 0
    v_mov_b32 v215, 0
    v_mov_b32 v216, 0
    v_mov_b32 v217, 0
    v_mov_b32 v218, 0
    v_mov_b32 v219, 0
    v_mov_b32 v220, 0
    v_mov_b32 v221, 0
    v_mov_b32 v222, 0
    v_mov_b32 v223, 0
    v_mov_b32 v232, s100
    v_mov_b32 v233, s101
    s_barrier
    s_branch L_b_restart
P1B_QQQ:
    s_mul_i32 s36, s33, 168
    s_and_b32 s37, s36, 15
    s_sub_u32 s36, s36, s37
    v_and_b32 v3, 15, v1
    v_lshrrev_b32 v4, 4, v1
    v_lshrrev_b32 v5, 1, v3
    v_xor_b32 v5, v5, v4
    s_lshl_b32 s40, s34, 12
    v_lshl_add_u32 v6, v3, 7, s40
    v_lshl_add_u32 v8, v5, 4, v6
    v_xor_b32 v9, 64, v8
    v_bfe_u32 v5, v1, 2, 2
    v_lshl_add_u32 v5, v4, 2, v5
    v_mul_u32_u24 v5, 352, v5
    v_and_b32 v6, 3, v1
    v_lshl_add_u32 v5, v6, 3, v5
    s_add_u32 s40, s37, 98304
    v_add_u32 v12, s40, v5
    v_lshlrev_b32 v79, 4, v4
    v_add_u32 v79, 159744, v79
    v_mov_b32 v2, 163840
    s_mov_b32 vcc_lo, 0x00010001
    s_mov_b32 vcc_hi, 0x00010001
    v_cndmask_b32 v79, v2, v79, vcc
    s_waitcnt lgkmcnt(0)
    s_mov_b32 s96, s20
    s_and_b32 s97, s21, 0xffff
    s_mov_b32 s98, 256
    s_mov_b32 s99, 0x20000
    s_or_b32 s53, s2, s34
    s_cbranch_scc1 notag_55
    s_memrealtime s[100:101]
    s_waitcnt lgkmcnt(0)
    s_lshl_b64 s[100:101], s[100:101], 1
    s_or_b32 s100, s100, 1
    v_mov_b32 v76, s100
    v_mov_b32 v77, s101
    s_mov_b64 exec, 1
    buffer_store_dwordx2 v[76:77], off, s[96:99], 0 sc1
    s_mov_b64 exec, -1
notag_55:
    s_xor_b32 s62, s33, 1
    s_lshr_b32 s40, s33, 1
    s_cmp_eq_u32 s40, 2
    s_cselect_b32 s62, s33, s62
    s_cmp_eq_u32 s40, 5
    s_cselect_b32 s62, s33, s62
    s_mul_i32 s38, s62, 168
    s_and_b32 s39, s38, 15
    s_sub_u32 s38, s38, s39
    v_add_u32 v5, s39, v5
    v_add_u32 v13, 98304, v5
    v_add_u32 v6, 65536, v5
    v_lshlrev_b32 v2, 4, v3
    v_lshl_add_u32 v14, v4, 9, v2
    v_cmp_eq_u32 vcc, 12, v3
    v_mov_b32 v2, 0x3f803f80
    s_mov_b32 s50, 1049335798
    s_mov_b32 s51, 1049335798
    v_cndmask_b32 v7, 0, v2, vcc
    s_lshl_b32 s39, s35, 12
    s_lshl_b32 s40, s32, 2
    s_add_u32 s40, s40, s35
    s_mov_b32 s60, 0
    s_lshl_b32 s41, s33, 6
    s_add_u32 s41, s41, s40
    s_lshl_b32 s41, s41, 11
    s_add_u32 s41, s41, 8388608
    s_add_u32 s42, s41, 2097152
    s_lshl_b32 s45, s40, 5
    s_add_u32 s45, s45, s33
    s_lshl_b32 s43, s45, 11
    s_add_u32 s43, s43, 12582912
    s_add_u32 s44, s43, 32768
    s_lshl_b32 s45, s45, 7
    s_add_u32 s45, s45, 21233664
    s_mov_b32 s56, 1400897536
    s_mov_b32 s57, 729808896
    s_lshr_b32 s38, s2, 3
    s_mul_i32 s36, s38, 37
    s_lshr_b32 s36, s36, 8
    s_mul_i32 s37, s36, 7
    s_sub_u32 s37, s38, s37
    s_and_b32 s46, s2, 1
    s_lshl_b32 s46, s46, 4
    s_add_u32 s36, s36, s46
    s_and_b32 s46, s2, 6
    s_lshl_b32 s46, s46, 1
    s_add_u32 s36, s36, s46
    s_cmp_eq_u32 s35, 3
    s_cselect_b32 s49, 4294952960, 0
    s_lshl_b32 s46, s62, 6
    s_add_u32 s46, s46, s40
    s_lshl_b32 s46, s46, 7
    s_add_u32 s3, s46, 20971520
    s_lshl_b32 s46, s33, 6
    s_add_u32 s46, s46, s40
    s_lshl_b32 s46, s46, 7
    s_add_u32 s52, s46, 21102592
    s_mov_b32 s28, s22
    s_and_b32 s29, s23, 0xffff
    s_mov_b32 s30, 22020096
    s_mov_b32 s31, 0x20000
    s_lshl_b32 s46, s33, 18
    s_add_u32 s10, s22, s46
    s_addc_u32 s11, s23, 0
    s_mov_b32 s64, s10
    s_and_b32 s65, s11, 0xffff
    s_mov_b32 s66, 262144
    s_mov_b32 s67, 0x20000
    s_add_u32 s10, s10, 4194304
    s_addc_u32 s11, s11, 0
    s_mov_b32 s68, s10
    s_and_b32 s69, s11, 0xffff
    s_mov_b32 s70, 262144
    s_mov_b32 s71, 0x20000
    s_mov_b32 s24, s14
    s_and_b32 s25, s15, 0xffff
    s_mov_b32 s26, 401408
    s_mov_b32 s27, 0x20000
    s_and_b32 s4, s34, 1
    s_lshr_b32 s5, s34, 1
    s_lshl_b32 s46, s36, 1
    s_add_u32 s46, s46, s4
    s_lshl_b32 s47, s46, 5
    s_xor_b32 s48, s5, 2
    s_lshl_b32 s48, s48, 3
    s_add_u32 s47, s47, s48
    s_lshl_b32 s6, s47, 11
    s_add_u32 s6, s6, 12582912
    s_lshl_b32 s7, s47, 7
    s_add_u32 s7, s7, 21233664
    s_mul_i32 s58, s33, 3
    s_add_u32 s61, s58, 0
    s_and_b32 s61, s61, 15
    s_lshl_b32 s61, s61, 6
    s_add_u32 s61, s61, s40
    s_lshl_b32 s61, s61, 11
    s_add_u32 s54, s61, 10485760
    s_add_u32 s61, s58, 1
    s_and_b32 s61, s61, 15
    s_lshl_b32 s61, s61, 6
    s_add_u32 s61, s61, s40
    s_lshl_b32 s61, s61, 11
    s_add_u32 s55, s61, 10485760
    s_add_u32 s61, s58, 2
    s_and_b32 s61, s61, 15
    s_lshl_b32 s61, s61, 6
    s_add_u32 s61, s61, s40
    s_lshl_b32 s61, s61, 11
    s_add_u32 s17, s61, 10485760
    s_mul_i32 s58, s62, 3
    s_add_u32 s61, s58, 0
    s_and_b32 s61, s61, 15
    s_lshl_b32 s61, s61, 6
    s_add_u32 s61, s61, s40
    s_lshl_b32 s61, s61, 11
    s_add_u32 s47, s61, 8388608
    s_add_u32 s61, s58, 1
    s_and_b32 s61, s61, 15
    s_lshl_b32 s61, s61, 6
    s_add_u32 s61, s61, s40
    s_lshl_b32 s61, s61, 11
    s_add_u32 s59, s61, 8388608
    s_add_u32 s61, s58, 2
    s_and_b32 s61, s61, 15
    s_lshl_b32 s61, s61, 6
    s_add_u32 s61, s61, s40
    s_lshl_b32 s61, s61, 11
    s_add_u32 s16, s61, 8388608
    v_mov_b32 v54, 0
    v_mov_b32 v55, 0
    v_mov_b32 v58, 0
    v_mov_b32 v59, 0
    v_mov_b32 v62, 0
    v_mov_b32 v63, 0
    v_mov_b32 v66, 0
    v_mov_b32 v67, 0
    v_mov_b32 v70, 0
    v_mov_b32 v71, 0
    v_mov_b32 v74, 0
    v_mov_b32 v75, 0
    s_barrier
    ds_read_b128 v[128:131], v8 offset:0
    ds_read_b128 v[132:135], v8 offset:2048
    ds_read_b64_tr_b16 v[16:17], v12 offset:0
    ds_read_b64_tr_b16 v[18:19], v12 offset:176
    ds_read_b64_tr_b16 v[20:21], v12 offset:32
    ds_read_b64_tr_b16 v[22:23], v12 offset:208
    ds_read_b64_tr_b16 v[24:25], v12 offset:56
    ds_read_b64_tr_b16 v[26:27], v12 offset:232
    ds_read_b64_tr_b16 v[28:29], v12 offset:88
    ds_read_b64_tr_b16 v[30:31], v12 offset:264
    ds_read_b64_tr_b16 v[32:33], v12 offset:112
    ds_read_b64_tr_b16 v[34:35], v12 offset:288
    ds_read_b64_tr_b16 v[36:37], v12 offset:144
    ds_read_b64_tr_b16 v[38:39], v12 offset:320
    ds_read_b128 v[160:163], v79 offset:0
    s_waitcnt lgkmcnt(9)
    v_mfma_f32_16x16x32_bf16 v[80:83], v[16:19], v[128:131], 0
    ds_read_b128 v[136:139], v9 offset:0
    ds_read_b128 v[140:143], v9 offset:2048
    v_mfma_f32_16x16x32_bf16 v[88:91], v[16:19], v[132:135], 0
    ds_read_b64_tr_b16 v[40:41], v12 offset:5632
    ds_read_b64_tr_b16 v[42:43], v12 offset:5808
    v_mfma_f32_16x16x32_bf16 v[84:87], v[20:23], v[128:131], 0
    ds_read_b64_tr_b16 v[44:45], v12 offset:5664
    v_mfma_f32_16x16x32_bf16 v[92:95], v[20:23], v[132:135], 0
    ds_read_b64_tr_b16 v[46:47], v12 offset:5840
    s_waitcnt lgkmcnt(11)
    v_mfma_f32_16x16x32_bf16 v[96:99], v[24:27], v[128:131], 0
    ds_read_b64_tr_b16 v[16:17], v12 offset:5688
    v_mfma_f32_16x16x32_bf16 v[104:107], v[24:27], v[132:135], 0
    ds_read_b64_tr_b16 v[18:19], v12 offset:5864
    v_mfma_f32_16x16x32_bf16 v[100:103], v[28:31], v[128:131], 0
    ds_read_b64_tr_b16 v[20:21], v12 offset:5720
    v_mfma_f32_16x16x32_bf16 v[108:111], v[28:31], v[132:135], 0
    ds_read_b64_tr_b16 v[22:23], v12 offset:5896
    s_waitcnt lgkmcnt(10)
    v_mfma_f32_16x16x32_bf16 v[112:115], v[32:35], v[128:131], 0
    ds_read_b64_tr_b16 v[24:25], v12 offset:5744
    ds_read_b64_tr_b16 v[26:27], v12 offset:5920
    v_mfma_f32_16x16x32_bf16 v[120:123], v[32:35], v[132:135], 0
    ds_read_b64_tr_b16 v[28:29], v12 offset:5776
    v_mfma_f32_16x16x32_bf16 v[116:119], v[36:39], v[128:131], 0
    ds_read_b64_tr_b16 v[30:31], v12 offset:5952
    v_mfma_f32_16x16x32_bf16 v[124:127], v[36:39], v[132:135], 0
    ds_read_b128 v[168:171], v79 offset:64
    v_mfma_f32_16x16x32_bf16 v[240:243], v[160:163], v[128:131], 0
    v_mfma_f32_16x16x32_bf16 v[244:247], v[160:163], v[132:135], 0
    s_waitcnt lgkmcnt(9)
    s_barrier
    v_mfma_f32_16x16x32_bf16 v[80:83], v[40:43], v[136:139], v[80:83]
    ds_read_b128 v[144:147], v8 offset:16384
    ds_read_b128 v[148:151], v8 offset:18432
    v_mfma_f32_16x16x32_bf16 v[88:91], v[40:43], v[140:143], v[88:91]
    ds_read_b64_tr_b16 v[32:33], v12 offset:12288
    ds_read_b64_tr_b16 v[34:35], v12 offset:12464
    v_mfma_f32_16x16x32_bf16 v[84:87], v[44:47], v[136:139], v[84:87]
    ds_read_b64_tr_b16 v[36:37], v12 offset:12320
    v_mfma_f32_16x16x32_bf16 v[92:95], v[44:47], v[140:143], v[92:95]
    ds_read_b64_tr_b16 v[38:39], v12 offset:12496
    s_waitcnt lgkmcnt(11)
    v_mfma_f32_16x16x32_bf16 v[96:99], v[16:19], v[136:139], v[96:99]
    ds_read_b64_tr_b16 v[40:41], v12 offset:12344
    v_mfma_f32_16x16x32_bf16 v[104:107], v[16:19], v[140:143], v[104:107]
    ds_read_b64_tr_b16 v[42:43], v12 offset:12520
    v_mfma_f32_16x16x32_bf16 v[100:103], v[20:23], v[136:139], v[100:103]
    ds_read_b64_tr_b16 v[44:45], v12 offset:12376
    v_mfma_f32_16x16x32_bf16 v[108:111], v[20:23], v[140:143], v[108:111]
    ds_read_b64_tr_b16 v[46:47], v12 offset:12552
    s_waitcnt lgkmcnt(10)
    v_mfma_f32_16x16x32_bf16 v[112:115], v[24:27], v[136:139], v[112:115]
    ds_read_b64_tr_b16 v[16:17], v12 offset:12400
    ds_read_b64_tr_b16 v[18:19], v12 offset:12576
    v_mfma_f32_16x16x32_bf16 v[120:123], v[24:27], v[140:143], v[120:123]
    ds_read_b64_tr_b16 v[20:21], v12 offset:12432
    v_mfma_f32_16x16x32_bf16 v[116:119], v[28:31], v[136:139], v[116:119]
    ds_read_b64_tr_b16 v[22:23], v12 offset:12608
    v_mfma_f32_16x16x32_bf16 v[124:127], v[28:31], v[140:143], v[124:127]
    ds_read_b128 v[176:179], v79 offset:128
    v_mfma_f32_16x16x32_bf16 v[240:243], v[168:171], v[136:139], v[240:243]
    v_mfma_f32_16x16x32_bf16 v[244:247], v[168:171], v[140:143], v[244:247]
    s_waitcnt lgkmcnt(9)
    v_mfma_f32_16x16x32_bf16 v[80:83], v[32:35], v[144:147], v[80:83]
    ds_read_b128 v[152:155], v9 offset:16384
    ds_read_b128 v[156:159], v9 offset:18432
    v_mfma_f32_16x16x32_bf16 v[88:91], v[32:35], v[148:151], v[88:91]
    ds_read_b64_tr_b16 v[24:25], v12 offset:17920
    ds_read_b64_tr_b16 v[26:27], v12 offset:18096
    v_mfma_f32_16x16x32_bf16 v[84:87], v[36:39], v[144:147], v[84:87]
    ds_read_b64_tr_b16 v[28:29], v12 offset:17952
    v_mfma_f32_16x16x32_bf16 v[92:95], v[36:39], v[148:151], v[92:95]
    ds_read_b64_tr_b16 v[30:31], v12 offset:18128
    s_waitcnt lgkmcnt(11)
    v_mfma_f32_16x16x32_bf16 v[96:99], v[40:43], v[144:147], v[96:99]
    ds_read_b64_tr_b16 v[32:33], v12 offset:17976
    v_mfma_f32_16x16x32_bf16 v[104:107], v[40:43], v[148:151], v[104:107]
    ds_read_b64_tr_b16 v[34:35], v12 offset:18152
    v_mfma_f32_16x16x32_bf16 v[100:103], v[44:47], v[144:147], v[100:103]
    ds_read_b64_tr_b16 v[36:37], v12 offset:18008
    v_mfma_f32_16x16x32_bf16 v[108:111], v[44:47], v[148:151], v[108:111]
    ds_read_b64_tr_b16 v[38:39], v12 offset:18184
    s_waitcnt lgkmcnt(10)
    v_mfma_f32_16x16x32_bf16 v[112:115], v[16:19], v[144:147], v[112:115]
    ds_read_b64_tr_b16 v[40:41], v12 offset:18032
    ds_read_b64_tr_b16 v[42:43], v12 offset:18208
    v_mfma_f32_16x16x32_bf16 v[120:123], v[16:19], v[148:151], v[120:123]
    ds_read_b64_tr_b16 v[44:45], v12 offset:18064
    v_mfma_f32_16x16x32_bf16 v[116:119], v[20:23], v[144:147], v[116:119]
    ds_read_b64_tr_b16 v[46:47], v12 offset:18240
    v_mfma_f32_16x16x32_bf16 v[124:127], v[20:23], v[148:151], v[124:127]
    ds_read_b128 v[184:187], v79 offset:192
    v_mfma_f32_16x16x32_bf16 v[240:243], v[176:179], v[144:147], v[240:243]
    v_mfma_f32_16x16x32_bf16 v[244:247], v[176:179], v[148:151], v[244:247]
    s_waitcnt lgkmcnt(9)
    s_barrier
    v_mfma_f32_16x16x32_bf16 v[80:83], v[24:27], v[152:155], v[80:83]
    ds_read_b128 v[160:163], v8 offset:32768
    ds_read_b128 v[164:167], v8 offset:34816
    v_mfma_f32_16x16x32_bf16 v[88:91], v[24:27], v[156:159], v[88:91]
    ds_read_b64_tr_b16 v[16:17], v12 offset:24576
    ds_read_b64_tr_b16 v[18:19], v12 offset:24752
    v_mfma_f32_16x16x32_bf16 v[84:87], v[28:31], v[152:155], v[84:87]
    ds_read_b64_tr_b16 v[20:21], v12 offset:24608
    v_mfma_f32_16x16x32_bf16 v[92:95], v[28:31], v[156:159], v[92:95]
    ds_read_b64_tr_b16 v[22:23], v12 offset:24784
    s_waitcnt lgkmcnt(11)
    v_mfma_f32_16x16x32_bf16 v[96:99], v[32:35], v[152:155], v[96:99]
    ds_read_b64_tr_b16 v[24:25], v12 offset:24632
    v_mfma_f32_16x16x32_bf16 v[104:107], v[32:35], v[156:159], v[104:107]
    ds_read_b64_tr_b16 v[26:27], v12 offset:24808
    v_mfma_f32_16x16x32_bf16 v[100:103], v[36:39], v[152:155], v[100:103]
    ds_read_b64_tr_b16 v[28:29], v12 offset:24664
    v_mfma_f32_16x16x32_bf16 v[108:111], v[36:39], v[156:159], v[108:111]
    ds_read_b64_tr_b16 v[30:31], v12 offset:24840
    s_waitcnt lgkmcnt(10)
    v_mfma_f32_16x16x32_bf16 v[112:115], v[40:43], v[152:155], v[112:115]
    ds_read_b64_tr_b16 v[32:33], v12 offset:24688
    ds_read_b64_tr_b16 v[34:35], v12 offset:24864
    v_mfma_f32_16x16x32_bf16 v[120:123], v[40:43], v[156:159], v[120:123]
    ds_read_b64_tr_b16 v[36:37], v12 offset:24720
    v_mfma_f32_16x16x32_bf16 v[116:119], v[44:47], v[152:155], v[116:119]
    ds_read_b64_tr_b16 v[38:39], v12 offset:24896
    v_mfma_f32_16x16x32_bf16 v[124:127], v[44:47], v[156:159], v[124:127]
    ds_read_b128 v[192:195], v79 offset:256
    v_mfma_f32_16x16x32_bf16 v[240:243], v[184:187], v[152:155], v[240:243]
    v_mfma_f32_16x16x32_bf16 v[244:247], v[184:187], v[156:159], v[244:247]
    s_waitcnt lgkmcnt(9)
    v_mfma_f32_16x16x32_bf16 v[80:83], v[16:19], v[160:163], v[80:83]
    ds_read_b128 v[168:171], v9 offset:32768
    ds_read_b128 v[172:175], v9 offset:34816
    v_mfma_f32_16x16x32_bf16 v[88:91], v[16:19], v[164:167], v[88:91]
    ds_read_b64_tr_b16 v[40:41], v12 offset:30208
    ds_read_b64_tr_b16 v[42:43], v12 offset:30384
    v_mfma_f32_16x16x32_bf16 v[84:87], v[20:23], v[160:163], v[84:87]
    ds_read_b64_tr_b16 v[44:45], v12 offset:30240
    v_mfma_f32_16x16x32_bf16 v[92:95], v[20:23], v[164:167], v[92:95]
    ds_read_b64_tr_b16 v[46:47], v12 offset:30416
    s_waitcnt lgkmcnt(11)
    v_mfma_f32_16x16x32_bf16 v[96:99], v[24:27], v[160:163], v[96:99]
    ds_read_b64_tr_b16 v[16:17], v12 offset:30264
    v_mfma_f32_16x16x32_bf16 v[104:107], v[24:27], v[164:167], v[104:107]
    ds_read_b64_tr_b16 v[18:19], v12 offset:30440
    v_mfma_f32_16x16x32_bf16 v[100:103], v[28:31], v[160:163], v[100:103]
    ds_read_b64_tr_b16 v[20:21], v12 offset:30296
    v_mfma_f32_16x16x32_bf16 v[108:111], v[28:31], v[164:167], v[108:111]
    ds_read_b64_tr_b16 v[22:23], v12 offset:30472
    s_waitcnt lgkmcnt(10)
    v_mfma_f32_16x16x32_bf16 v[112:115], v[32:35], v[160:163], v[112:115]
    ds_read_b64_tr_b16 v[24:25], v12 offset:30320
    ds_read_b64_tr_b16 v[26:27], v12 offset:30496
    v_mfma_f32_16x16x32_bf16 v[120:123], v[32:35], v[164:167], v[120:123]
    ds_read_b64_tr_b16 v[28:29], v12 offset:30352
    v_mfma_f32_16x16x32_bf16 v[116:119], v[36:39], v[160:163], v[116:119]
    ds_read_b64_tr_b16 v[30:31], v12 offset:30528
    v_mfma_f32_16x16x32_bf16 v[124:127], v[36:39], v[164:167], v[124:127]
    ds_read_b128 v[200:203], v79 offset:320
    v_mfma_f32_16x16x32_bf16 v[240:243], v[192:195], v[160:163], v[240:243]
    v_mfma_f32_16x16x32_bf16 v[244:247], v[192:195], v[164:167], v[244:247]
    v_lshlrev_b32 v2, 3, v1
    v_mov_b32 v76, 0
    v_mov_b32 v77, 0
    s_add_u32 s46, s45, 2048
    s_mov_b64 exec, 0xffff
    buffer_store_dwordx2 v[76:77], v2, s[28:31], s45 offen sc1
    s_mov_b64 exec, -1
    s_mov_b64 exec, 0xffff
    buffer_store_dwordx2 v[76:77], v2, s[28:31], s46 offen sc1
    s_mov_b64 exec, -1
    s_waitcnt lgkmcnt(9)
    s_barrier
    v_mfma_f32_16x16x32_bf16 v[80:83], v[40:43], v[168:171], v[80:83]
    ds_read_b128 v[176:179], v8 offset:49152
    ds_read_b128 v[180:183], v8 offset:51200
    v_mfma_f32_16x16x32_bf16 v[88:91], v[40:43], v[172:175], v[88:91]
    ds_read_b64_tr_b16 v[32:33], v12 offset:36864
    ds_read_b64_tr_b16 v[34:35], v12 offset:37040
    v_mfma_f32_16x16x32_bf16 v[84:87], v[44:47], v[168:171], v[84:87]
    ds_read_b64_tr_b16 v[36:37], v12 offset:36896
    v_mfma_f32_16x16x32_bf16 v[92:95], v[44:47], v[172:175], v[92:95]
    ds_read_b64_tr_b16 v[38:39], v12 offset:37072
    s_waitcnt lgkmcnt(11)
    v_mfma_f32_16x16x32_bf16 v[96:99], v[16:19], v[168:171], v[96:99]
    ds_read_b64_tr_b16 v[40:41], v12 offset:36920
    v_mfma_f32_16x16x32_bf16 v[104:107], v[16:19], v[172:175], v[104:107]
    ds_read_b64_tr_b16 v[42:43], v12 offset:37096
    v_mfma_f32_16x16x32_bf16 v[100:103], v[20:23], v[168:171], v[100:103]
    ds_read_b64_tr_b16 v[44:45], v12 offset:36952
    v_mfma_f32_16x16x32_bf16 v[108:111], v[20:23], v[172:175], v[108:111]
    ds_read_b64_tr_b16 v[46:47], v12 offset:37128
    s_waitcnt lgkmcnt(10)
    v_mfma_f32_16x16x32_bf16 v[112:115], v[24:27], v[168:171], v[112:115]
    ds_read_b64_tr_b16 v[16:17], v12 offset:36976
    ds_read_b64_tr_b16 v[18:19], v12 offset:37152
    v_mfma_f32_16x16x32_bf16 v[120:123], v[24:27], v[172:175], v[120:123]
    ds_read_b64_tr_b16 v[20:21], v12 offset:37008
    v_mfma_f32_16x16x32_bf16 v[116:119], v[28:31], v[168:171], v[116:119]
    ds_read_b64_tr_b16 v[22:23], v12 offset:37184
    v_mfma_f32_16x16x32_bf16 v[124:127], v[28:31], v[172:175], v[124:127]
    ds_read_b128 v[208:211], v79 offset:384
    v_mfma_f32_16x16x32_bf16 v[240:243], v[200:203], v[168:171], v[240:243]
    v_mfma_f32_16x16x32_bf16 v[244:247], v[200:203], v[172:175], v[244:247]
    s_waitcnt lgkmcnt(9)
    v_mfma_f32_16x16x32_bf16 v[80:83], v[32:35], v[176:179], v[80:83]
    ds_read_b128 v[184:187], v9 offset:49152
    ds_read_b128 v[188:191], v9 offset:51200
    v_mfma_f32_16x16x32_bf16 v[88:91], v[32:35], v[180:183], v[88:91]
    ds_read_b64_tr_b16 v[24:25], v12 offset:42496
    ds_read_b64_tr_b16 v[26:27], v12 offset:42672
    v_mfma_f32_16x16x32_bf16 v[84:87], v[36:39], v[176:179], v[84:87]
    ds_read_b64_tr_b16 v[28:29], v12 offset:42528
    v_mfma_f32_16x16x32_bf16 v[92:95], v[36:39], v[180:183], v[92:95]
    ds_read_b64_tr_b16 v[30:31], v12 offset:42704
    s_waitcnt lgkmcnt(11)
    v_mfma_f32_16x16x32_bf16 v[96:99], v[40:43], v[176:179], v[96:99]
    ds_read_b64_tr_b16 v[32:33], v12 offset:42552
    v_mfma_f32_16x16x32_bf16 v[104:107], v[40:43], v[180:183], v[104:107]
    ds_read_b64_tr_b16 v[34:35], v12 offset:42728
    v_mfma_f32_16x16x32_bf16 v[100:103], v[44:47], v[176:179], v[100:103]
    ds_read_b64_tr_b16 v[36:37], v12 offset:42584
    v_mfma_f32_16x16x32_bf16 v[108:111], v[44:47], v[180:183], v[108:111]
    ds_read_b64_tr_b16 v[38:39], v12 offset:42760
    s_waitcnt lgkmcnt(10)
    v_mfma_f32_16x16x32_bf16 v[112:115], v[16:19], v[176:179], v[112:115]
    ds_read_b64_tr_b16 v[40:41], v12 offset:42608
    ds_read_b64_tr_b16 v[42:43], v12 offset:42784
    v_mfma_f32_16x16x32_bf16 v[120:123], v[16:19], v[180:183], v[120:123]
    ds_read_b64_tr_b16 v[44:45], v12 offset:42640
    v_mfma_f32_16x16x32_bf16 v[116:119], v[20:23], v[176:179], v[116:119]
    ds_read_b64_tr_b16 v[46:47], v12 offset:42816
    v_mfma_f32_16x16x32_bf16 v[124:127], v[20:23], v[180:183], v[124:127]
    ds_read_b128 v[216:219], v79 offset:448
    v_mfma_f32_16x16x32_bf16 v[240:243], v[208:211], v[176:179], v[240:243]
    v_mfma_f32_16x16x32_bf16 v[244:247], v[208:211], v[180:183], v[244:247]
    s_waitcnt lgkmcnt(9)
    s_barrier
    v_mfma_f32_16x16x32_bf16 v[80:83], v[24:27], v[184:187], v[80:83]
    ds_read_b128 v[192:195], v8 offset:0
    ds_read_b128 v[196:199], v8 offset:2048
    v_mfma_f32_16x16x32_bf16 v[88:91], v[24:27], v[188:191], v[88:91]
    ds_read_b64_tr_b16 v[16:17], v12 offset:49152
    ds_read_b64_tr_b16 v[18:19], v12 offset:49328
    v_mfma_f32_16x16x32_bf16 v[84:87], v[28:31], v[184:187], v[84:87]
    ds_read_b64_tr_b16 v[20:21], v12 offset:49184
    v_mfma_f32_16x16x32_bf16 v[92:95], v[28:31], v[188:191], v[92:95]
    ds_read_b64_tr_b16 v[22:23], v12 offset:49360
    s_waitcnt lgkmcnt(11)
    v_mfma_f32_16x16x32_bf16 v[96:99], v[32:35], v[184:187], v[96:99]
    ds_read_b64_tr_b16 v[24:25], v12 offset:49208
    v_mfma_f32_16x16x32_bf16 v[104:107], v[32:35], v[188:191], v[104:107]
    ds_read_b64_tr_b16 v[26:27], v12 offset:49384
    v_mfma_f32_16x16x32_bf16 v[100:103], v[36:39], v[184:187], v[100:103]
    ds_read_b64_tr_b16 v[28:29], v12 offset:49240
    v_mfma_f32_16x16x32_bf16 v[108:111], v[36:39], v[188:191], v[108:111]
    ds_read_b64_tr_b16 v[30:31], v12 offset:49416
    buffer_load_dwordx2 v[76:77], off, s[96:99], 0 sc1
    s_waitcnt lgkmcnt(10)
    v_mfma_f32_16x16x32_bf16 v[112:115], v[40:43], v[184:187], v[112:115]
    ds_read_b64_tr_b16 v[32:33], v12 offset:49264
    ds_read_b64_tr_b16 v[34:35], v12 offset:49440
    v_mfma_f32_16x16x32_bf16 v[120:123], v[40:43], v[188:191], v[120:123]
    ds_read_b64_tr_b16 v[36:37], v12 offset:49296
    v_mfma_f32_16x16x32_bf16 v[116:119], v[44:47], v[184:187], v[116:119]
    ds_read_b64_tr_b16 v[38:39], v12 offset:49472
    v_mfma_f32_16x16x32_bf16 v[124:127], v[44:47], v[188:191], v[124:127]
    ds_read_b128 v[224:227], v79 offset:512
    v_mfma_f32_16x16x32_bf16 v[240:243], v[216:219], v[184:187], v[240:243]
    v_mfma_f32_16x16x32_bf16 v[244:247], v[216:219], v[188:191], v[244:247]
    s_waitcnt lgkmcnt(9)
    v_mfma_f32_16x16x32_bf16 v[80:83], v[16:19], v[192:195], v[80:83]
    ds_read_b128 v[200:203], v9 offset:0
    ds_read_b128 v[204:207], v9 offset:2048
    v_mfma_f32_16x16x32_bf16 v[88:91], v[16:19], v[196:199], v[88:91]
    ds_read_b64_tr_b16 v[40:41], v12 offset:54784
    ds_read_b64_tr_b16 v[42:43], v12 offset:54960
    v_mfma_f32_16x16x32_bf16 v[84:87], v[20:23], v[192:195], v[84:87]
    ds_read_b64_tr_b16 v[44:45], v12 offset:54816
    v_mfma_f32_16x16x32_bf16 v[92:95], v[20:23], v[196:199], v[92:95]
    ds_read_b64_tr_b16 v[46:47], v12 offset:54992
    s_waitcnt lgkmcnt(11)
    v_mfma_f32_16x16x32_bf16 v[96:99], v[24:27], v[192:195], v[96:99]
    ds_read_b64_tr_b16 v[16:17], v12 offset:54840
    v_mfma_f32_16x16x32_bf16 v[104:107], v[24:27], v[196:199], v[104:107]
    ds_read_b64_tr_b16 v[18:19], v12 offset:55016
    v_mfma_f32_16x16x32_bf16 v[100:103], v[28:31], v[192:195], v[100:103]
    ds_read_b64_tr_b16 v[20:21], v12 offset:54872
    v_mfma_f32_16x16x32_bf16 v[108:111], v[28:31], v[196:199], v[108:111]
    ds_read_b64_tr_b16 v[22:23], v12 offset:55048
    s_waitcnt lgkmcnt(10)
    v_mfma_f32_16x16x32_bf16 v[112:115], v[32:35], v[192:195], v[112:115]
    ds_read_b64_tr_b16 v[24:25], v12 offset:54896
    ds_read_b64_tr_b16 v[26:27], v12 offset:55072
    v_mfma_f32_16x16x32_bf16 v[120:123], v[32:35], v[196:199], v[120:123]
    ds_read_b64_tr_b16 v[28:29], v12 offset:54928
    v_mfma_f32_16x16x32_bf16 v[116:119], v[36:39], v[192:195], v[116:119]
    ds_read_b64_tr_b16 v[30:31], v12 offset:55104
    v_mfma_f32_16x16x32_bf16 v[124:127], v[36:39], v[196:199], v[124:127]
    ds_read_b128 v[232:235], v79 offset:576
    v_mfma_f32_16x16x32_bf16 v[240:243], v[224:227], v[192:195], v[240:243]
    v_mfma_f32_16x16x32_bf16 v[244:247], v[224:227], v[196:199], v[244:247]
    s_waitcnt lgkmcnt(9)
    s_barrier
    v_mfma_f32_16x16x32_bf16 v[80:83], v[40:43], v[200:203], v[80:83]
    ds_read_b128 v[208:211], v8 offset:16384
    ds_read_b128 v[212:215], v8 offset:18432
    v_mfma_f32_16x16x32_bf16 v[88:91], v[40:43], v[204:207], v[88:91]
    ds_read_b64_tr_b16 v[32:33], v12 offset:0
    ds_read_b64_tr_b16 v[34:35], v12 offset:176
    v_mfma_f32_16x16x32_bf16 v[84:87], v[44:47], v[200:203], v[84:87]
    ds_read_b64_tr_b16 v[36:37], v12 offset:32
    v_mfma_f32_16x16x32_bf16 v[92:95], v[44:47], v[204:207], v[92:95]
    ds_read_b64_tr_b16 v[38:39], v12 offset:208
    s_waitcnt lgkmcnt(11)
    v_mfma_f32_16x16x32_bf16 v[96:99], v[16:19], v[200:203], v[96:99]
    ds_read_b64_tr_b16 v[40:41], v12 offset:56
    v_mfma_f32_16x16x32_bf16 v[104:107], v[16:19], v[204:207], v[104:107]
    ds_read_b64_tr_b16 v[42:43], v12 offset:232
    v_mfma_f32_16x16x32_bf16 v[100:103], v[20:23], v[200:203], v[100:103]
    ds_read_b64_tr_b16 v[44:45], v12 offset:88
    v_mfma_f32_16x16x32_bf16 v[108:111], v[20:23], v[204:207], v[108:111]
    ds_read_b64_tr_b16 v[46:47], v12 offset:264
    s_waitcnt lgkmcnt(10)
    v_mfma_f32_16x16x32_bf16 v[112:115], v[24:27], v[200:203], v[112:115]
    ds_read_b64_tr_b16 v[16:17], v12 offset:112
    v_mfma_f32_16x16x32_bf16 v[120:123], v[24:27], v[204:207], v[120:123]
    ds_read_b64_tr_b16 v[18:19], v12 offset:288
    v_mfma_f32_16x16x32_bf16 v[116:119], v[28:31], v[200:203], v[116:119]
    ds_read_b64_tr_b16 v[20:21], v12 offset:144
    v_mfma_f32_16x16x32_bf16 v[124:127], v[28:31], v[204:207], v[124:127]
    ds_read_b64_tr_b16 v[22:23], v12 offset:320
    v_mfma_f32_16x16x32_bf16 v[240:243], v[232:235], v[200:203], v[240:243]
    v_mfma_f32_16x16x32_bf16 v[244:247], v[232:235], v[204:207], v[244:247]
    s_waitcnt lgkmcnt(8)
    v_mfma_f32_16x16x32_bf16 v[80:83], v[32:35], v[208:211], v[80:83]
    ds_read_b128 v[216:219], v9 offset:16384
    ds_read_b128 v[220:223], v9 offset:18432
    v_mfma_f32_16x16x32_bf16 v[88:91], v[32:35], v[212:215], v[88:91]
    ds_read_b64_tr_b16 v[24:25], v12 offset:5632
    ds_read_b64_tr_b16 v[26:27], v12 offset:5808
    v_mfma_f32_16x16x32_bf16 v[84:87], v[36:39], v[208:211], v[84:87]
    ds_read_b64_tr_b16 v[28:29], v12 offset:5664
    v_mfma_f32_16x16x32_bf16 v[92:95], v[36:39], v[212:215], v[92:95]
    ds_read_b64_tr_b16 v[30:31], v12 offset:5840
    s_waitcnt lgkmcnt(10)
    v_mfma_f32_16x16x32_bf16 v[96:99], v[40:43], v[208:211], v[96:99]
    ds_read_b64_tr_b16 v[32:33], v12 offset:5688
    v_mfma_f32_16x16x32_bf16 v[104:107], v[40:43], v[212:215], v[104:107]
    ds_read_b64_tr_b16 v[34:35], v12 offset:5864
    v_mfma_f32_16x16x32_bf16 v[100:103], v[44:47], v[208:211], v[100:103]
    ds_read_b64_tr_b16 v[36:37], v12 offset:5720
    v_mfma_f32_16x16x32_bf16 v[108:111], v[44:47], v[212:215], v[108:111]
    ds_read_b64_tr_b16 v[38:39], v12 offset:5896
    s_waitcnt lgkmcnt(10)
    v_mfma_f32_16x16x32_bf16 v[112:115], v[16:19], v[208:211], v[112:115]
    ds_read_b64_tr_b16 v[40:41], v12 offset:5744
    v_mfma_f32_16x16x32_bf16 v[120:123], v[16:19], v[212:215], v[120:123]
    ds_read_b64_tr_b16 v[42:43], v12 offset:5920
    v_mfma_f32_16x16x32_bf16 v[116:119], v[20:23], v[208:211], v[116:119]
    ds_read_b64_tr_b16 v[44:45], v12 offset:5776
    v_mfma_f32_16x16x32_bf16 v[124:127], v[20:23], v[212:215], v[124:127]
    ds_read_b64_tr_b16 v[46:47], v12 offset:5952
    s_waitcnt lgkmcnt(8)
    s_barrier
    v_mfma_f32_16x16x32_bf16 v[80:83], v[24:27], v[216:219], v[80:83]
    ds_read_b128 v[224:227], v8 offset:32768
    ds_read_b128 v[228:231], v8 offset:34816
    v_mfma_f32_16x16x32_bf16 v[88:91], v[24:27], v[220:223], v[88:91]
    ds_read_b64_tr_b16 v[16:17], v12 offset:12288
    ds_read_b64_tr_b16 v[18:19], v12 offset:12464
    v_mfma_f32_16x16x32_bf16 v[84:87], v[28:31], v[216:219], v[84:87]
    ds_read_b64_tr_b16 v[20:21], v12 offset:12320
    v_mfma_f32_16x16x32_bf16 v[92:95], v[28:31], v[220:223], v[92:95]
    ds_read_b64_tr_b16 v[22:23], v12 offset:12496
    s_waitcnt lgkmcnt(10)
    v_mfma_f32_16x16x32_bf16 v[96:99], v[32:35], v[216:219], v[96:99]
    ds_read_b64_tr_b16 v[24:25], v12 offset:12344
    v_mfma_f32_16x16x32_bf16 v[104:107], v[32:35], v[220:223], v[104:107]
    ds_read_b64_tr_b16 v[26:27], v12 offset:12520
    v_mfma_f32_16x16x32_bf16 v[100:103], v[36:39], v[216:219], v[100:103]
    ds_read_b64_tr_b16 v[28:29], v12 offset:12376
    v_mfma_f32_16x16x32_bf16 v[108:111], v[36:39], v[220:223], v[108:111]
    ds_read_b64_tr_b16 v[30:31], v12 offset:12552
    s_waitcnt lgkmcnt(10)
    v_mfma_f32_16x16x32_bf16 v[112:115], v[40:43], v[216:219], v[112:115]
    ds_read_b64_tr_b16 v[32:33], v12 offset:12400
    v_mfma_f32_16x16x32_bf16 v[120:123], v[40:43], v[220:223], v[120:123]
    ds_read_b64_tr_b16 v[34:35], v12 offset:12576
    v_mfma_f32_16x16x32_bf16 v[116:119], v[44:47], v[216:219], v[116:119]
    ds_read_b64_tr_b16 v[36:37], v12 offset:12432
    v_mfma_f32_16x16x32_bf16 v[124:127], v[44:47], v[220:223], v[124:127]
    ds_read_b64_tr_b16 v[38:39], v12 offset:12608
    s_waitcnt lgkmcnt(8)
    v_mfma_f32_16x16x32_bf16 v[80:83], v[16:19], v[224:227], v[80:83]
    ds_read_b128 v[232:235], v9 offset:32768
    ds_read_b128 v[236:239], v9 offset:34816
    v_mfma_f32_16x16x32_bf16 v[88:91], v[16:19], v[228:231], v[88:91]
    ds_read_b64_tr_b16 v[40:41], v12 offset:17920
    ds_read_b64_tr_b16 v[42:43], v12 offset:18096
    v_mfma_f32_16x16x32_bf16 v[84:87], v[20:23], v[224:227], v[84:87]
    ds_read_b64_tr_b16 v[44:45], v12 offset:17952
    v_mfma_f32_16x16x32_bf16 v[92:95], v[20:23], v[228:231], v[92:95]
    ds_read_b64_tr_b16 v[46:47], v12 offset:18128
    s_waitcnt lgkmcnt(10)
    v_mfma_f32_16x16x32_bf16 v[96:99], v[24:27], v[224:227], v[96:99]
    ds_read_b64_tr_b16 v[16:17], v12 offset:17976
    v_mfma_f32_16x16x32_bf16 v[104:107], v[24:27], v[228:231], v[104:107]
    ds_read_b64_tr_b16 v[18:19], v12 offset:18152
    v_mfma_f32_16x16x32_bf16 v[100:103], v[28:31], v[224:227], v[100:103]
    ds_read_b64_tr_b16 v[20:21], v12 offset:18008
    v_mfma_f32_16x16x32_bf16 v[108:111], v[28:31], v[228:231], v[108:111]
    ds_read_b64_tr_b16 v[22:23], v12 offset:18184
    s_waitcnt lgkmcnt(10)
    v_mfma_f32_16x16x32_bf16 v[112:115], v[32:35], v[224:227], v[112:115]
    ds_read_b64_tr_b16 v[24:25], v12 offset:18032
    v_mfma_f32_16x16x32_bf16 v[120:123], v[32:35], v[228:231], v[120:123]
    ds_read_b64_tr_b16 v[26:27], v12 offset:18208
    v_mfma_f32_16x16x32_bf16 v[116:119], v[36:39], v[224:227], v[116:119]
    ds_read_b64_tr_b16 v[28:29], v12 offset:18064
    v_mfma_f32_16x16x32_bf16 v[124:127], v[36:39], v[228:231], v[124:127]
    ds_read_b64_tr_b16 v[30:31], v12 offset:18240
    s_waitcnt lgkmcnt(8)
    v_mfma_f32_16x16x32_bf16 v[80:83], v[40:43], v[232:235], v[80:83]
    v_mfma_f32_16x16x32_bf16 v[88:91], v[40:43], v[236:239], v[88:91]
    v_mfma_f32_16x16x32_bf16 v[84:87], v[44:47], v[232:235], v[84:87]
    v_mfma_f32_16x16x32_bf16 v[92:95], v[44:47], v[236:239], v[92:95]
    s_waitcnt lgkmcnt(4)
    v_mfma_f32_16x16x32_bf16 v[96:99], v[16:19], v[232:235], v[96:99]
    v_mfma_f32_16x16x32_bf16 v[104:107], v[16:19], v[236:239], v[104:107]
    v_mfma_f32_16x16x32_bf16 v[100:103], v[20:23], v[232:235], v[100:103]
    v_mfma_f32_16x16x32_bf16 v[108:111], v[20:23], v[236:239], v[108:111]
    s_nop 1
    s_waitcnt lgkmcnt(0)
    v_mfma_f32_16x16x32_bf16 v[112:115], v[24:27], v[232:235], v[112:115]
    v_mfma_f32_16x16x32_bf16 v[120:123], v[24:27], v[236:239], v[120:123]
    v_mfma_f32_16x16x32_bf16 v[116:119], v[28:31], v[232:235], v[116:119]
    v_mfma_f32_16x16x32_bf16 v[124:127], v[28:31], v[236:239], v[124:127]
    ds_read_b128 v[32:35], v79 offset:640
    ds_read_b128 v[36:39], v79 offset:704
    ds_read_b128 v[40:43], v79 offset:768
    ds_read_b128 v[44:47], v79 offset:832
    v_mul_f32 v80, s50, v80
    v_mul_f32 v81, s50, v81
    v_mul_f32 v82, s50, v82
    v_mul_f32 v83, s50, v83
    v_mul_f32 v84, s50, v84
    v_mul_f32 v85, s50, v85
    v_mul_f32 v86, s50, v86
    v_mul_f32 v87, s50, v87
    v_mul_f32 v88, s50, v88
    v_mul_f32 v89, s50, v89
    v_mul_f32 v90, s50, v90
    v_mul_f32 v91, s50, v91
    v_mul_f32 v92, s50, v92
    v_mul_f32 v93, s50, v93
    v_mul_f32 v94, s50, v94
    v_mul_f32 v95, s50, v95
    v_cvt_pk_bf16_f32 v52, v80, v81
    v_cvt_pk_bf16_f32 v53, v82, v83
    v_cvt_pk_bf16_f32 v56, v88, v89
    v_cvt_pk_bf16_f32 v57, v90, v91
    s_mov_b32 exec_hi, 0xffff
    v_cvt_pk_bf16_f32 v54, v84, v85
    v_cvt_pk_bf16_f32 v55, v86, v87
    v_cvt_pk_bf16_f32 v58, v92, v93
    v_cvt_pk_bf16_f32 v59, v94, v95
    s_mov_b32 exec_hi, -1
    buffer_store_dwordx4 v[52:55], v14, s[28:31], s54 offen sc1
    buffer_store_dwordx4 v[56:59], v14, s[28:31], s54 offen offset:256 sc1
    v_mul_f32 v96, s50, v96
    v_mul_f32 v97, s50, v97
    v_mul_f32 v98, s50, v98
    v_mul_f32 v99, s50, v99
    v_mul_f32 v100, s50, v100
    v_mul_f32 v101, s50, v101
    v_mul_f32 v102, s50, v102
    v_mul_f32 v103, s50, v103
    v_mul_f32 v104, s50, v104
    v_mul_f32 v105, s50, v105
    v_mul_f32 v106, s50, v106
    v_mul_f32 v107, s50, v107
    v_mul_f32 v108, s50, v108
    v_mul_f32 v109, s50, v109
    v_mul_f32 v110, s50, v110
    v_mul_f32 v111, s50, v111
    v_cvt_pk_bf16_f32 v60, v96, v97
    v_cvt_pk_bf16_f32 v61, v98, v99
    v_cvt_pk_bf16_f32 v64, v104, v105
    v_cvt_pk_bf16_f32 v65, v106, v107
    s_mov_b32 exec_hi, 0xffff
    v_cvt_pk_bf16_f32 v62, v100, v101
    v_cvt_pk_bf16_f32 v63, v102, v103
    v_cvt_pk_bf16_f32 v66, v108, v109
    v_cvt_pk_bf16_f32 v67, v110, v111
    s_mov_b32 exec_hi, -1
    buffer_store_dwordx4 v[60:63], v14, s[28:31], s55 offen sc1
    buffer_store_dwordx4 v[64:67], v14, s[28:31], s55 offen offset:256 sc1
    v_pk_mul_f32 v[112:113], v[112:113], s[50:51]
    v_pk_mul_f32 v[114:115], v[114:115], s[50:51]
    v_pk_mul_f32 v[116:117], v[116:117], s[50:51]
    v_pk_mul_f32 v[118:119], v[118:119], s[50:51]
    v_pk_mul_f32 v[120:121], v[120:121], s[50:51]
    v_pk_mul_f32 v[122:123], v[122:123], s[50:51]
    v_pk_mul_f32 v[124:125], v[124:125], s[50:51]
    v_pk_mul_f32 v[126:127], v[126:127], s[50:51]
    v_cvt_pk_bf16_f32 v68, v112, v113
    v_cvt_pk_bf16_f32 v69, v114, v115
    v_cvt_pk_bf16_f32 v72, v120, v121
    v_cvt_pk_bf16_f32 v73, v122, v123
    s_mov_b32 exec_hi, 0xffff
    v_cvt_pk_bf16_f32 v70, v116, v117
    v_cvt_pk_bf16_f32 v71, v118, v119
    v_cvt_pk_bf16_f32 v74, v124, v125
    v_cvt_pk_bf16_f32 v75, v126, v127
    s_mov_b32 exec_hi, -1
    buffer_store_dwordx4 v[68:71], v14, s[28:31], s17 offen sc1
    buffer_store_dwordx4 v[72:75], v14, s[28:31], s17 offen offset:256 sc1
    s_waitcnt lgkmcnt(0)
    v_mfma_f32_16x16x32_bf16 v[240:243], v[32:35], v[208:211], v[240:243]
    v_mfma_f32_16x16x32_bf16 v[244:247], v[32:35], v[212:215], v[244:247]
    v_mfma_f32_16x16x32_bf16 v[240:243], v[36:39], v[216:219], v[240:243]
    v_mfma_f32_16x16x32_bf16 v[244:247], v[36:39], v[220:223], v[244:247]
    v_mfma_f32_16x16x32_bf16 v[240:243], v[40:43], v[224:227], v[240:243]
    v_mfma_f32_16x16x32_bf16 v[244:247], v[40:43], v[228:231], v[244:247]
    v_mfma_f32_16x16x32_bf16 v[240:243], v[44:47], v[232:235], v[240:243]
    v_mfma_f32_16x16x32_bf16 v[244:247], v[44:47], v[236:239], v[244:247]
    s_barrier
    ds_read_b64_tr_b16 v[16:17], v6 offset:0
    ds_read_b64_tr_b16 v[18:19], v6 offset:176
    ds_read_b64_tr_b16 v[20:21], v6 offset:32
    ds_read_b64_tr_b16 v[22:23], v6 offset:208
    ds_read_b64_tr_b16 v[24:25], v6 offset:56
    ds_read_b64_tr_b16 v[26:27], v6 offset:232
    ds_read_b64_tr_b16 v[28:29], v6 offset:88
    ds_read_b64_tr_b16 v[30:31], v6 offset:264
    ds_read_b64_tr_b16 v[32:33], v6 offset:112
    ds_read_b64_tr_b16 v[34:35], v6 offset:288
    ds_read_b64_tr_b16 v[36:37], v6 offset:144
    ds_read_b64_tr_b16 v[38:39], v6 offset:320
    s_waitcnt lgkmcnt(8)
    v_mfma_f32_16x16x32_bf16 v[80:83], v[16:19], v[128:131], 0
    ds_read_b64_tr_b16 v[40:41], v6 offset:5632
    v_mfma_f32_16x16x32_bf16 v[88:91], v[16:19], v[132:135], 0
    ds_read_b64_tr_b16 v[42:43], v6 offset:5808
    v_mfma_f32_16x16x32_bf16 v[84:87], v[20:23], v[128:131], 0
    ds_read_b64_tr_b16 v[44:45], v6 offset:5664
    v_mfma_f32_16x16x32_bf16 v[92:95], v[20:23], v[132:135], 0
    ds_read_b64_tr_b16 v[46:47], v6 offset:5840
    s_waitcnt lgkmcnt(8)
    v_mfma_f32_16x16x32_bf16 v[96:99], v[24:27], v[128:131], 0
    ds_read_b64_tr_b16 v[16:17], v6 offset:5688
    v_mfma_f32_16x16x32_bf16 v[104:107], v[24:27], v[132:135], 0
    ds_read_b64_tr_b16 v[18:19], v6 offset:5864
    v_mfma_f32_16x16x32_bf16 v[100:103], v[28:31], v[128:131], 0
    ds_read_b64_tr_b16 v[20:21], v6 offset:5720
    v_mfma_f32_16x16x32_bf16 v[108:111], v[28:31], v[132:135], 0
    ds_read_b64_tr_b16 v[22:23], v6 offset:5896
    s_waitcnt lgkmcnt(8)
    v_mfma_f32_16x16x32_bf16 v[112:115], v[32:35], v[128:131], 0
    ds_read_b64_tr_b16 v[24:25], v6 offset:5744
    v_mfma_f32_16x16x32_bf16 v[120:123], v[32:35], v[132:135], 0
    ds_read_b64_tr_b16 v[26:27], v6 offset:5920
    v_mfma_f32_16x16x32_bf16 v[116:119], v[36:39], v[128:131], 0
    ds_read_b64_tr_b16 v[28:29], v6 offset:5776
    v_mfma_f32_16x16x32_bf16 v[124:127], v[36:39], v[132:135], 0
    ds_read_b64_tr_b16 v[30:31], v6 offset:5952
    s_waitcnt lgkmcnt(8)
    v_mfma_f32_16x16x32_bf16 v[80:83], v[40:43], v[136:139], v[80:83]
    ds_read_b64_tr_b16 v[32:33], v6 offset:12288
    v_mfma_f32_16x16x32_bf16 v[88:91], v[40:43], v[140:143], v[88:91]
    ds_read_b64_tr_b16 v[34:35], v6 offset:12464
    v_mfma_f32_16x16x32_bf16 v[84:87], v[44:47], v[136:139], v[84:87]
    ds_read_b64_tr_b16 v[36:37], v6 offset:12320
    v_mfma_f32_16x16x32_bf16 v[92:95], v[44:47], v[140:143], v[92:95]
    ds_read_b64_tr_b16 v[38:39], v6 offset:12496
    s_waitcnt lgkmcnt(8)
    v_mfma_f32_16x16x32_bf16 v[96:99], v[16:19], v[136:139], v[96:99]
    ds_read_b64_tr_b16 v[40:41], v6 offset:12344
    v_mfma_f32_16x16x32_bf16 v[104:107], v[16:19], v[140:143], v[104:107]
    ds_read_b64_tr_b16 v[42:43], v6 offset:12520
    v_mfma_f32_16x16x32_bf16 v[100:103], v[20:23], v[136:139], v[100:103]
    ds_read_b64_tr_b16 v[44:45], v6 offset:12376
    v_mfma_f32_16x16x32_bf16 v[108:111], v[20:23], v[140:143], v[108:111]
    ds_read_b64_tr_b16 v[46:47], v6 offset:12552
    s_waitcnt lgkmcnt(8)
    v_mfma_f32_16x16x32_bf16 v[112:115], v[24:27], v[136:139], v[112:115]
    ds_read_b64_tr_b16 v[16:17], v6 offset:12400
    v_mfma_f32_16x16x32_bf16 v[120:123], v[24:27], v[140:143], v[120:123]
    ds_read_b64_tr_b16 v[18:19], v6 offset:12576
    v_mfma_f32_16x16x32_bf16 v[116:119], v[28:31], v[136:139], v[116:119]
    ds_read_b64_tr_b16 v[20:21], v6 offset:12432
    v_mfma_f32_16x16x32_bf16 v[124:127], v[28:31], v[140:143], v[124:127]
    ds_read_b64_tr_b16 v[22:23], v6 offset:12608
    s_waitcnt lgkmcnt(8)
    v_mfma_f32_16x16x32_bf16 v[80:83], v[32:35], v[144:147], v[80:83]
    ds_read_b64_tr_b16 v[24:25], v6 offset:17920
    v_mfma_f32_16x16x32_bf16 v[88:91], v[32:35], v[148:151], v[88:91]
    ds_read_b64_tr_b16 v[26:27], v6 offset:18096
    v_mfma_f32_16x16x32_bf16 v[84:87], v[36:39], v[144:147], v[84:87]
    ds_read_b64_tr_b16 v[28:29], v6 offset:17952
    v_mfma_f32_16x16x32_bf16 v[92:95], v[36:39], v[148:151], v[92:95]
    ds_read_b64_tr_b16 v[30:31], v6 offset:18128
    s_waitcnt lgkmcnt(8)
    v_mfma_f32_16x16x32_bf16 v[96:99], v[40:43], v[144:147], v[96:99]
    ds_read_b64_tr_b16 v[32:33], v6 offset:17976
    v_mfma_f32_16x16x32_bf16 v[104:107], v[40:43], v[148:151], v[104:107]
    ds_read_b64_tr_b16 v[34:35], v6 offset:18152
    v_mfma_f32_16x16x32_bf16 v[100:103], v[44:47], v[144:147], v[100:103]
    ds_read_b64_tr_b16 v[36:37], v6 offset:18008
    v_mfma_f32_16x16x32_bf16 v[108:111], v[44:47], v[148:151], v[108:111]
    ds_read_b64_tr_b16 v[38:39], v6 offset:18184
    s_waitcnt lgkmcnt(8)
    v_mfma_f32_16x16x32_bf16 v[112:115], v[16:19], v[144:147], v[112:115]
    ds_read_b64_tr_b16 v[40:41], v6 offset:18032
    v_mfma_f32_16x16x32_bf16 v[120:123], v[16:19], v[148:151], v[120:123]
    ds_read_b64_tr_b16 v[42:43], v6 offset:18208
    v_mfma_f32_16x16x32_bf16 v[116:119], v[20:23], v[144:147], v[116:119]
    ds_read_b64_tr_b16 v[44:45], v6 offset:18064
    v_mfma_f32_16x16x32_bf16 v[124:127], v[20:23], v[148:151], v[124:127]
    ds_read_b64_tr_b16 v[46:47], v6 offset:18240
    s_waitcnt vmcnt(0)
    s_mov_b32 s61, 65536
go_a_lp_57:
    v_cmp_eq_u32 vcc, 0, v76
    s_sub_u32 s61, s61, 1
    s_cselect_b64 vcc, 0, vcc
    s_cbranch_vccz go_a_ok_56
    s_sleep 8
    buffer_load_dwordx2 v[76:77], off, s[96:99], 0 sc1
    s_waitcnt vmcnt(0)
    s_branch go_a_lp_57
go_a_ok_56:
    v_readfirstlane_b32 s100, v76
    v_readfirstlane_b32 s101, v77
    s_nop 1
    v_lshlrev_b32 v2, 3, v1
    v_mov_b32 v76, s100
    v_mov_b32 v77, s101
    s_mov_b64 exec, 0xffff
    buffer_store_dwordx2 v[76:77], v2, s[28:31], s52 offen sc1
    s_mov_b64 exec, -1
    s_waitcnt lgkmcnt(8)
    v_mfma_f32_16x16x32_bf16 v[80:83], v[24:27], v[152:155], v[80:83]
    ds_read_b64_tr_b16 v[16:17], v13 offset:24576
    v_mfma_f32_16x16x32_bf16 v[88:91], v[24:27], v[156:159], v[88:91]
    ds_read_b64_tr_b16 v[18:19], v13 offset:24752
    v_mfma_f32_16x16x32_bf16 v[84:87], v[28:31], v[152:155], v[84:87]
    ds_read_b64_tr_b16 v[20:21], v13 offset:24608
    v_mfma_f32_16x16x32_bf16 v[92:95], v[28:31], v[156:159], v[92:95]
    ds_read_b64_tr_b16 v[22:23], v13 offset:24784
    s_waitcnt lgkmcnt(8)
    v_mfma_f32_16x16x32_bf16 v[96:99], v[32:35], v[152:155], v[96:99]
    ds_read_b64_tr_b16 v[24:25], v13 offset:24632
    v_mfma_f32_16x16x32_bf16 v[104:107], v[32:35], v[156:159], v[104:107]
    ds_read_b64_tr_b16 v[26:27], v13 offset:24808
    v_mfma_f32_16x16x32_bf16 v[100:103], v[36:39], v[152:155], v[100:103]
    ds_read_b64_tr_b16 v[28:29], v13 offset:24664
    v_mfma_f32_16x16x32_bf16 v[108:111], v[36:39], v[156:159], v[108:111]
    ds_read_b64_tr_b16 v[30:31], v13 offset:24840
    s_waitcnt lgkmcnt(8)
    v_mfma_f32_16x16x32_bf16 v[112:115], v[40:43], v[152:155], v[112:115]
    ds_read_b64_tr_b16 v[32:33], v13 offset:24688
    v_mfma_f32_16x16x32_bf16 v[120:123], v[40:43], v[156:159], v[120:123]
    ds_read_b64_tr_b16 v[34:35], v13 offset:24864
    v_mfma_f32_16x16x32_bf16 v[116:119], v[44:47], v[152:155], v[116:119]
    ds_read_b64_tr_b16 v[36:37], v13 offset:24720
    v_mfma_f32_16x16x32_bf16 v[124:127], v[44:47], v[156:159], v[124:127]
    ds_read_b64_tr_b16 v[38:39], v13 offset:24896
    s_waitcnt lgkmcnt(8)
    v_mfma_f32_16x16x32_bf16 v[80:83], v[16:19], v[160:163], v[80:83]
    ds_read_b64_tr_b16 v[40:41], v13 offset:30208
    v_mfma_f32_16x16x32_bf16 v[88:91], v[16:19], v[164:167], v[88:91]
    ds_read_b64_tr_b16 v[42:43], v13 offset:30384
    v_mfma_f32_16x16x32_bf16 v[84:87], v[20:23], v[160:163], v[84:87]
    ds_read_b64_tr_b16 v[44:45], v13 offset:30240
    v_mfma_f32_16x16x32_bf16 v[92:95], v[20:23], v[164:167], v[92:95]
    ds_read_b64_tr_b16 v[46:47], v13 offset:30416
    s_waitcnt lgkmcnt(8)
    v_mfma_f32_16x16x32_bf16 v[96:99], v[24:27], v[160:163], v[96:99]
    ds_read_b64_tr_b16 v[16:17], v13 offset:30264
    v_mfma_f32_16x16x32_bf16 v[104:107], v[24:27], v[164:167], v[104:107]
    ds_read_b64_tr_b16 v[18:19], v13 offset:30440
    v_mfma_f32_16x16x32_bf16 v[100:103], v[28:31], v[160:163], v[100:103]
    ds_read_b64_tr_b16 v[20:21], v13 offset:30296
    v_mfma_f32_16x16x32_bf16 v[108:111], v[28:31], v[164:167], v[108:111]
    ds_read_b64_tr_b16 v[22:23], v13 offset:30472
    s_waitcnt lgkmcnt(8)
    v_mfma_f32_16x16x32_bf16 v[112:115], v[32:35], v[160:163], v[112:115]
    ds_read_b64_tr_b16 v[24:25], v13 offset:30320
    v_mfma_f32_16x16x32_bf16 v[120:123], v[32:35], v[164:167], v[120:123]
    ds_read_b64_tr_b16 v[26:27], v13 offset:30496
    v_mfma_f32_16x16x32_bf16 v[116:119], v[36:39], v[160:163], v[116:119]
    ds_read_b64_tr_b16 v[28:29], v13 offset:30352
    v_mfma_f32_16x16x32_bf16 v[124:127], v[36:39], v[164:167], v[124:127]
    ds_read_b64_tr_b16 v[30:31], v13 offset:30528
    s_waitcnt lgkmcnt(8)
    s_barrier
    v_mfma_f32_16x16x32_bf16 v[80:83], v[40:43], v[168:171], v[80:83]
    ds_read_b64_tr_b16 v[32:33], v5 offset:0
    v_mfma_f32_16x16x32_bf16 v[88:91], v[40:43], v[172:175], v[88:91]
    ds_read_b64_tr_b16 v[34:35], v5 offset:176
    v_mfma_f32_16x16x32_bf16 v[84:87], v[44:47], v[168:171], v[84:87]
    ds_read_b64_tr_b16 v[36:37], v5 offset:32
    v_mfma_f32_16x16x32_bf16 v[92:95], v[44:47], v[172:175], v[92:95]
    ds_read_b64_tr_b16 v[38:39], v5 offset:208
    s_waitcnt lgkmcnt(8)
    v_mfma_f32_16x16x32_bf16 v[96:99], v[16:19], v[168:171], v[96:99]
    ds_read_b64_tr_b16 v[40:41], v5 offset:56
    v_mfma_f32_16x16x32_bf16 v[104:107], v[16:19], v[172:175], v[104:107]
    ds_read_b64_tr_b16 v[42:43], v5 offset:232
    v_mfma_f32_16x16x32_bf16 v[100:103], v[20:23], v[168:171], v[100:103]
    ds_read_b64_tr_b16 v[44:45], v5 offset:88
    v_mfma_f32_16x16x32_bf16 v[108:111], v[20:23], v[172:175], v[108:111]
    ds_read_b64_tr_b16 v[46:47], v5 offset:264
    s_waitcnt lgkmcnt(8)
    v_mfma_f32_16x16x32_bf16 v[112:115], v[24:27], v[168:171], v[112:115]
    ds_read_b64_tr_b16 v[16:17], v5 offset:112
    v_mfma_f32_16x16x32_bf16 v[120:123], v[24:27], v[172:175], v[120:123]
    ds_read_b64_tr_b16 v[18:19], v5 offset:288
    v_mfma_f32_16x16x32_bf16 v[116:119], v[28:31], v[168:171], v[116:119]
    ds_read_b64_tr_b16 v[20:21], v5 offset:144
    v_mfma_f32_16x16x32_bf16 v[124:127], v[28:31], v[172:175], v[124:127]
    ds_read_b64_tr_b16 v[22:23], v5 offset:320
    s_waitcnt lgkmcnt(8)
    v_mfma_f32_16x16x32_bf16 v[80:83], v[32:35], v[176:179], v[80:83]
    ds_read_b64_tr_b16 v[24:25], v5 offset:5632
    v_mfma_f32_16x16x32_bf16 v[88:91], v[32:35], v[180:183], v[88:91]
    ds_read_b64_tr_b16 v[26:27], v5 offset:5808
    v_mfma_f32_16x16x32_bf16 v[84:87], v[36:39], v[176:179], v[84:87]
    ds_read_b64_tr_b16 v[28:29], v5 offset:5664
    v_mfma_f32_16x16x32_bf16 v[92:95], v[36:39], v[180:183], v[92:95]
    ds_read_b64_tr_b16 v[30:31], v5 offset:5840
    s_waitcnt lgkmcnt(8)
    v_mfma_f32_16x16x32_bf16 v[96:99], v[40:43], v[176:179], v[96:99]
    ds_read_b64_tr_b16 v[32:33], v5 offset:5688
    v_mfma_f32_16x16x32_bf16 v[104:107], v[40:43], v[180:183], v[104:107]
    ds_read_b64_tr_b16 v[34:35], v5 offset:5864
    v_mfma_f32_16x16x32_bf16 v[100:103], v[44:47], v[176:179], v[100:103]
    ds_read_b64_tr_b16 v[36:37], v5 offset:5720
    v_mfma_f32_16x16x32_bf16 v[108:111], v[44:47], v[180:183], v[108:111]
    ds_read_b64_tr_b16 v[38:39], v5 offset:5896
    s_waitcnt lgkmcnt(8)
    v_mfma_f32_16x16x32_bf16 v[112:115], v[16:19], v[176:179], v[112:115]
    ds_read_b64_tr_b16 v[40:41], v5 offset:5744
    v_mfma_f32_16x16x32_bf16 v[120:123], v[16:19], v[180:183], v[120:123]
    ds_read_b64_tr_b16 v[42:43], v5 offset:5920
    v_mfma_f32_16x16x32_bf16 v[116:119], v[20:23], v[176:179], v[116:119]
    ds_read_b64_tr_b16 v[44:45], v5 offset:5776
    v_mfma_f32_16x16x32_bf16 v[124:127], v[20:23], v[180:183], v[124:127]
    ds_read_b64_tr_b16 v[46:47], v5 offset:5952
    s_waitcnt lgkmcnt(8)
    v_mfma_f32_16x16x32_bf16 v[80:83], v[24:27], v[184:187], v[80:83]
    ds_read_b64_tr_b16 v[16:17], v13 offset:36864
    v_mfma_f32_16x16x32_bf16 v[88:91], v[24:27], v[188:191], v[88:91]
    ds_read_b64_tr_b16 v[18:19], v13 offset:37040
    v_mfma_f32_16x16x32_bf16 v[84:87], v[28:31], v[184:187], v[84:87]
    ds_read_b64_tr_b16 v[20:21], v13 offset:36896
    v_mfma_f32_16x16x32_bf16 v[92:95], v[28:31], v[188:191], v[92:95]
    ds_read_b64_tr_b16 v[22:23], v13 offset:37072
    s_waitcnt lgkmcnt(8)
    v_mfma_f32_16x16x32_bf16 v[96:99], v[32:35], v[184:187], v[96:99]
    ds_read_b64_tr_b16 v[24:25], v13 offset:36920
    v_mfma_f32_16x16x32_bf16 v[104:107], v[32:35], v[188:191], v[104:107]
    ds_read_b64_tr_b16 v[26:27], v13 offset:37096
    v_mfma_f32_16x16x32_bf16 v[100:103], v[36:39], v[184:187], v[100:103]
    ds_read_b64_tr_b16 v[28:29], v13 offset:36952
    v_mfma_f32_16x16x32_bf16 v[108:111], v[36:39], v[188:191], v[108:111]
    ds_read_b64_tr_b16 v[30:31], v13 offset:37128
    s_waitcnt lgkmcnt(8)
    v_mfma_f32_16x16x32_bf16 v[112:115], v[40:43], v[184:187], v[112:115]
    ds_read_b64_tr_b16 v[32:33], v13 offset:36976
    v_mfma_f32_16x16x32_bf16 v[120:123], v[40:43], v[188:191], v[120:123]
    ds_read_b64_tr_b16 v[34:35], v13 offset:37152
    v_mfma_f32_16x16x32_bf16 v[116:119], v[44:47], v[184:187], v[116:119]
    ds_read_b64_tr_b16 v[36:37], v13 offset:37008
    v_mfma_f32_16x16x32_bf16 v[124:127], v[44:47], v[188:191], v[124:127]
    ds_read_b64_tr_b16 v[38:39], v13 offset:37184
    s_waitcnt lgkmcnt(8)
    v_mfma_f32_16x16x32_bf16 v[80:83], v[16:19], v[192:195], v[80:83]
    ds_read_b64_tr_b16 v[40:41], v13 offset:42496
    v_mfma_f32_16x16x32_bf16 v[88:91], v[16:19], v[196:199], v[88:91]
    ds_read_b64_tr_b16 v[42:43], v13 offset:42672
    v_mfma_f32_16x16x32_bf16 v[84:87], v[20:23], v[192:195], v[84:87]
    ds_read_b64_tr_b16 v[44:45], v13 offset:42528
    v_mfma_f32_16x16x32_bf16 v[92:95], v[20:23], v[196:199], v[92:95]
    ds_read_b64_tr_b16 v[46:47], v13 offset:42704
    s_waitcnt lgkmcnt(8)
    v_mfma_f32_16x16x32_bf16 v[96:99], v[24:27], v[192:195], v[96:99]
    ds_read_b64_tr_b16 v[16:17], v13 offset:42552
    v_mfma_f32_16x16x32_bf16 v[104:107], v[24:27], v[196:199], v[104:107]
    ds_read_b64_tr_b16 v[18:19], v13 offset:42728
    v_mfma_f32_16x16x32_bf16 v[100:103], v[28:31], v[192:195], v[100:103]
    ds_read_b64_tr_b16 v[20:21], v13 offset:42584
    v_mfma_f32_16x16x32_bf16 v[108:111], v[28:31], v[196:199], v[108:111]
    ds_read_b64_tr_b16 v[22:23], v13 offset:42760
    s_waitcnt lgkmcnt(8)
    v_mfma_f32_16x16x32_bf16 v[112:115], v[32:35], v[192:195], v[112:115]
    ds_read_b64_tr_b16 v[24:25], v13 offset:42608
    v_mfma_f32_16x16x32_bf16 v[120:123], v[32:35], v[196:199], v[120:123]
    ds_read_b64_tr_b16 v[26:27], v13 offset:42784
    v_mfma_f32_16x16x32_bf16 v[116:119], v[36:39], v[192:195], v[116:119]
    ds_read_b64_tr_b16 v[28:29], v13 offset:42640
    v_mfma_f32_16x16x32_bf16 v[124:127], v[36:39], v[196:199], v[124:127]
    ds_read_b64_tr_b16 v[30:31], v13 offset:42816
    s_waitcnt lgkmcnt(8)
    s_barrier
    v_mfma_f32_16x16x32_bf16 v[80:83], v[40:43], v[200:203], v[80:83]
    ds_read_b64_tr_b16 v[32:33], v5 offset:32768
    v_mfma_f32_16x16x32_bf16 v[88:91], v[40:43], v[204:207], v[88:91]
    ds_read_b64_tr_b16 v[34:35], v5 offset:32944
    v_mfma_f32_16x16x32_bf16 v[84:87], v[44:47], v[200:203], v[84:87]
    ds_read_b64_tr_b16 v[36:37], v5 offset:32800
    v_mfma_f32_16x16x32_bf16 v[92:95], v[44:47], v[204:207], v[92:95]
    ds_read_b64_tr_b16 v[38:39], v5 offset:32976
    s_waitcnt lgkmcnt(8)
    v_mfma_f32_16x16x32_bf16 v[96:99], v[16:19], v[200:203], v[96:99]
    ds_read_b64_tr_b16 v[40:41], v5 offset:32824
    v_mfma_f32_16x16x32_bf16 v[104:107], v[16:19], v[204:207], v[104:107]
    ds_read_b64_tr_b16 v[42:43], v5 offset:33000
    v_mfma_f32_16x16x32_bf16 v[100:103], v[20:23], v[200:203], v[100:103]
    ds_read_b64_tr_b16 v[44:45], v5 offset:32856
    v_mfma_f32_16x16x32_bf16 v[108:111], v[20:23], v[204:207], v[108:111]
    ds_read_b64_tr_b16 v[46:47], v5 offset:33032
    s_waitcnt lgkmcnt(8)
    v_mfma_f32_16x16x32_bf16 v[112:115], v[24:27], v[200:203], v[112:115]
    ds_read_b64_tr_b16 v[16:17], v5 offset:32880
    v_mfma_f32_16x16x32_bf16 v[120:123], v[24:27], v[204:207], v[120:123]
    ds_read_b64_tr_b16 v[18:19], v5 offset:33056
    v_mfma_f32_16x16x32_bf16 v[116:119], v[28:31], v[200:203], v[116:119]
    ds_read_b64_tr_b16 v[20:21], v5 offset:32912
    v_mfma_f32_16x16x32_bf16 v[124:127], v[28:31], v[204:207], v[124:127]
    ds_read_b64_tr_b16 v[22:23], v5 offset:33088
    s_waitcnt lgkmcnt(8)
    v_mfma_f32_16x16x32_bf16 v[80:83], v[32:35], v[208:211], v[80:83]
    ds_read_b64_tr_b16 v[24:25], v5 offset:38400
    v_mfma_f32_16x16x32_bf16 v[88:91], v[32:35], v[212:215], v[88:91]
    ds_read_b64_tr_b16 v[26:27], v5 offset:38576
    v_mfma_f32_16x16x32_bf16 v[84:87], v[36:39], v[208:211], v[84:87]
    ds_read_b64_tr_b16 v[28:29], v5 offset:38432
    v_mfma_f32_16x16x32_bf16 v[92:95], v[36:39], v[212:215], v[92:95]
    ds_read_b64_tr_b16 v[30:31], v5 offset:38608
    s_waitcnt lgkmcnt(8)
    v_mfma_f32_16x16x32_bf16 v[96:99], v[40:43], v[208:211], v[96:99]
    ds_read_b64_tr_b16 v[32:33], v5 offset:38456
    v_mfma_f32_16x16x32_bf16 v[104:107], v[40:43], v[212:215], v[104:107]
    ds_read_b64_tr_b16 v[34:35], v5 offset:38632
    v_mfma_f32_16x16x32_bf16 v[100:103], v[44:47], v[208:211], v[100:103]
    ds_read_b64_tr_b16 v[36:37], v5 offset:38488
    v_mfma_f32_16x16x32_bf16 v[108:111], v[44:47], v[212:215], v[108:111]
    ds_read_b64_tr_b16 v[38:39], v5 offset:38664
    s_waitcnt lgkmcnt(8)
    v_mfma_f32_16x16x32_bf16 v[112:115], v[16:19], v[208:211], v[112:115]
    ds_read_b64_tr_b16 v[40:41], v5 offset:38512
    v_mfma_f32_16x16x32_bf16 v[120:123], v[16:19], v[212:215], v[120:123]
    ds_read_b64_tr_b16 v[42:43], v5 offset:38688
    v_mfma_f32_16x16x32_bf16 v[116:119], v[20:23], v[208:211], v[116:119]
    ds_read_b64_tr_b16 v[44:45], v5 offset:38544
    v_mfma_f32_16x16x32_bf16 v[124:127], v[20:23], v[212:215], v[124:127]
    ds_read_b64_tr_b16 v[46:47], v5 offset:38720
    s_waitcnt lgkmcnt(8)
    v_mfma_f32_16x16x32_bf16 v[80:83], v[24:27], v[216:219], v[80:83]
    ds_read_b64_tr_b16 v[16:17], v13 offset:49152
    v_mfma_f32_16x16x32_bf16 v[88:91], v[24:27], v[220:223], v[88:91]
    ds_read_b64_tr_b16 v[18:19], v13 offset:49328
    v_mfma_f32_16x16x32_bf16 v[84:87], v[28:31], v[216:219], v[84:87]
    ds_read_b64_tr_b16 v[20:21], v13 offset:49184
    v_mfma_f32_16x16x32_bf16 v[92:95], v[28:31], v[220:223], v[92:95]
    ds_read_b64_tr_b16 v[22:23], v13 offset:49360
    s_waitcnt lgkmcnt(8)
    v_mfma_f32_16x16x32_bf16 v[96:99], v[32:35], v[216:219], v[96:99]
    ds_read_b64_tr_b16 v[24:25], v13 offset:49208
    v_mfma_f32_16x16x32_bf16 v[104:107], v[32:35], v[220:223], v[104:107]
    ds_read_b64_tr_b16 v[26:27], v13 offset:49384
    v_mfma_f32_16x16x32_bf16 v[100:103], v[36:39], v[216:219], v[100:103]
    ds_read_b64_tr_b16 v[28:29], v13 offset:49240
    v_mfma_f32_16x16x32_bf16 v[108:111], v[36:39], v[220:223], v[108:111]
    ds_read_b64_tr_b16 v[30:31], v13 offset:49416
    s_waitcnt lgkmcnt(8)
    v_mfma_f32_16x16x32_bf16 v[112:115], v[40:43], v[216:219], v[112:115]
    ds_read_b64_tr_b16 v[32:33], v13 offset:49264
    v_mfma_f32_16x16x32_bf16 v[120:123], v[40:43], v[220:223], v[120:123]
    ds_read_b64_tr_b16 v[34:35], v13 offset:49440
    v_mfma_f32_16x16x32_bf16 v[116:119], v[44:47], v[216:219], v[116:119]
    ds_read_b64_tr_b16 v[36:37], v13 offset:49296
    v_mfma_f32_16x16x32_bf16 v[124:127], v[44:47], v[220:223], v[124:127]
    ds_read_b64_tr_b16 v[38:39], v13 offset:49472
    s_waitcnt lgkmcnt(8)
    v_mfma_f32_16x16x32_bf16 v[80:83], v[16:19], v[224:227], v[80:83]
    ds_read_b64_tr_b16 v[40:41], v13 offset:54784
    v_mfma_f32_16x16x32_bf16 v[88:91], v[16:19], v[228:231], v[88:91]
    ds_read_b64_tr_b16 v[42:43], v13 offset:54960
    v_mfma_f32_16x16x32_bf16 v[84:87], v[20:23], v[224:227], v[84:87]
    ds_read_b64_tr_b16 v[44:45], v13 offset:54816
    v_mfma_f32_16x16x32_bf16 v[92:95], v[20:23], v[228:231], v[92:95]
    ds_read_b64_tr_b16 v[46:47], v13 offset:54992
    s_waitcnt lgkmcnt(8)
    v_mfma_f32_16x16x32_bf16 v[96:99], v[24:27], v[224:227], v[96:99]
    ds_read_b64_tr_b16 v[16:17], v13 offset:54840
    v_mfma_f32_16x16x32_bf16 v[104:107], v[24:27], v[228:231], v[104:107]
    ds_read_b64_tr_b16 v[18:19], v13 offset:55016
    v_mfma_f32_16x16x32_bf16 v[100:103], v[28:31], v[224:227], v[100:103]
    ds_read_b64_tr_b16 v[20:21], v13 offset:54872
    v_mfma_f32_16x16x32_bf16 v[108:111], v[28:31], v[228:231], v[108:111]
    ds_read_b64_tr_b16 v[22:23], v13 offset:55048
    v_mov_b32 v194, 0
    v_mov_b32 v195, 0
    v_mov_b32 v198, 0
    v_mov_b32 v199, 0
    v_mov_b32 v202, 0
    v_mov_b32 v203, 0
    v_mov_b32 v206, 0
    v_mov_b32 v207, 0
    v_mov_b32 v210, 0
    v_mov_b32 v211, 0
    v_mov_b32 v214, 0
    v_mov_b32 v215, 0
    s_waitcnt lgkmcnt(8)
    v_mfma_f32_16x16x32_bf16 v[112:115], v[32:35], v[224:227], v[112:115]
    ds_read_b64_tr_b16 v[24:25], v13 offset:54896
    v_mfma_f32_16x16x32_bf16 v[120:123], v[32:35], v[228:231], v[120:123]
    ds_read_b64_tr_b16 v[26:27], v13 offset:55072
    v_mfma_f32_16x16x32_bf16 v[116:119], v[36:39], v[224:227], v[116:119]
    ds_read_b64_tr_b16 v[28:29], v13 offset:54928
    v_mfma_f32_16x16x32_bf16 v[124:127], v[36:39], v[228:231], v[124:127]
    ds_read_b64_tr_b16 v[30:31], v13 offset:55104
    s_waitcnt lgkmcnt(8)
    v_mfma_f32_16x16x32_bf16 v[80:83], v[40:43], v[232:235], v[80:83]
    v_mfma_f32_16x16x32_bf16 v[88:91], v[40:43], v[236:239], v[88:91]
    v_mfma_f32_16x16x32_bf16 v[84:87], v[44:47], v[232:235], v[84:87]
    v_mfma_f32_16x16x32_bf16 v[92:95], v[44:47], v[236:239], v[92:95]
    s_waitcnt lgkmcnt(4)
    v_mfma_f32_16x16x32_bf16 v[96:99], v[16:19], v[232:235], v[96:99]
    v_mfma_f32_16x16x32_bf16 v[104:107], v[16:19], v[236:239], v[104:107]
    v_mfma_f32_16x16x32_bf16 v[100:103], v[20:23], v[232:235], v[100:103]
    v_mfma_f32_16x16x32_bf16 v[108:111], v[20:23], v[236:239], v[108:111]
    s_nop 1
    s_waitcnt lgkmcnt(0)
    v_mfma_f32_16x16x32_bf16 v[112:115], v[24:27], v[232:235], v[112:115]
    v_mfma_f32_16x16x32_bf16 v[120:123], v[24:27], v[236:239], v[120:123]
    v_mfma_f32_16x16x32_bf16 v[116:119], v[28:31], v[232:235], v[116:119]
    v_mfma_f32_16x16x32_bf16 v[124:127], v[28:31], v[236:239], v[124:127]
    v_mul_f32 v80, s50, v80
    v_mul_f32 v81, s50, v81
    v_mul_f32 v82, s50, v82
    v_mul_f32 v83, s50, v83
    v_mul_f32 v84, s50, v84
    v_mul_f32 v85, s50, v85
    v_mul_f32 v86, s50, v86
    v_mul_f32 v87, s50, v87
    v_mul_f32 v88, s50, v88
    v_mul_f32 v89, s50, v89
    v_mul_f32 v90, s50, v90
    v_mul_f32 v91, s50, v91
    v_mul_f32 v92, s50, v92
    v_mul_f32 v93, s50, v93
    v_mul_f32 v94, s50, v94
    v_mul_f32 v95, s50, v95
    v_cvt_pk_bf16_f32 v192, v80, v81
    v_cvt_pk_bf16_f32 v193, v82, v83
    v_cvt_pk_bf16_f32 v196, v88, v89
    v_cvt_pk_bf16_f32 v197, v90, v91
    s_mov_b32 exec_hi, 0xffff
    v_cvt_pk_bf16_f32 v194, v84, v85
    v_cvt_pk_bf16_f32 v195, v86, v87
    v_cvt_pk_bf16_f32 v198, v92, v93
    v_cvt_pk_bf16_f32 v199, v94, v95
    s_mov_b32 exec_hi, -1
    v_mul_f32 v96, s50, v96
    v_mul_f32 v97, s50, v97
    v_mul_f32 v98, s50, v98
    v_mul_f32 v99, s50, v99
    v_mul_f32 v100, s50, v100
    v_mul_f32 v101, s50, v101
    v_mul_f32 v102, s50, v102
    v_mul_f32 v103, s50, v103
    v_mul_f32 v104, s50, v104
    v_mul_f32 v105, s50, v105
    v_mul_f32 v106, s50, v106
    v_mul_f32 v107, s50, v107
    v_mul_f32 v108, s50, v108
    v_mul_f32 v109, s50, v109
    v_mul_f32 v110, s50, v110
    v_mul_f32 v111, s50, v111
    v_cvt_pk_bf16_f32 v200, v96, v97
    v_cvt_pk_bf16_f32 v201, v98, v99
    v_cvt_pk_bf16_f32 v204, v104, v105
    v_cvt_pk_bf16_f32 v205, v106, v107
    s_mov_b32 exec_hi, 0xffff
    v_cvt_pk_bf16_f32 v202, v100, v101
    v_cvt_pk_bf16_f32 v203, v102, v103
    v_cvt_pk_bf16_f32 v206, v108, v109
    v_cvt_pk_bf16_f32 v207, v110, v111
    s_mov_b32 exec_hi, -1
    v_pk_mul_f32 v[112:113], v[112:113], s[50:51]
    v_pk_mul_f32 v[114:115], v[114:115], s[50:51]
    v_pk_mul_f32 v[116:117], v[116:117], s[50:51]
    v_pk_mul_f32 v[118:119], v[118:119], s[50:51]
    v_pk_mul_f32 v[120:121], v[120:121], s[50:51]
    v_pk_mul_f32 v[122:123], v[122:123], s[50:51]
    v_pk_mul_f32 v[124:125], v[124:125], s[50:51]
    v_pk_mul_f32 v[126:127], v[126:127], s[50:51]
    v_cvt_pk_bf16_f32 v208, v112, v113
    v_cvt_pk_bf16_f32 v209, v114, v115
    v_cvt_pk_bf16_f32 v212, v120, v121
    v_cvt_pk_bf16_f32 v213, v122, v123
    s_mov_b32 exec_hi, 0xffff
    v_cvt_pk_bf16_f32 v210, v116, v117
    v_cvt_pk_bf16_f32 v211, v118, v119
    v_cvt_pk_bf16_f32 v214, v124, v125
    v_cvt_pk_bf16_f32 v215, v126, v127
    s_mov_b32 exec_hi, -1
    v_mov_b32 v216, v14
    s_branch L_a_attn
P1B_QKK:
    s_mul_i32 s36, s33, 168
    s_and_b32 s37, s36, 15
    s_sub_u32 s36, s36, s37
    v_and_b32 v3, 15, v1
    v_lshrrev_b32 v4, 4, v1
    v_lshrrev_b32 v5, 1, v3
    v_xor_b32 v5, v5, v4
    s_lshl_b32 s40, s34, 12
    v_lshl_add_u32 v6, v3, 7, s40
    v_lshl_add_u32 v8, v5, 4, v6
    v_xor_b32 v9, 64, v8
    v_bfe_u32 v5, v1, 2, 2
    v_lshl_add_u32 v5, v4, 2, v5
    v_mul_u32_u24 v5, 352, v5
    v_and_b32 v6, 3, v1
    v_lshl_add_u32 v5, v6, 3, v5
    s_add_u32 s40, s37, 98304
    v_add_u32 v12, s40, v5
    v_lshlrev_b32 v79, 4, v4
    v_add_u32 v79, 159744, v79
    v_mov_b32 v2, 163840
    s_mov_b32 vcc_lo, 0x00010001
    s_mov_b32 vcc_hi, 0x00010001
    v_cndmask_b32 v79, v2, v79, vcc
    s_waitcnt lgkmcnt(0)
    s_mov_b32 s96, s20
    s_and_b32 s97, s21, 0xffff
    s_mov_b32 s98, 256
    s_mov_b32 s99, 0x20000
    s_or_b32 s53, s2, s34
    s_cbranch_scc1 notag_58
    s_memrealtime s[100:101]
    s_waitcnt lgkmcnt(0)
    s_lshl_b64 s[100:101], s[100:101], 1
    s_or_b32 s100, s100, 1
    v_mov_b32 v76, s100
    v_mov_b32 v77, s101
    s_mov_b64 exec, 1
    buffer_store_dwordx2 v[76:77], off, s[96:99], 0 sc1
    s_mov_b64 exec, -1
notag_58:
    s_xor_b32 s62, s33, 1
    s_lshr_b32 s40, s33, 1
    s_cmp_eq_u32 s40, 2
    s_cselect_b32 s62, s33, s62
    s_cmp_eq_u32 s40, 5
    s_cselect_b32 s62, s33, s62
    s_mul_i32 s38, s62, 168
    s_and_b32 s39, s38, 15
    s_sub_u32 s38, s38, s39
    v_add_u32 v5, s39, v5
    v_add_u32 v13, 98304, v5
    v_add_u32 v6, 65536, v5
    v_lshlrev_b32 v2, 4, v3
    v_lshl_add_u32 v14, v4, 9, v2
    v_cmp_eq_u32 vcc, 12, v3
    v_mov_b32 v2, 0x3f803f80
    s_mov_b32 s50, 1049335798
    s_mov_b32 s51, 1049335798
    v_cndmask_b32 v7, 0, v2, vcc
    s_lshl_b32 s39, s35, 12
    s_lshl_b32 s40, s32, 2
    s_add_u32 s40, s40, s35
    s_mov_b32 s60, 0
    s_lshl_b32 s41, s33, 6
    s_add_u32 s41, s41, s40
    s_lshl_b32 s41, s41, 11
    s_add_u32 s41, s41, 8388608
    s_add_u32 s42, s41, 2097152
    s_lshl_b32 s45, s40, 5
    s_add_u32 s45, s45, s33
    s_lshl_b32 s43, s45, 11
    s_add_u32 s43, s43, 12582912
    s_add_u32 s44, s43, 32768
    s_lshl_b32 s45, s45, 7
    s_add_u32 s45, s45, 21233664
    s_mov_b32 s56, 1400897536
    s_mov_b32 s57, 729808896
    s_lshr_b32 s38, s2, 3
    s_mul_i32 s36, s38, 37
    s_lshr_b32 s36, s36, 8
    s_mul_i32 s37, s36, 7
    s_sub_u32 s37, s38, s37
    s_and_b32 s46, s2, 1
    s_lshl_b32 s46, s46, 4
    s_add_u32 s36, s36, s46
    s_and_b32 s46, s2, 6
    s_lshl_b32 s46, s46, 1
    s_add_u32 s36, s36, s46
    s_cmp_eq_u32 s35, 3
    s_cselect_b32 s49, 4294952960, 0
    s_lshl_b32 s46, s62, 6
    s_add_u32 s46, s46, s40
    s_lshl_b32 s46, s46, 7
    s_add_u32 s3, s46, 20971520
    s_lshl_b32 s46, s33, 6
    s_add_u32 s46, s46, s40
    s_lshl_b32 s46, s46, 7
    s_add_u32 s52, s46, 21102592
    s_mov_b32 s28, s22
    s_and_b32 s29, s23, 0xffff
    s_mov_b32 s30, 22020096
    s_mov_b32 s31, 0x20000
    s_lshl_b32 s46, s33, 18
    s_add_u32 s10, s22, s46
    s_addc_u32 s11, s23, 0
    s_mov_b32 s64, s10
    s_and_b32 s65, s11, 0xffff
    s_mov_b32 s66, 262144
    s_mov_b32 s67, 0x20000
    s_add_u32 s10, s10, 4194304
    s_addc_u32 s11, s11, 0
    s_mov_b32 s68, s10
    s_and_b32 s69, s11, 0xffff
    s_mov_b32 s70, 262144
    s_mov_b32 s71, 0x20000
    s_mov_b32 s24, s14
    s_and_b32 s25, s15, 0xffff
    s_mov_b32 s26, 401408
    s_mov_b32 s27, 0x20000
    s_and_b32 s4, s34, 1
    s_lshr_b32 s5, s34, 1
    s_lshl_b32 s46, s36, 1
    s_add_u32 s46, s46, s4
    s_lshl_b32 s47, s46, 5
    s_xor_b32 s48, s5, 2
    s_lshl_b32 s48, s48, 3
    s_add_u32 s47, s47, s48
    s_lshl_b32 s6, s47, 11
    s_add_u32 s6, s6, 12582912
    s_lshl_b32 s7, s47, 7
    s_add_u32 s7, s7, 21233664
    s_mul_i32 s58, s33, 3
    s_add_u32 s61, s58, 0
    s_and_b32 s61, s61, 15
    s_lshl_b32 s61, s61, 6
    s_add_u32 s61, s61, s40
    s_lshl_b32 s61, s61, 11
    s_add_u32 s54, s61, 10485760
    s_add_u32 s61, s58, 1
    s_and_b32 s61, s61, 15
    s_lshl_b32 s61, s61, 6
    s_add_u32 s61, s61, s40
    s_lshl_b32 s61, s61, 12
    s_add_u32 s55, s61, 4194304
    s_add_u32 s61, s58, 2
    s_and_b32 s61, s61, 15
    s_lshl_b32 s61, s61, 6
    s_add_u32 s61, s61, s40
    s_lshl_b32 s61, s61, 12
    s_add_u32 s17, s61, 4194304
    s_mul_i32 s58, s62, 3
    s_add_u32 s61, s58, 0
    s_and_b32 s61, s61, 15
    s_lshl_b32 s61, s61, 6
    s_add_u32 s61, s61, s40
    s_lshl_b32 s61, s61, 11
    s_add_u32 s47, s61, 8388608
    s_add_u32 s61, s58, 1
    s_and_b32 s61, s61, 15
    s_lshl_b32 s61, s61, 6
    s_add_u32 s61, s61, s40
    s_lshl_b32 s61, s61, 12
    s_add_u32 s59, s61, 0
    s_add_u32 s61, s58, 2
    s_and_b32 s61, s61, 15
    s_lshl_b32 s61, s61, 6
    s_add_u32 s61, s61, s40
    s_lshl_b32 s61, s61, 12
    s_add_u32 s16, s61, 0
    v_mov_b32 v54, 0
    v_mov_b32 v55, 0
    v_mov_b32 v58, 0
    v_mov_b32 v59, 0
    v_mov_b32 v62, 0x3f803f80
    v_mov_b32 v63, 0x3f80
    v_mov_b32 v66, 0x3f803f80
    v_mov_b32 v67, 0x3f80
    v_mov_b32 v70, 0x3f803f80
    v_mov_b32 v71, 0x3f80
    v_mov_b32 v74, 0x3f803f80
    v_mov_b32 v75, 0x3f80
    s_barrier
    ds_read_b128 v[128:131], v8 offset:0
    ds_read_b128 v[132:135], v8 offset:2048
    ds_read_b64_tr_b16 v[16:17], v12 offset:0
    ds_read_b64_tr_b16 v[18:19], v12 offset:176
    ds_read_b64_tr_b16 v[20:21], v12 offset:32
    ds_read_b64_tr_b16 v[22:23], v12 offset:208
    ds_read_b64_tr_b16 v[24:25], v12 offset:56
    ds_read_b64_tr_b16 v[26:27], v12 offset:232
    ds_read_b64_tr_b16 v[28:29], v12 offset:88
    ds_read_b64_tr_b16 v[30:31], v12 offset:264
    ds_read_b64_tr_b16 v[32:33], v12 offset:112
    ds_read_b64_tr_b16 v[34:35], v12 offset:288
    ds_read_b64_tr_b16 v[36:37], v12 offset:144
    ds_read_b64_tr_b16 v[38:39], v12 offset:320
    ds_read_b128 v[160:163], v79 offset:0
    s_waitcnt lgkmcnt(9)
    v_mfma_f32_16x16x32_bf16 v[80:83], v[16:19], v[128:131], 0
    ds_read_b128 v[136:139], v9 offset:0
    ds_read_b128 v[140:143], v9 offset:2048
    v_mfma_f32_16x16x32_bf16 v[88:91], v[16:19], v[132:135], 0
    ds_read_b64_tr_b16 v[40:41], v12 offset:5632
    ds_read_b64_tr_b16 v[42:43], v12 offset:5808
    v_mfma_f32_16x16x32_bf16 v[84:87], v[20:23], v[128:131], 0
    ds_read_b64_tr_b16 v[44:45], v12 offset:5664
    v_mfma_f32_16x16x32_bf16 v[92:95], v[20:23], v[132:135], 0
    ds_read_b64_tr_b16 v[46:47], v12 offset:5840
    s_waitcnt lgkmcnt(11)
    v_mfma_f32_16x16x32_bf16 v[96:99], v[24:27], v[128:131], 0
    ds_read_b64_tr_b16 v[16:17], v12 offset:5688
    v_mfma_f32_16x16x32_bf16 v[104:107], v[24:27], v[132:135], 0
    ds_read_b64_tr_b16 v[18:19], v12 offset:5864
    v_mfma_f32_16x16x32_bf16 v[100:103], v[28:31], v[128:131], 0
    ds_read_b64_tr_b16 v[20:21], v12 offset:5720
    v_mfma_f32_16x16x32_bf16 v[108:111], v[28:31], v[132:135], 0
    ds_read_b64_tr_b16 v[22:23], v12 offset:5896
    s_waitcnt lgkmcnt(10)
    v_mfma_f32_16x16x32_bf16 v[112:115], v[32:35], v[128:131], 0
    ds_read_b64_tr_b16 v[24:25], v12 offset:5744
    ds_read_b64_tr_b16 v[26:27], v12 offset:5920
    v_mfma_f32_16x16x32_bf16 v[120:123], v[32:35], v[132:135], 0
    ds_read_b64_tr_b16 v[28:29], v12 offset:5776
    v_mfma_f32_16x16x32_bf16 v[116:119], v[36:39], v[128:131], 0
    ds_read_b64_tr_b16 v[30:31], v12 offset:5952
    v_mfma_f32_16x16x32_bf16 v[124:127], v[36:39], v[132:135], 0
    ds_read_b128 v[168:171], v79 offset:64
    v_mfma_f32_16x16x32_bf16 v[240:243], v[160:163], v[128:131], 0
    v_mfma_f32_16x16x32_bf16 v[244:247], v[160:163], v[132:135], 0
    s_waitcnt lgkmcnt(9)
    s_barrier
    v_mfma_f32_16x16x32_bf16 v[80:83], v[40:43], v[136:139], v[80:83]
    ds_read_b128 v[144:147], v8 offset:16384
    ds_read_b128 v[148:151], v8 offset:18432
    v_mfma_f32_16x16x32_bf16 v[88:91], v[40:43], v[140:143], v[88:91]
    ds_read_b64_tr_b16 v[32:33], v12 offset:12288
    ds_read_b64_tr_b16 v[34:35], v12 offset:12464
    v_mfma_f32_16x16x32_bf16 v[84:87], v[44:47], v[136:139], v[84:87]
    ds_read_b64_tr_b16 v[36:37], v12 offset:12320
    v_mfma_f32_16x16x32_bf16 v[92:95], v[44:47], v[140:143], v[92:95]
    ds_read_b64_tr_b16 v[38:39], v12 offset:12496
    s_waitcnt lgkmcnt(11)
    v_mfma_f32_16x16x32_bf16 v[96:99], v[16:19], v[136:139], v[96:99]
    ds_read_b64_tr_b16 v[40:41], v12 offset:12344
    v_mfma_f32_16x16x32_bf16 v[104:107], v[16:19], v[140:143], v[104:107]
    ds_read_b64_tr_b16 v[42:43], v12 offset:12520
    v_mfma_f32_16x16x32_bf16 v[100:103], v[20:23], v[136:139], v[100:103]
    ds_read_b64_tr_b16 v[44:45], v12 offset:12376
    v_mfma_f32_16x16x32_bf16 v[108:111], v[20:23], v[140:143], v[108:111]
    ds_read_b64_tr_b16 v[46:47], v12 offset:12552
    s_waitcnt lgkmcnt(10)
    v_mfma_f32_16x16x32_bf16 v[112:115], v[24:27], v[136:139], v[112:115]
    ds_read_b64_tr_b16 v[16:17], v12 offset:12400
    ds_read_b64_tr_b16 v[18:19], v12 offset:12576
    v_mfma_f32_16x16x32_bf16 v[120:123], v[24:27], v[140:143], v[120:123]
    ds_read_b64_tr_b16 v[20:21], v12 offset:12432
    v_mfma_f32_16x16x32_bf16 v[116:119], v[28:31], v[136:139], v[116:119]
    ds_read_b64_tr_b16 v[22:23], v12 offset:12608
    v_mfma_f32_16x16x32_bf16 v[124:127], v[28:31], v[140:143], v[124:127]
    ds_read_b128 v[176:179], v79 offset:128
    v_mfma_f32_16x16x32_bf16 v[240:243], v[168:171], v[136:139], v[240:243]
    v_mfma_f32_16x16x32_bf16 v[244:247], v[168:171], v[140:143], v[244:247]
    s_waitcnt lgkmcnt(9)
    v_mfma_f32_16x16x32_bf16 v[80:83], v[32:35], v[144:147], v[80:83]
    ds_read_b128 v[152:155], v9 offset:16384
    ds_read_b128 v[156:159], v9 offset:18432
    v_mfma_f32_16x16x32_bf16 v[88:91], v[32:35], v[148:151], v[88:91]
    ds_read_b64_tr_b16 v[24:25], v12 offset:17920
    ds_read_b64_tr_b16 v[26:27], v12 offset:18096
    v_mfma_f32_16x16x32_bf16 v[84:87], v[36:39], v[144:147], v[84:87]
    ds_read_b64_tr_b16 v[28:29], v12 offset:17952
    v_mfma_f32_16x16x32_bf16 v[92:95], v[36:39], v[148:151], v[92:95]
    ds_read_b64_tr_b16 v[30:31], v12 offset:18128
    s_waitcnt lgkmcnt(11)
    v_mfma_f32_16x16x32_bf16 v[96:99], v[40:43], v[144:147], v[96:99]
    ds_read_b64_tr_b16 v[32:33], v12 offset:17976
    v_mfma_f32_16x16x32_bf16 v[104:107], v[40:43], v[148:151], v[104:107]
    ds_read_b64_tr_b16 v[34:35], v12 offset:18152
    v_mfma_f32_16x16x32_bf16 v[100:103], v[44:47], v[144:147], v[100:103]
    ds_read_b64_tr_b16 v[36:37], v12 offset:18008
    v_mfma_f32_16x16x32_bf16 v[108:111], v[44:47], v[148:151], v[108:111]
    ds_read_b64_tr_b16 v[38:39], v12 offset:18184
    s_waitcnt lgkmcnt(10)
    v_mfma_f32_16x16x32_bf16 v[112:115], v[16:19], v[144:147], v[112:115]
    ds_read_b64_tr_b16 v[40:41], v12 offset:18032
    ds_read_b64_tr_b16 v[42:43], v12 offset:18208
    v_mfma_f32_16x16x32_bf16 v[120:123], v[16:19], v[148:151], v[120:123]
    ds_read_b64_tr_b16 v[44:45], v12 offset:18064
    v_mfma_f32_16x16x32_bf16 v[116:119], v[20:23], v[144:147], v[116:119]
    ds_read_b64_tr_b16 v[46:47], v12 offset:18240
    v_mfma_f32_16x16x32_bf16 v[124:127], v[20:23], v[148:151], v[124:127]
    ds_read_b128 v[184:187], v79 offset:192
    v_mfma_f32_16x16x32_bf16 v[240:243], v[176:179], v[144:147], v[240:243]
    v_mfma_f32_16x16x32_bf16 v[244:247], v[176:179], v[148:151], v[244:247]
    s_waitcnt lgkmcnt(9)
    s_barrier
    v_mfma_f32_16x16x32_bf16 v[80:83], v[24:27], v[152:155], v[80:83]
    ds_read_b128 v[160:163], v8 offset:32768
    ds_read_b128 v[164:167], v8 offset:34816
    v_mfma_f32_16x16x32_bf16 v[88:91], v[24:27], v[156:159], v[88:91]
    ds_read_b64_tr_b16 v[16:17], v12 offset:24576
    ds_read_b64_tr_b16 v[18:19], v12 offset:24752
    v_mfma_f32_16x16x32_bf16 v[84:87], v[28:31], v[152:155], v[84:87]
    ds_read_b64_tr_b16 v[20:21], v12 offset:24608
    v_mfma_f32_16x16x32_bf16 v[92:95], v[28:31], v[156:159], v[92:95]
    ds_read_b64_tr_b16 v[22:23], v12 offset:24784
    s_waitcnt lgkmcnt(11)
    v_mfma_f32_16x16x32_bf16 v[96:99], v[32:35], v[152:155], v[96:99]
    ds_read_b64_tr_b16 v[24:25], v12 offset:24632
    v_mfma_f32_16x16x32_bf16 v[104:107], v[32:35], v[156:159], v[104:107]
    ds_read_b64_tr_b16 v[26:27], v12 offset:24808
    v_mfma_f32_16x16x32_bf16 v[100:103], v[36:39], v[152:155], v[100:103]
    ds_read_b64_tr_b16 v[28:29], v12 offset:24664
    v_mfma_f32_16x16x32_bf16 v[108:111], v[36:39], v[156:159], v[108:111]
    ds_read_b64_tr_b16 v[30:31], v12 offset:24840
    s_waitcnt lgkmcnt(10)
    v_mfma_f32_16x16x32_bf16 v[112:115], v[40:43], v[152:155], v[112:115]
    ds_read_b64_tr_b16 v[32:33], v12 offset:24688
    ds_read_b64_tr_b16 v[34:35], v12 offset:24864
    v_mfma_f32_16x16x32_bf16 v[120:123], v[40:43], v[156:159], v[120:123]
    ds_read_b64_tr_b16 v[36:37], v12 offset:24720
    v_mfma_f32_16x16x32_bf16 v[116:119], v[44:47], v[152:155], v[116:119]
    ds_read_b64_tr_b16 v[38:39], v12 offset:24896
    v_mfma_f32_16x16x32_bf16 v[124:127], v[44:47], v[156:159], v[124:127]
    ds_read_b128 v[192:195], v79 offset:256
    v_mfma_f32_16x16x32_bf16 v[240:243], v[184:187], v[152:155], v[240:243]
    v_mfma_f32_16x16x32_bf16 v[244:247], v[184:187], v[156:159], v[244:247]
    s_waitcnt lgkmcnt(9)
    v_mfma_f32_16x16x32_bf16 v[80:83], v[16:19], v[160:163], v[80:83]
    ds_read_b128 v[168:171], v9 offset:32768
    ds_read_b128 v[172:175], v9 offset:34816
    v_mfma_f32_16x16x32_bf16 v[88:91], v[16:19], v[164:167], v[88:91]
    ds_read_b64_tr_b16 v[40:41], v12 offset:30208
    ds_read_b64_tr_b16 v[42:43], v12 offset:30384
    v_mfma_f32_16x16x32_bf16 v[84:87], v[20:23], v[160:163], v[84:87]
    ds_read_b64_tr_b16 v[44:45], v12 offset:30240
    v_mfma_f32_16x16x32_bf16 v[92:95], v[20:23], v[164:167], v[92:95]
    ds_read_b64_tr_b16 v[46:47], v12 offset:30416
    s_waitcnt lgkmcnt(11)
    v_mfma_f32_16x16x32_bf16 v[96:99], v[24:27], v[160:163], v[96:99]
    ds_read_b64_tr_b16 v[16:17], v12 offset:30264
    v_mfma_f32_16x16x32_bf16 v[104:107], v[24:27], v[164:167], v[104:107]
    ds_read_b64_tr_b16 v[18:19], v12 offset:30440
    v_mfma_f32_16x16x32_bf16 v[100:103], v[28:31], v[160:163], v[100:103]
    ds_read_b64_tr_b16 v[20:21], v12 offset:30296
    v_mfma_f32_16x16x32_bf16 v[108:111], v[28:31], v[164:167], v[108:111]
    ds_read_b64_tr_b16 v[22:23], v12 offset:30472
    s_waitcnt lgkmcnt(10)
    v_mfma_f32_16x16x32_bf16 v[112:115], v[32:35], v[160:163], v[112:115]
    ds_read_b64_tr_b16 v[24:25], v12 offset:30320
    ds_read_b64_tr_b16 v[26:27], v12 offset:30496
    v_mfma_f32_16x16x32_bf16 v[120:123], v[32:35], v[164:167], v[120:123]
    ds_read_b64_tr_b16 v[28:29], v12 offset:30352
    v_mfma_f32_16x16x32_bf16 v[116:119], v[36:39], v[160:163], v[116:119]
    ds_read_b64_tr_b16 v[30:31], v12 offset:30528
    v_mfma_f32_16x16x32_bf16 v[124:127], v[36:39], v[164:167], v[124:127]
    ds_read_b128 v[200:203], v79 offset:320
    v_mfma_f32_16x16x32_bf16 v[240:243], v[192:195], v[160:163], v[240:243]
    v_mfma_f32_16x16x32_bf16 v[244:247], v[192:195], v[164:167], v[244:247]
    v_lshlrev_b32 v2, 3, v1
    v_mov_b32 v76, 0
    v_mov_b32 v77, 0
    s_add_u32 s46, s45, 2048
    s_mov_b64 exec, 0xffff
    buffer_store_dwordx2 v[76:77], v2, s[28:31], s45 offen sc1
    s_mov_b64 exec, -1
    s_mov_b64 exec, 0xffff
    buffer_store_dwordx2 v[76:77], v2, s[28:31], s46 offen sc1
    s_mov_b64 exec, -1
    s_waitcnt lgkmcnt(9)
    s_barrier
    v_mfma_f32_16x16x32_bf16 v[80:83], v[40:43], v[168:171], v[80:83]
    ds_read_b128 v[176:179], v8 offset:49152
    ds_read_b128 v[180:183], v8 offset:51200
    v_mfma_f32_16x16x32_bf16 v[88:91], v[40:43], v[172:175], v[88:91]
    ds_read_b64_tr_b16 v[32:33], v12 offset:36864
    ds_read_b64_tr_b16 v[34:35], v12 offset:37040
    v_mfma_f32_16x16x32_bf16 v[84:87], v[44:47], v[168:171], v[84:87]
    ds_read_b64_tr_b16 v[36:37], v12 offset:36896
    v_mfma_f32_16x16x32_bf16 v[92:95], v[44:47], v[172:175], v[92:95]
    ds_read_b64_tr_b16 v[38:39], v12 offset:37072
    s_waitcnt lgkmcnt(11)
    v_mfma_f32_16x16x32_bf16 v[96:99], v[16:19], v[168:171], v[96:99]
    ds_read_b64_tr_b16 v[40:41], v12 offset:36920
    v_mfma_f32_16x16x32_bf16 v[104:107], v[16:19], v[172:175], v[104:107]
    ds_read_b64_tr_b16 v[42:43], v12 offset:37096
    v_mfma_f32_16x16x32_bf16 v[100:103], v[20:23], v[168:171], v[100:103]
    ds_read_b64_tr_b16 v[44:45], v12 offset:36952
    v_mfma_f32_16x16x32_bf16 v[108:111], v[20:23], v[172:175], v[108:111]
    ds_read_b64_tr_b16 v[46:47], v12 offset:37128
    s_waitcnt lgkmcnt(10)
    v_mfma_f32_16x16x32_bf16 v[112:115], v[24:27], v[168:171], v[112:115]
    ds_read_b64_tr_b16 v[16:17], v12 offset:36976
    ds_read_b64_tr_b16 v[18:19], v12 offset:37152
    v_mfma_f32_16x16x32_bf16 v[120:123], v[24:27], v[172:175], v[120:123]
    ds_read_b64_tr_b16 v[20:21], v12 offset:37008
    v_mfma_f32_16x16x32_bf16 v[116:119], v[28:31], v[168:171], v[116:119]
    ds_read_b64_tr_b16 v[22:23], v12 offset:37184
    v_mfma_f32_16x16x32_bf16 v[124:127], v[28:31], v[172:175], v[124:127]
    ds_read_b128 v[208:211], v79 offset:384
    v_mfma_f32_16x16x32_bf16 v[240:243], v[200:203], v[168:171], v[240:243]
    v_mfma_f32_16x16x32_bf16 v[244:247], v[200:203], v[172:175], v[244:247]
    s_waitcnt lgkmcnt(9)
    v_mfma_f32_16x16x32_bf16 v[80:83], v[32:35], v[176:179], v[80:83]
    ds_read_b128 v[184:187], v9 offset:49152
    ds_read_b128 v[188:191], v9 offset:51200
    v_mfma_f32_16x16x32_bf16 v[88:91], v[32:35], v[180:183], v[88:91]
    ds_read_b64_tr_b16 v[24:25], v12 offset:42496
    ds_read_b64_tr_b16 v[26:27], v12 offset:42672
    v_mfma_f32_16x16x32_bf16 v[84:87], v[36:39], v[176:179], v[84:87]
    ds_read_b64_tr_b16 v[28:29], v12 offset:42528
    v_mfma_f32_16x16x32_bf16 v[92:95], v[36:39], v[180:183], v[92:95]
    ds_read_b64_tr_b16 v[30:31], v12 offset:42704
    s_waitcnt lgkmcnt(11)
    v_mfma_f32_16x16x32_bf16 v[96:99], v[40:43], v[176:179], v[96:99]
    ds_read_b64_tr_b16 v[32:33], v12 offset:42552
    v_mfma_f32_16x16x32_bf16 v[104:107], v[40:43], v[180:183], v[104:107]
    ds_read_b64_tr_b16 v[34:35], v12 offset:42728
    v_mfma_f32_16x16x32_bf16 v[100:103], v[44:47], v[176:179], v[100:103]
    ds_read_b64_tr_b16 v[36:37], v12 offset:42584
    v_mfma_f32_16x16x32_bf16 v[108:111], v[44:47], v[180:183], v[108:111]
    ds_read_b64_tr_b16 v[38:39], v12 offset:42760
    s_waitcnt lgkmcnt(10)
    v_mfma_f32_16x16x32_bf16 v[112:115], v[16:19], v[176:179], v[112:115]
    ds_read_b64_tr_b16 v[40:41], v12 offset:42608
    ds_read_b64_tr_b16 v[42:43], v12 offset:42784
    v_mfma_f32_16x16x32_bf16 v[120:123], v[16:19], v[180:183], v[120:123]
    ds_read_b64_tr_b16 v[44:45], v12 offset:42640
    v_mfma_f32_16x16x32_bf16 v[116:119], v[20:23], v[176:179], v[116:119]
    ds_read_b64_tr_b16 v[46:47], v12 offset:42816
    v_mfma_f32_16x16x32_bf16 v[124:127], v[20:23], v[180:183], v[124:127]
    ds_read_b128 v[216:219], v79 offset:448
    v_mfma_f32_16x16x32_bf16 v[240:243], v[208:211], v[176:179], v[240:243]
    v_mfma_f32_16x16x32_bf16 v[244:247], v[208:211], v[180:183], v[244:247]
    s_waitcnt lgkmcnt(9)
    s_barrier
    v_mfma_f32_16x16x32_bf16 v[80:83], v[24:27], v[184:187], v[80:83]
    ds_read_b128 v[192:195], v8 offset:0
    ds_read_b128 v[196:199], v8 offset:2048
    v_mfma_f32_16x16x32_bf16 v[88:91], v[24:27], v[188:191], v[88:91]
    ds_read_b64_tr_b16 v[16:17], v12 offset:49152
    ds_read_b64_tr_b16 v[18:19], v12 offset:49328
    v_mfma_f32_16x16x32_bf16 v[84:87], v[28:31], v[184:187], v[84:87]
    ds_read_b64_tr_b16 v[20:21], v12 offset:49184
    v_mfma_f32_16x16x32_bf16 v[92:95], v[28:31], v[188:191], v[92:95]
    ds_read_b64_tr_b16 v[22:23], v12 offset:49360
    s_waitcnt lgkmcnt(11)
    v_mfma_f32_16x16x32_bf16 v[96:99], v[32:35], v[184:187], v[96:99]
    ds_read_b64_tr_b16 v[24:25], v12 offset:49208
    v_mfma_f32_16x16x32_bf16 v[104:107], v[32:35], v[188:191], v[104:107]
    ds_read_b64_tr_b16 v[26:27], v12 offset:49384
    v_mfma_f32_16x16x32_bf16 v[100:103], v[36:39], v[184:187], v[100:103]
    ds_read_b64_tr_b16 v[28:29], v12 offset:49240
    v_mfma_f32_16x16x32_bf16 v[108:111], v[36:39], v[188:191], v[108:111]
    ds_read_b64_tr_b16 v[30:31], v12 offset:49416
    buffer_load_dwordx2 v[76:77], off, s[96:99], 0 sc1
    s_waitcnt lgkmcnt(10)
    v_mfma_f32_16x16x32_bf16 v[112:115], v[40:43], v[184:187], v[112:115]
    ds_read_b64_tr_b16 v[32:33], v12 offset:49264
    ds_read_b64_tr_b16 v[34:35], v12 offset:49440
    v_mfma_f32_16x16x32_bf16 v[120:123], v[40:43], v[188:191], v[120:123]
    ds_read_b64_tr_b16 v[36:37], v12 offset:49296
    v_mfma_f32_16x16x32_bf16 v[116:119], v[44:47], v[184:187], v[116:119]
    ds_read_b64_tr_b16 v[38:39], v12 offset:49472
    v_mfma_f32_16x16x32_bf16 v[124:127], v[44:47], v[188:191], v[124:127]
    ds_read_b128 v[224:227], v79 offset:512
    v_mfma_f32_16x16x32_bf16 v[240:243], v[216:219], v[184:187], v[240:243]
    v_mfma_f32_16x16x32_bf16 v[244:247], v[216:219], v[188:191], v[244:247]
    s_waitcnt lgkmcnt(9)
    v_mfma_f32_16x16x32_bf16 v[80:83], v[16:19], v[192:195], v[80:83]
    ds_read_b128 v[200:203], v9 offset:0
    ds_read_b128 v[204:207], v9 offset:2048
    v_mfma_f32_16x16x32_bf16 v[88:91], v[16:19], v[196:199], v[88:91]
    ds_read_b64_tr_b16 v[40:41], v12 offset:54784
    ds_read_b64_tr_b16 v[42:43], v12 offset:54960
    v_mfma_f32_16x16x32_bf16 v[84:87], v[20:23], v[192:195], v[84:87]
    ds_read_b64_tr_b16 v[44:45], v12 offset:54816
    v_mfma_f32_16x16x32_bf16 v[92:95], v[20:23], v[196:199], v[92:95]
    ds_read_b64_tr_b16 v[46:47], v12 offset:54992
    s_waitcnt lgkmcnt(11)
    v_mfma_f32_16x16x32_bf16 v[96:99], v[24:27], v[192:195], v[96:99]
    ds_read_b64_tr_b16 v[16:17], v12 offset:54840
    v_mfma_f32_16x16x32_bf16 v[104:107], v[24:27], v[196:199], v[104:107]
    ds_read_b64_tr_b16 v[18:19], v12 offset:55016
    v_mfma_f32_16x16x32_bf16 v[100:103], v[28:31], v[192:195], v[100:103]
    ds_read_b64_tr_b16 v[20:21], v12 offset:54872
    v_mfma_f32_16x16x32_bf16 v[108:111], v[28:31], v[196:199], v[108:111]
    ds_read_b64_tr_b16 v[22:23], v12 offset:55048
    s_waitcnt lgkmcnt(10)
    v_mfma_f32_16x16x32_bf16 v[112:115], v[32:35], v[192:195], v[112:115]
    ds_read_b64_tr_b16 v[24:25], v12 offset:54896
    ds_read_b64_tr_b16 v[26:27], v12 offset:55072
    v_mfma_f32_16x16x32_bf16 v[120:123], v[32:35], v[196:199], v[120:123]
    ds_read_b64_tr_b16 v[28:29], v12 offset:54928
    v_mfma_f32_16x16x32_bf16 v[116:119], v[36:39], v[192:195], v[116:119]
    ds_read_b64_tr_b16 v[30:31], v12 offset:55104
    v_mfma_f32_16x16x32_bf16 v[124:127], v[36:39], v[196:199], v[124:127]
    ds_read_b128 v[232:235], v79 offset:576
    v_mfma_f32_16x16x32_bf16 v[240:243], v[224:227], v[192:195], v[240:243]
    v_mfma_f32_16x16x32_bf16 v[244:247], v[224:227], v[196:199], v[244:247]
    s_waitcnt lgkmcnt(9)
    s_barrier
    v_mfma_f32_16x16x32_bf16 v[80:83], v[40:43], v[200:203], v[80:83]
    ds_read_b128 v[208:211], v8 offset:16384
    ds_read_b128 v[212:215], v8 offset:18432
    v_mfma_f32_16x16x32_bf16 v[88:91], v[40:43], v[204:207], v[88:91]
    ds_read_b64_tr_b16 v[32:33], v12 offset:0
    ds_read_b64_tr_b16 v[34:35], v12 offset:176
    v_mfma_f32_16x16x32_bf16 v[84:87], v[44:47], v[200:203], v[84:87]
    ds_read_b64_tr_b16 v[36:37], v12 offset:32
    v_mfma_f32_16x16x32_bf16 v[92:95], v[44:47], v[204:207], v[92:95]
    ds_read_b64_tr_b16 v[38:39], v12 offset:208
    s_waitcnt lgkmcnt(11)
    v_mfma_f32_16x16x32_bf16 v[96:99], v[16:19], v[200:203], v[96:99]
    ds_read_b64_tr_b16 v[40:41], v12 offset:56
    v_mfma_f32_16x16x32_bf16 v[104:107], v[16:19], v[204:207], v[104:107]
    ds_read_b64_tr_b16 v[42:43], v12 offset:232
    v_mfma_f32_16x16x32_bf16 v[100:103], v[20:23], v[200:203], v[100:103]
    ds_read_b64_tr_b16 v[44:45], v12 offset:88
    v_mfma_f32_16x16x32_bf16 v[108:111], v[20:23], v[204:207], v[108:111]
    ds_read_b64_tr_b16 v[46:47], v12 offset:264
    s_waitcnt lgkmcnt(10)
    v_mfma_f32_16x16x32_bf16 v[112:115], v[24:27], v[200:203], v[112:115]
    ds_read_b64_tr_b16 v[16:17], v12 offset:112
    v_mfma_f32_16x16x32_bf16 v[120:123], v[24:27], v[204:207], v[120:123]
    ds_read_b64_tr_b16 v[18:19], v12 offset:288
    v_mfma_f32_16x16x32_bf16 v[116:119], v[28:31], v[200:203], v[116:119]
    ds_read_b64_tr_b16 v[20:21], v12 offset:144
    v_mfma_f32_16x16x32_bf16 v[124:127], v[28:31], v[204:207], v[124:127]
    ds_read_b64_tr_b16 v[22:23], v12 offset:320
    v_mfma_f32_16x16x32_bf16 v[240:243], v[232:235], v[200:203], v[240:243]
    v_mfma_f32_16x16x32_bf16 v[244:247], v[232:235], v[204:207], v[244:247]
    s_waitcnt lgkmcnt(8)
    v_mfma_f32_16x16x32_bf16 v[80:83], v[32:35], v[208:211], v[80:83]
    ds_read_b128 v[216:219], v9 offset:16384
    ds_read_b128 v[220:223], v9 offset:18432
    v_mfma_f32_16x16x32_bf16 v[88:91], v[32:35], v[212:215], v[88:91]
    ds_read_b64_tr_b16 v[24:25], v12 offset:5632
    ds_read_b64_tr_b16 v[26:27], v12 offset:5808
    v_mfma_f32_16x16x32_bf16 v[84:87], v[36:39], v[208:211], v[84:87]
    ds_read_b64_tr_b16 v[28:29], v12 offset:5664
    v_mfma_f32_16x16x32_bf16 v[92:95], v[36:39], v[212:215], v[92:95]
    ds_read_b64_tr_b16 v[30:31], v12 offset:5840
    s_waitcnt lgkmcnt(10)
    v_mfma_f32_16x16x32_bf16 v[96:99], v[40:43], v[208:211], v[96:99]
    ds_read_b64_tr_b16 v[32:33], v12 offset:5688
    v_mfma_f32_16x16x32_bf16 v[104:107], v[40:43], v[212:215], v[104:107]
    ds_read_b64_tr_b16 v[34:35], v12 offset:5864
    v_mfma_f32_16x16x32_bf16 v[100:103], v[44:47], v[208:211], v[100:103]
    ds_read_b64_tr_b16 v[36:37], v12 offset:5720
    v_mfma_f32_16x16x32_bf16 v[108:111], v[44:47], v[212:215], v[108:111]
    ds_read_b64_tr_b16 v[38:39], v12 offset:5896
    s_waitcnt lgkmcnt(10)
    v_mfma_f32_16x16x32_bf16 v[112:115], v[16:19], v[208:211], v[112:115]
    ds_read_b64_tr_b16 v[40:41], v12 offset:5744
    v_mfma_f32_16x16x32_bf16 v[120:123], v[16:19], v[212:215], v[120:123]
    ds_read_b64_tr_b16 v[42:43], v12 offset:5920
    v_mfma_f32_16x16x32_bf16 v[116:119], v[20:23], v[208:211], v[116:119]
    ds_read_b64_tr_b16 v[44:45], v12 offset:5776
    v_mfma_f32_16x16x32_bf16 v[124:127], v[20:23], v[212:215], v[124:127]
    ds_read_b64_tr_b16 v[46:47], v12 offset:5952
    s_waitcnt lgkmcnt(8)
    s_barrier
    v_mfma_f32_16x16x32_bf16 v[80:83], v[24:27], v[216:219], v[80:83]
    ds_read_b128 v[224:227], v8 offset:32768
    ds_read_b128 v[228:231], v8 offset:34816
    v_mfma_f32_16x16x32_bf16 v[88:91], v[24:27], v[220:223], v[88:91]
    ds_read_b64_tr_b16 v[16:17], v12 offset:12288
    ds_read_b64_tr_b16 v[18:19], v12 offset:12464
    v_mfma_f32_16x16x32_bf16 v[84:87], v[28:31], v[216:219], v[84:87]
    ds_read_b64_tr_b16 v[20:21], v12 offset:12320
    v_mfma_f32_16x16x32_bf16 v[92:95], v[28:31], v[220:223], v[92:95]
    ds_read_b64_tr_b16 v[22:23], v12 offset:12496
    s_waitcnt lgkmcnt(10)
    v_mfma_f32_16x16x32_bf16 v[96:99], v[32:35], v[216:219], v[96:99]
    ds_read_b64_tr_b16 v[24:25], v12 offset:12344
    v_mfma_f32_16x16x32_bf16 v[104:107], v[32:35], v[220:223], v[104:107]
    ds_read_b64_tr_b16 v[26:27], v12 offset:12520
    v_mfma_f32_16x16x32_bf16 v[100:103], v[36:39], v[216:219], v[100:103]
    ds_read_b64_tr_b16 v[28:29], v12 offset:12376
    v_mfma_f32_16x16x32_bf16 v[108:111], v[36:39], v[220:223], v[108:111]
    ds_read_b64_tr_b16 v[30:31], v12 offset:12552
    s_waitcnt lgkmcnt(10)
    v_mfma_f32_16x16x32_bf16 v[112:115], v[40:43], v[216:219], v[112:115]
    ds_read_b64_tr_b16 v[32:33], v12 offset:12400
    v_mfma_f32_16x16x32_bf16 v[120:123], v[40:43], v[220:223], v[120:123]
    ds_read_b64_tr_b16 v[34:35], v12 offset:12576
    v_mfma_f32_16x16x32_bf16 v[116:119], v[44:47], v[216:219], v[116:119]
    ds_read_b64_tr_b16 v[36:37], v12 offset:12432
    v_mfma_f32_16x16x32_bf16 v[124:127], v[44:47], v[220:223], v[124:127]
    ds_read_b64_tr_b16 v[38:39], v12 offset:12608
    s_waitcnt lgkmcnt(8)
    v_mfma_f32_16x16x32_bf16 v[80:83], v[16:19], v[224:227], v[80:83]
    ds_read_b128 v[232:235], v9 offset:32768
    ds_read_b128 v[236:239], v9 offset:34816
    v_mfma_f32_16x16x32_bf16 v[88:91], v[16:19], v[228:231], v[88:91]
    ds_read_b64_tr_b16 v[40:41], v12 offset:17920
    ds_read_b64_tr_b16 v[42:43], v12 offset:18096
    v_mfma_f32_16x16x32_bf16 v[84:87], v[20:23], v[224:227], v[84:87]
    ds_read_b64_tr_b16 v[44:45], v12 offset:17952
    v_mfma_f32_16x16x32_bf16 v[92:95], v[20:23], v[228:231], v[92:95]
    ds_read_b64_tr_b16 v[46:47], v12 offset:18128
    s_waitcnt lgkmcnt(10)
    v_mfma_f32_16x16x32_bf16 v[96:99], v[24:27], v[224:227], v[96:99]
    ds_read_b64_tr_b16 v[16:17], v12 offset:17976
    v_mfma_f32_16x16x32_bf16 v[104:107], v[24:27], v[228:231], v[104:107]
    ds_read_b64_tr_b16 v[18:19], v12 offset:18152
    v_mfma_f32_16x16x32_bf16 v[100:103], v[28:31], v[224:227], v[100:103]
    ds_read_b64_tr_b16 v[20:21], v12 offset:18008
    v_mfma_f32_16x16x32_bf16 v[108:111], v[28:31], v[228:231], v[108:111]
    ds_read_b64_tr_b16 v[22:23], v12 offset:18184
    s_waitcnt lgkmcnt(10)
    v_mfma_f32_16x16x32_bf16 v[112:115], v[32:35], v[224:227], v[112:115]
    ds_read_b64_tr_b16 v[24:25], v12 offset:18032
    v_mfma_f32_16x16x32_bf16 v[120:123], v[32:35], v[228:231], v[120:123]
    ds_read_b64_tr_b16 v[26:27], v12 offset:18208
    v_mfma_f32_16x16x32_bf16 v[116:119], v[36:39], v[224:227], v[116:119]
    ds_read_b64_tr_b16 v[28:29], v12 offset:18064
    v_mfma_f32_16x16x32_bf16 v[124:127], v[36:39], v[228:231], v[124:127]
    ds_read_b64_tr_b16 v[30:31], v12 offset:18240
    s_waitcnt lgkmcnt(8)
    v_mfma_f32_16x16x32_bf16 v[80:83], v[40:43], v[232:235], v[80:83]
    v_mfma_f32_16x16x32_bf16 v[88:91], v[40:43], v[236:239], v[88:91]
    v_mfma_f32_16x16x32_bf16 v[84:87], v[44:47], v[232:235], v[84:87]
    v_mfma_f32_16x16x32_bf16 v[92:95], v[44:47], v[236:239], v[92:95]
    s_waitcnt lgkmcnt(4)
    v_mfma_f32_16x16x32_bf16 v[96:99], v[16:19], v[232:235], v[96:99]
    v_mfma_f32_16x16x32_bf16 v[104:107], v[16:19], v[236:239], v[104:107]
    v_mfma_f32_16x16x32_bf16 v[100:103], v[20:23], v[232:235], v[100:103]
    v_mfma_f32_16x16x32_bf16 v[108:111], v[20:23], v[236:239], v[108:111]
    s_nop 1
    s_waitcnt lgkmcnt(0)
    v_mfma_f32_16x16x32_bf16 v[112:115], v[24:27], v[232:235], v[112:115]
    v_mfma_f32_16x16x32_bf16 v[120:123], v[24:27], v[236:239], v[120:123]
    v_mfma_f32_16x16x32_bf16 v[116:119], v[28:31], v[232:235], v[116:119]
    v_mfma_f32_16x16x32_bf16 v[124:127], v[28:31], v[236:239], v[124:127]
    ds_read_b128 v[32:35], v79 offset:640
    ds_read_b128 v[36:39], v79 offset:704
    ds_read_b128 v[40:43], v79 offset:768
    ds_read_b128 v[44:47], v79 offset:832
    v_mul_f32 v80, s50, v80
    v_mul_f32 v81, s50, v81
    v_mul_f32 v82, s50, v82
    v_mul_f32 v83, s50, v83
    v_mul_f32 v84, s50, v84
    v_mul_f32 v85, s50, v85
    v_mul_f32 v86, s50, v86
    v_mul_f32 v87, s50, v87
    v_mul_f32 v88, s50, v88
    v_mul_f32 v89, s50, v89
    v_mul_f32 v90, s50, v90
    v_mul_f32 v91, s50, v91
    v_mul_f32 v92, s50, v92
    v_mul_f32 v93, s50, v93
    v_mul_f32 v94, s50, v94
    v_mul_f32 v95, s50, v95
    v_cvt_pk_bf16_f32 v52, v80, v81
    v_cvt_pk_bf16_f32 v53, v82, v83
    v_cvt_pk_bf16_f32 v56, v88, v89
    v_cvt_pk_bf16_f32 v57, v90, v91
    s_mov_b32 exec_hi, 0xffff
    v_cvt_pk_bf16_f32 v54, v84, v85
    v_cvt_pk_bf16_f32 v55, v86, v87
    v_cvt_pk_bf16_f32 v58, v92, v93
    v_cvt_pk_bf16_f32 v59, v94, v95
    s_mov_b32 exec_hi, -1
    buffer_store_dwordx4 v[52:55], v14, s[28:31], s54 offen sc1
    buffer_store_dwordx4 v[56:59], v14, s[28:31], s54 offen offset:256 sc1
    v_cvt_pk_bf16_f32 v60, v96, v97
    v_cvt_pk_bf16_f32 v61, v98, v99
    v_cvt_pk_bf16_f32 v64, v104, v105
    v_cvt_pk_bf16_f32 v65, v106, v107
    s_mov_b32 exec_hi, 0xffff
    v_cvt_pk_bf16_f32 v62, v100, v101
    v_cvt_pk_bf16_f32 v63, v102, v103
    v_cvt_pk_bf16_f32 v66, v108, v109
    v_cvt_pk_bf16_f32 v67, v110, v111
    s_mov_b32 exec_hi, -1
    buffer_store_dwordx4 v[60:63], v14, s[28:31], s55 offen sc1
    buffer_store_dwordx4 v[64:67], v14, s[28:31], s55 offen offset:256 sc1
    v_cvt_pk_bf16_f32 v68, v112, v113
    v_cvt_pk_bf16_f32 v69, v114, v115
    v_cvt_pk_bf16_f32 v72, v120, v121
    v_cvt_pk_bf16_f32 v73, v122, v123
    s_mov_b32 exec_hi, 0xffff
    v_cvt_pk_bf16_f32 v70, v116, v117
    v_cvt_pk_bf16_f32 v71, v118, v119
    v_cvt_pk_bf16_f32 v74, v124, v125
    v_cvt_pk_bf16_f32 v75, v126, v127
    s_mov_b32 exec_hi, -1
    buffer_store_dwordx4 v[68:71], v14, s[28:31], s17 offen sc1
    buffer_store_dwordx4 v[72:75], v14, s[28:31], s17 offen offset:256 sc1
    s_waitcnt lgkmcnt(0)
    v_mfma_f32_16x16x32_bf16 v[240:243], v[32:35], v[208:211], v[240:243]
    v_mfma_f32_16x16x32_bf16 v[244:247], v[32:35], v[212:215], v[244:247]
    v_mfma_f32_16x16x32_bf16 v[240:243], v[36:39], v[216:219], v[240:243]
    v_mfma_f32_16x16x32_bf16 v[244:247], v[36:39], v[220:223], v[244:247]
    v_mfma_f32_16x16x32_bf16 v[240:243], v[40:43], v[224:227], v[240:243]
    v_mfma_f32_16x16x32_bf16 v[244:247], v[40:43], v[228:231], v[244:247]
    v_mfma_f32_16x16x32_bf16 v[240:243], v[44:47], v[232:235], v[240:243]
    v_mfma_f32_16x16x32_bf16 v[244:247], v[44:47], v[236:239], v[244:247]
    s_barrier
    ds_read_b64_tr_b16 v[16:17], v6 offset:0
    ds_read_b64_tr_b16 v[18:19], v6 offset:176
    ds_read_b64_tr_b16 v[20:21], v6 offset:32
    ds_read_b64_tr_b16 v[22:23], v6 offset:208
    ds_read_b64_tr_b16 v[24:25], v6 offset:56
    ds_read_b64_tr_b16 v[26:27], v6 offset:232
    ds_read_b64_tr_b16 v[28:29], v6 offset:88
    ds_read_b64_tr_b16 v[30:31], v6 offset:264
    ds_read_b64_tr_b16 v[32:33], v6 offset:112
    ds_read_b64_tr_b16 v[34:35], v6 offset:288
    ds_read_b64_tr_b16 v[36:37], v6 offset:144
    ds_read_b64_tr_b16 v[38:39], v6 offset:320
    s_waitcnt lgkmcnt(8)
    v_mfma_f32_16x16x32_bf16 v[80:83], v[16:19], v[128:131], 0
    ds_read_b64_tr_b16 v[40:41], v6 offset:5632
    v_mfma_f32_16x16x32_bf16 v[88:91], v[16:19], v[132:135], 0
    ds_read_b64_tr_b16 v[42:43], v6 offset:5808
    v_mfma_f32_16x16x32_bf16 v[84:87], v[20:23], v[128:131], 0
    ds_read_b64_tr_b16 v[44:45], v6 offset:5664
    v_mfma_f32_16x16x32_bf16 v[92:95], v[20:23], v[132:135], 0
    ds_read_b64_tr_b16 v[46:47], v6 offset:5840
    s_waitcnt lgkmcnt(8)
    v_mfma_f32_16x16x32_bf16 v[96:99], v[24:27], v[128:131], 0
    ds_read_b64_tr_b16 v[16:17], v6 offset:5688
    v_mfma_f32_16x16x32_bf16 v[104:107], v[24:27], v[132:135], 0
    ds_read_b64_tr_b16 v[18:19], v6 offset:5864
    v_mfma_f32_16x16x32_bf16 v[100:103], v[28:31], v[128:131], 0
    ds_read_b64_tr_b16 v[20:21], v6 offset:5720
    v_mfma_f32_16x16x32_bf16 v[108:111], v[28:31], v[132:135], 0
    ds_read_b64_tr_b16 v[22:23], v6 offset:5896
    s_waitcnt lgkmcnt(8)
    v_mfma_f32_16x16x32_bf16 v[112:115], v[32:35], v[128:131], 0
    ds_read_b64_tr_b16 v[24:25], v6 offset:5744
    v_mfma_f32_16x16x32_bf16 v[120:123], v[32:35], v[132:135], 0
    ds_read_b64_tr_b16 v[26:27], v6 offset:5920
    v_mfma_f32_16x16x32_bf16 v[116:119], v[36:39], v[128:131], 0
    ds_read_b64_tr_b16 v[28:29], v6 offset:5776
    v_mfma_f32_16x16x32_bf16 v[124:127], v[36:39], v[132:135], 0
    ds_read_b64_tr_b16 v[30:31], v6 offset:5952
    s_waitcnt lgkmcnt(8)
    v_mfma_f32_16x16x32_bf16 v[80:83], v[40:43], v[136:139], v[80:83]
    ds_read_b64_tr_b16 v[32:33], v6 offset:12288
    v_mfma_f32_16x16x32_bf16 v[88:91], v[40:43], v[140:143], v[88:91]
    ds_read_b64_tr_b16 v[34:35], v6 offset:12464
    v_mfma_f32_16x16x32_bf16 v[84:87], v[44:47], v[136:139], v[84:87]
    ds_read_b64_tr_b16 v[36:37], v6 offset:12320
    v_mfma_f32_16x16x32_bf16 v[92:95], v[44:47], v[140:143], v[92:95]
    ds_read_b64_tr_b16 v[38:39], v6 offset:12496
    s_waitcnt lgkmcnt(8)
    v_mfma_f32_16x16x32_bf16 v[96:99], v[16:19], v[136:139], v[96:99]
    ds_read_b64_tr_b16 v[40:41], v6 offset:12344
    v_mfma_f32_16x16x32_bf16 v[104:107], v[16:19], v[140:143], v[104:107]
    ds_read_b64_tr_b16 v[42:43], v6 offset:12520
    v_mfma_f32_16x16x32_bf16 v[100:103], v[20:23], v[136:139], v[100:103]
    ds_read_b64_tr_b16 v[44:45], v6 offset:12376
    v_mfma_f32_16x16x32_bf16 v[108:111], v[20:23], v[140:143], v[108:111]
    ds_read_b64_tr_b16 v[46:47], v6 offset:12552
    s_waitcnt lgkmcnt(8)
    v_mfma_f32_16x16x32_bf16 v[112:115], v[24:27], v[136:139], v[112:115]
    ds_read_b64_tr_b16 v[16:17], v6 offset:12400
    v_mfma_f32_16x16x32_bf16 v[120:123], v[24:27], v[140:143], v[120:123]
    ds_read_b64_tr_b16 v[18:19], v6 offset:12576
    v_mfma_f32_16x16x32_bf16 v[116:119], v[28:31], v[136:139], v[116:119]
    ds_read_b64_tr_b16 v[20:21], v6 offset:12432
    v_mfma_f32_16x16x32_bf16 v[124:127], v[28:31], v[140:143], v[124:127]
    ds_read_b64_tr_b16 v[22:23], v6 offset:12608
    s_waitcnt lgkmcnt(8)
    v_mfma_f32_16x16x32_bf16 v[80:83], v[32:35], v[144:147], v[80:83]
    ds_read_b64_tr_b16 v[24:25], v6 offset:17920
    v_mfma_f32_16x16x32_bf16 v[88:91], v[32:35], v[148:151], v[88:91]
    ds_read_b64_tr_b16 v[26:27], v6 offset:18096
    v_mfma_f32_16x16x32_bf16 v[84:87], v[36:39], v[144:147], v[84:87]
    ds_read_b64_tr_b16 v[28:29], v6 offset:17952
    v_mfma_f32_16x16x32_bf16 v[92:95], v[36:39], v[148:151], v[92:95]
    ds_read_b64_tr_b16 v[30:31], v6 offset:18128
    s_waitcnt lgkmcnt(8)
    v_mfma_f32_16x16x32_bf16 v[96:99], v[40:43], v[144:147], v[96:99]
    ds_read_b64_tr_b16 v[32:33], v6 offset:17976
    v_mfma_f32_16x16x32_bf16 v[104:107], v[40:43], v[148:151], v[104:107]
    ds_read_b64_tr_b16 v[34:35], v6 offset:18152
    v_mfma_f32_16x16x32_bf16 v[100:103], v[44:47], v[144:147], v[100:103]
    ds_read_b64_tr_b16 v[36:37], v6 offset:18008
    v_mfma_f32_16x16x32_bf16 v[108:111], v[44:47], v[148:151], v[108:111]
    ds_read_b64_tr_b16 v[38:39], v6 offset:18184
    s_waitcnt lgkmcnt(8)
    v_mfma_f32_16x16x32_bf16 v[112:115], v[16:19], v[144:147], v[112:115]
    ds_read_b64_tr_b16 v[40:41], v6 offset:18032
    v_mfma_f32_16x16x32_bf16 v[120:123], v[16:19], v[148:151], v[120:123]
    ds_read_b64_tr_b16 v[42:43], v6 offset:18208
    v_mfma_f32_16x16x32_bf16 v[116:119], v[20:23], v[144:147], v[116:119]
    ds_read_b64_tr_b16 v[44:45], v6 offset:18064
    v_mfma_f32_16x16x32_bf16 v[124:127], v[20:23], v[148:151], v[124:127]
    ds_read_b64_tr_b16 v[46:47], v6 offset:18240
    s_waitcnt vmcnt(0)
    s_mov_b32 s61, 65536
go_a_lp_60:
    v_cmp_eq_u32 vcc, 0, v76
    s_sub_u32 s61, s61, 1
    s_cselect_b64 vcc, 0, vcc
    s_cbranch_vccz go_a_ok_59
    s_sleep 8
    buffer_load_dwordx2 v[76:77], off, s[96:99], 0 sc1
    s_waitcnt vmcnt(0)
    s_branch go_a_lp_60
go_a_ok_59:
    v_readfirstlane_b32 s100, v76
    v_readfirstlane_b32 s101, v77
    s_nop 1
    v_lshlrev_b32 v2, 3, v1
    v_mov_b32 v76, s100
    v_mov_b32 v77, s101
    s_mov_b64 exec, 0xffff
    buffer_store_dwordx2 v[76:77], v2, s[28:31], s52 offen sc1
    s_mov_b64 exec, -1
    s_waitcnt lgkmcnt(8)
    v_mfma_f32_16x16x32_bf16 v[80:83], v[24:27], v[152:155], v[80:83]
    ds_read_b64_tr_b16 v[16:17], v13 offset:24576
    v_mfma_f32_16x16x32_bf16 v[88:91], v[24:27], v[156:159], v[88:91]
    ds_read_b64_tr_b16 v[18:19], v13 offset:24752
    v_mfma_f32_16x16x32_bf16 v[84:87], v[28:31], v[152:155], v[84:87]
    ds_read_b64_tr_b16 v[20:21], v13 offset:24608
    v_mfma_f32_16x16x32_bf16 v[92:95], v[28:31], v[156:159], v[92:95]
    ds_read_b64_tr_b16 v[22:23], v13 offset:24784
    s_waitcnt lgkmcnt(8)
    v_mfma_f32_16x16x32_bf16 v[96:99], v[32:35], v[152:155], v[96:99]
    ds_read_b64_tr_b16 v[24:25], v13 offset:24632
    v_mfma_f32_16x16x32_bf16 v[104:107], v[32:35], v[156:159], v[104:107]
    ds_read_b64_tr_b16 v[26:27], v13 offset:24808
    v_mfma_f32_16x16x32_bf16 v[100:103], v[36:39], v[152:155], v[100:103]
    ds_read_b64_tr_b16 v[28:29], v13 offset:24664
    v_mfma_f32_16x16x32_bf16 v[108:111], v[36:39], v[156:159], v[108:111]
    ds_read_b64_tr_b16 v[30:31], v13 offset:24840
    s_waitcnt lgkmcnt(8)
    v_mfma_f32_16x16x32_bf16 v[112:115], v[40:43], v[152:155], v[112:115]
    ds_read_b64_tr_b16 v[32:33], v13 offset:24688
    v_mfma_f32_16x16x32_bf16 v[120:123], v[40:43], v[156:159], v[120:123]
    ds_read_b64_tr_b16 v[34:35], v13 offset:24864
    v_mfma_f32_16x16x32_bf16 v[116:119], v[44:47], v[152:155], v[116:119]
    ds_read_b64_tr_b16 v[36:37], v13 offset:24720
    v_mfma_f32_16x16x32_bf16 v[124:127], v[44:47], v[156:159], v[124:127]
    ds_read_b64_tr_b16 v[38:39], v13 offset:24896
    s_waitcnt lgkmcnt(8)
    v_mfma_f32_16x16x32_bf16 v[80:83], v[16:19], v[160:163], v[80:83]
    ds_read_b64_tr_b16 v[40:41], v13 offset:30208
    v_mfma_f32_16x16x32_bf16 v[88:91], v[16:19], v[164:167], v[88:91]
    ds_read_b64_tr_b16 v[42:43], v13 offset:30384
    v_mfma_f32_16x16x32_bf16 v[84:87], v[20:23], v[160:163], v[84:87]
    ds_read_b64_tr_b16 v[44:45], v13 offset:30240
    v_mfma_f32_16x16x32_bf16 v[92:95], v[20:23], v[164:167], v[92:95]
    ds_read_b64_tr_b16 v[46:47], v13 offset:30416
    s_waitcnt lgkmcnt(8)
    v_mfma_f32_16x16x32_bf16 v[96:99], v[24:27], v[160:163], v[96:99]
    ds_read_b64_tr_b16 v[16:17], v13 offset:30264
    v_mfma_f32_16x16x32_bf16 v[104:107], v[24:27], v[164:167], v[104:107]
    ds_read_b64_tr_b16 v[18:19], v13 offset:30440
    v_mfma_f32_16x16x32_bf16 v[100:103], v[28:31], v[160:163], v[100:103]
    ds_read_b64_tr_b16 v[20:21], v13 offset:30296
    v_mfma_f32_16x16x32_bf16 v[108:111], v[28:31], v[164:167], v[108:111]
    ds_read_b64_tr_b16 v[22:23], v13 offset:30472
    s_waitcnt lgkmcnt(8)
    v_mfma_f32_16x16x32_bf16 v[112:115], v[32:35], v[160:163], v[112:115]
    ds_read_b64_tr_b16 v[24:25], v13 offset:30320
    v_mfma_f32_16x16x32_bf16 v[120:123], v[32:35], v[164:167], v[120:123]
    ds_read_b64_tr_b16 v[26:27], v13 offset:30496
    v_mfma_f32_16x16x32_bf16 v[116:119], v[36:39], v[160:163], v[116:119]
    ds_read_b64_tr_b16 v[28:29], v13 offset:30352
    v_mfma_f32_16x16x32_bf16 v[124:127], v[36:39], v[164:167], v[124:127]
    ds_read_b64_tr_b16 v[30:31], v13 offset:30528
    s_waitcnt lgkmcnt(8)
    s_barrier
    v_mfma_f32_16x16x32_bf16 v[80:83], v[40:43], v[168:171], v[80:83]
    ds_read_b64_tr_b16 v[32:33], v5 offset:0
    v_mfma_f32_16x16x32_bf16 v[88:91], v[40:43], v[172:175], v[88:91]
    ds_read_b64_tr_b16 v[34:35], v5 offset:176
    v_mfma_f32_16x16x32_bf16 v[84:87], v[44:47], v[168:171], v[84:87]
    ds_read_b64_tr_b16 v[36:37], v5 offset:32
    v_mfma_f32_16x16x32_bf16 v[92:95], v[44:47], v[172:175], v[92:95]
    ds_read_b64_tr_b16 v[38:39], v5 offset:208
    s_waitcnt lgkmcnt(8)
    v_mfma_f32_16x16x32_bf16 v[96:99], v[16:19], v[168:171], v[96:99]
    ds_read_b64_tr_b16 v[40:41], v5 offset:56
    v_mfma_f32_16x16x32_bf16 v[104:107], v[16:19], v[172:175], v[104:107]
    ds_read_b64_tr_b16 v[42:43], v5 offset:232
    v_mfma_f32_16x16x32_bf16 v[100:103], v[20:23], v[168:171], v[100:103]
    ds_read_b64_tr_b16 v[44:45], v5 offset:88
    v_mfma_f32_16x16x32_bf16 v[108:111], v[20:23], v[172:175], v[108:111]
    ds_read_b64_tr_b16 v[46:47], v5 offset:264
    s_waitcnt lgkmcnt(8)
    v_mfma_f32_16x16x32_bf16 v[112:115], v[24:27], v[168:171], v[112:115]
    ds_read_b64_tr_b16 v[16:17], v5 offset:112
    v_mfma_f32_16x16x32_bf16 v[120:123], v[24:27], v[172:175], v[120:123]
    ds_read_b64_tr_b16 v[18:19], v5 offset:288
    v_mfma_f32_16x16x32_bf16 v[116:119], v[28:31], v[168:171], v[116:119]
    ds_read_b64_tr_b16 v[20:21], v5 offset:144
    v_mfma_f32_16x16x32_bf16 v[124:127], v[28:31], v[172:175], v[124:127]
    ds_read_b64_tr_b16 v[22:23], v5 offset:320
    s_waitcnt lgkmcnt(8)
    v_mfma_f32_16x16x32_bf16 v[80:83], v[32:35], v[176:179], v[80:83]
    ds_read_b64_tr_b16 v[24:25], v5 offset:5632
    v_mfma_f32_16x16x32_bf16 v[88:91], v[32:35], v[180:183], v[88:91]
    ds_read_b64_tr_b16 v[26:27], v5 offset:5808
    v_mfma_f32_16x16x32_bf16 v[84:87], v[36:39], v[176:179], v[84:87]
    ds_read_b64_tr_b16 v[28:29], v5 offset:5664
    v_mfma_f32_16x16x32_bf16 v[92:95], v[36:39], v[180:183], v[92:95]
    ds_read_b64_tr_b16 v[30:31], v5 offset:5840
    s_waitcnt lgkmcnt(8)
    v_mfma_f32_16x16x32_bf16 v[96:99], v[40:43], v[176:179], v[96:99]
    ds_read_b64_tr_b16 v[32:33], v5 offset:5688
    v_mfma_f32_16x16x32_bf16 v[104:107], v[40:43], v[180:183], v[104:107]
    ds_read_b64_tr_b16 v[34:35], v5 offset:5864
    v_mfma_f32_16x16x32_bf16 v[100:103], v[44:47], v[176:179], v[100:103]
    ds_read_b64_tr_b16 v[36:37], v5 offset:5720
    v_mfma_f32_16x16x32_bf16 v[108:111], v[44:47], v[180:183], v[108:111]
    ds_read_b64_tr_b16 v[38:39], v5 offset:5896
    s_waitcnt lgkmcnt(8)
    v_mfma_f32_16x16x32_bf16 v[112:115], v[16:19], v[176:179], v[112:115]
    ds_read_b64_tr_b16 v[40:41], v5 offset:5744
    v_mfma_f32_16x16x32_bf16 v[120:123], v[16:19], v[180:183], v[120:123]
    ds_read_b64_tr_b16 v[42:43], v5 offset:5920
    v_mfma_f32_16x16x32_bf16 v[116:119], v[20:23], v[176:179], v[116:119]
    ds_read_b64_tr_b16 v[44:45], v5 offset:5776
    v_mfma_f32_16x16x32_bf16 v[124:127], v[20:23], v[180:183], v[124:127]
    ds_read_b64_tr_b16 v[46:47], v5 offset:5952
    s_waitcnt lgkmcnt(8)
    v_mfma_f32_16x16x32_bf16 v[80:83], v[24:27], v[184:187], v[80:83]
    ds_read_b64_tr_b16 v[16:17], v13 offset:36864
    v_mfma_f32_16x16x32_bf16 v[88:91], v[24:27], v[188:191], v[88:91]
    ds_read_b64_tr_b16 v[18:19], v13 offset:37040
    v_mfma_f32_16x16x32_bf16 v[84:87], v[28:31], v[184:187], v[84:87]
    ds_read_b64_tr_b16 v[20:21], v13 offset:36896
    v_mfma_f32_16x16x32_bf16 v[92:95], v[28:31], v[188:191], v[92:95]
    ds_read_b64_tr_b16 v[22:23], v13 offset:37072
    s_waitcnt lgkmcnt(8)
    v_mfma_f32_16x16x32_bf16 v[96:99], v[32:35], v[184:187], v[96:99]
    ds_read_b64_tr_b16 v[24:25], v13 offset:36920
    v_mfma_f32_16x16x32_bf16 v[104:107], v[32:35], v[188:191], v[104:107]
    ds_read_b64_tr_b16 v[26:27], v13 offset:37096
    v_mfma_f32_16x16x32_bf16 v[100:103], v[36:39], v[184:187], v[100:103]
    ds_read_b64_tr_b16 v[28:29], v13 offset:36952
    v_mfma_f32_16x16x32_bf16 v[108:111], v[36:39], v[188:191], v[108:111]
    ds_read_b64_tr_b16 v[30:31], v13 offset:37128
    s_waitcnt lgkmcnt(8)
    v_mfma_f32_16x16x32_bf16 v[112:115], v[40:43], v[184:187], v[112:115]
    ds_read_b64_tr_b16 v[32:33], v13 offset:36976
    v_mfma_f32_16x16x32_bf16 v[120:123], v[40:43], v[188:191], v[120:123]
    ds_read_b64_tr_b16 v[34:35], v13 offset:37152
    v_mfma_f32_16x16x32_bf16 v[116:119], v[44:47], v[184:187], v[116:119]
    ds_read_b64_tr_b16 v[36:37], v13 offset:37008
    v_mfma_f32_16x16x32_bf16 v[124:127], v[44:47], v[188:191], v[124:127]
    ds_read_b64_tr_b16 v[38:39], v13 offset:37184
    s_waitcnt lgkmcnt(8)
    v_mfma_f32_16x16x32_bf16 v[80:83], v[16:19], v[192:195], v[80:83]
    ds_read_b64_tr_b16 v[40:41], v13 offset:42496
    v_mfma_f32_16x16x32_bf16 v[88:91], v[16:19], v[196:199], v[88:91]
    ds_read_b64_tr_b16 v[42:43], v13 offset:42672
    v_mfma_f32_16x16x32_bf16 v[84:87], v[20:23], v[192:195], v[84:87]
    ds_read_b64_tr_b16 v[44:45], v13 offset:42528
    v_mfma_f32_16x16x32_bf16 v[92:95], v[20:23], v[196:199], v[92:95]
    ds_read_b64_tr_b16 v[46:47], v13 offset:42704
    s_waitcnt lgkmcnt(8)
    v_mfma_f32_16x16x32_bf16 v[96:99], v[24:27], v[192:195], v[96:99]
    ds_read_b64_tr_b16 v[16:17], v13 offset:42552
    v_mfma_f32_16x16x32_bf16 v[104:107], v[24:27], v[196:199], v[104:107]
    ds_read_b64_tr_b16 v[18:19], v13 offset:42728
    v_mfma_f32_16x16x32_bf16 v[100:103], v[28:31], v[192:195], v[100:103]
    ds_read_b64_tr_b16 v[20:21], v13 offset:42584
    v_mfma_f32_16x16x32_bf16 v[108:111], v[28:31], v[196:199], v[108:111]
    ds_read_b64_tr_b16 v[22:23], v13 offset:42760
    s_waitcnt lgkmcnt(8)
    v_mfma_f32_16x16x32_bf16 v[112:115], v[32:35], v[192:195], v[112:115]
    ds_read_b64_tr_b16 v[24:25], v13 offset:42608
    v_mfma_f32_16x16x32_bf16 v[120:123], v[32:35], v[196:199], v[120:123]
    ds_read_b64_tr_b16 v[26:27], v13 offset:42784
    v_mfma_f32_16x16x32_bf16 v[116:119], v[36:39], v[192:195], v[116:119]
    ds_read_b64_tr_b16 v[28:29], v13 offset:42640
    v_mfma_f32_16x16x32_bf16 v[124:127], v[36:39], v[196:199], v[124:127]
    ds_read_b64_tr_b16 v[30:31], v13 offset:42816
    s_waitcnt lgkmcnt(8)
    s_barrier
    v_mfma_f32_16x16x32_bf16 v[80:83], v[40:43], v[200:203], v[80:83]
    ds_read_b64_tr_b16 v[32:33], v5 offset:32768
    v_mfma_f32_16x16x32_bf16 v[88:91], v[40:43], v[204:207], v[88:91]
    ds_read_b64_tr_b16 v[34:35], v5 offset:32944
    v_mfma_f32_16x16x32_bf16 v[84:87], v[44:47], v[200:203], v[84:87]
    ds_read_b64_tr_b16 v[36:37], v5 offset:32800
    v_mfma_f32_16x16x32_bf16 v[92:95], v[44:47], v[204:207], v[92:95]
    ds_read_b64_tr_b16 v[38:39], v5 offset:32976
    s_waitcnt lgkmcnt(8)
    v_mfma_f32_16x16x32_bf16 v[96:99], v[16:19], v[200:203], v[96:99]
    ds_read_b64_tr_b16 v[40:41], v5 offset:32824
    v_mfma_f32_16x16x32_bf16 v[104:107], v[16:19], v[204:207], v[104:107]
    ds_read_b64_tr_b16 v[42:43], v5 offset:33000
    v_mfma_f32_16x16x32_bf16 v[100:103], v[20:23], v[200:203], v[100:103]
    ds_read_b64_tr_b16 v[44:45], v5 offset:32856
    v_mfma_f32_16x16x32_bf16 v[108:111], v[20:23], v[204:207], v[108:111]
    ds_read_b64_tr_b16 v[46:47], v5 offset:33032
    s_waitcnt lgkmcnt(8)
    v_mfma_f32_16x16x32_bf16 v[112:115], v[24:27], v[200:203], v[112:115]
    ds_read_b64_tr_b16 v[16:17], v5 offset:32880
    v_mfma_f32_16x16x32_bf16 v[120:123], v[24:27], v[204:207], v[120:123]
    ds_read_b64_tr_b16 v[18:19], v5 offset:33056
    v_mfma_f32_16x16x32_bf16 v[116:119], v[28:31], v[200:203], v[116:119]
    ds_read_b64_tr_b16 v[20:21], v5 offset:32912
    v_mfma_f32_16x16x32_bf16 v[124:127], v[28:31], v[204:207], v[124:127]
    ds_read_b64_tr_b16 v[22:23], v5 offset:33088
    s_waitcnt lgkmcnt(8)
    v_mfma_f32_16x16x32_bf16 v[80:83], v[32:35], v[208:211], v[80:83]
    ds_read_b64_tr_b16 v[24:25], v5 offset:38400
    v_mfma_f32_16x16x32_bf16 v[88:91], v[32:35], v[212:215], v[88:91]
    ds_read_b64_tr_b16 v[26:27], v5 offset:38576
    v_mfma_f32_16x16x32_bf16 v[84:87], v[36:39], v[208:211], v[84:87]
    ds_read_b64_tr_b16 v[28:29], v5 offset:38432
    v_mfma_f32_16x16x32_bf16 v[92:95], v[36:39], v[212:215], v[92:95]
    ds_read_b64_tr_b16 v[30:31], v5 offset:38608
    s_waitcnt lgkmcnt(8)
    v_mfma_f32_16x16x32_bf16 v[96:99], v[40:43], v[208:211], v[96:99]
    ds_read_b64_tr_b16 v[32:33], v5 offset:38456
    v_mfma_f32_16x16x32_bf16 v[104:107], v[40:43], v[212:215], v[104:107]
    ds_read_b64_tr_b16 v[34:35], v5 offset:38632
    v_mfma_f32_16x16x32_bf16 v[100:103], v[44:47], v[208:211], v[100:103]
    ds_read_b64_tr_b16 v[36:37], v5 offset:38488
    v_mfma_f32_16x16x32_bf16 v[108:111], v[44:47], v[212:215], v[108:111]
    ds_read_b64_tr_b16 v[38:39], v5 offset:38664
    s_waitcnt lgkmcnt(8)
    v_mfma_f32_16x16x32_bf16 v[112:115], v[16:19], v[208:211], v[112:115]
    ds_read_b64_tr_b16 v[40:41], v5 offset:38512
    v_mfma_f32_16x16x32_bf16 v[120:123], v[16:19], v[212:215], v[120:123]
    ds_read_b64_tr_b16 v[42:43], v5 offset:38688
    v_mfma_f32_16x16x32_bf16 v[116:119], v[20:23], v[208:211], v[116:119]
    ds_read_b64_tr_b16 v[44:45], v5 offset:38544
    v_mfma_f32_16x16x32_bf16 v[124:127], v[20:23], v[212:215], v[124:127]
    ds_read_b64_tr_b16 v[46:47], v5 offset:38720
    s_waitcnt lgkmcnt(8)
    v_mfma_f32_16x16x32_bf16 v[80:83], v[24:27], v[216:219], v[80:83]
    ds_read_b64_tr_b16 v[16:17], v13 offset:49152
    v_mfma_f32_16x16x32_bf16 v[88:91], v[24:27], v[220:223], v[88:91]
    ds_read_b64_tr_b16 v[18:19], v13 offset:49328
    v_mfma_f32_16x16x32_bf16 v[84:87], v[28:31], v[216:219], v[84:87]
    ds_read_b64_tr_b16 v[20:21], v13 offset:49184
    v_mfma_f32_16x16x32_bf16 v[92:95], v[28:31], v[220:223], v[92:95]
    ds_read_b64_tr_b16 v[22:23], v13 offset:49360
    s_waitcnt lgkmcnt(8)
    v_mfma_f32_16x16x32_bf16 v[96:99], v[32:35], v[216:219], v[96:99]
    ds_read_b64_tr_b16 v[24:25], v13 offset:49208
    v_mfma_f32_16x16x32_bf16 v[104:107], v[32:35], v[220:223], v[104:107]
    ds_read_b64_tr_b16 v[26:27], v13 offset:49384
    v_mfma_f32_16x16x32_bf16 v[100:103], v[36:39], v[216:219], v[100:103]
    ds_read_b64_tr_b16 v[28:29], v13 offset:49240
    v_mfma_f32_16x16x32_bf16 v[108:111], v[36:39], v[220:223], v[108:111]
    ds_read_b64_tr_b16 v[30:31], v13 offset:49416
    s_waitcnt lgkmcnt(8)
    v_mfma_f32_16x16x32_bf16 v[112:115], v[40:43], v[216:219], v[112:115]
    ds_read_b64_tr_b16 v[32:33], v13 offset:49264
    v_mfma_f32_16x16x32_bf16 v[120:123], v[40:43], v[220:223], v[120:123]
    ds_read_b64_tr_b16 v[34:35], v13 offset:49440
    v_mfma_f32_16x16x32_bf16 v[116:119], v[44:47], v[216:219], v[116:119]
    ds_read_b64_tr_b16 v[36:37], v13 offset:49296
    v_mfma_f32_16x16x32_bf16 v[124:127], v[44:47], v[220:223], v[124:127]
    ds_read_b64_tr_b16 v[38:39], v13 offset:49472
    s_waitcnt lgkmcnt(8)
    v_mfma_f32_16x16x32_bf16 v[80:83], v[16:19], v[224:227], v[80:83]
    ds_read_b64_tr_b16 v[40:41], v13 offset:54784
    v_mfma_f32_16x16x32_bf16 v[88:91], v[16:19], v[228:231], v[88:91]
    ds_read_b64_tr_b16 v[42:43], v13 offset:54960
    v_mfma_f32_16x16x32_bf16 v[84:87], v[20:23], v[224:227], v[84:87]
    ds_read_b64_tr_b16 v[44:45], v13 offset:54816
    v_mfma_f32_16x16x32_bf16 v[92:95], v[20:23], v[228:231], v[92:95]
    ds_read_b64_tr_b16 v[46:47], v13 offset:54992
    s_waitcnt lgkmcnt(8)
    v_mfma_f32_16x16x32_bf16 v[96:99], v[24:27], v[224:227], v[96:99]
    ds_read_b64_tr_b16 v[16:17], v13 offset:54840
    v_mfma_f32_16x16x32_bf16 v[104:107], v[24:27], v[228:231], v[104:107]
    ds_read_b64_tr_b16 v[18:19], v13 offset:55016
    v_mfma_f32_16x16x32_bf16 v[100:103], v[28:31], v[224:227], v[100:103]
    ds_read_b64_tr_b16 v[20:21], v13 offset:54872
    v_mfma_f32_16x16x32_bf16 v[108:111], v[28:31], v[228:231], v[108:111]
    ds_read_b64_tr_b16 v[22:23], v13 offset:55048
    v_mov_b32 v194, 0
    v_mov_b32 v195, 0
    v_mov_b32 v198, 0
    v_mov_b32 v199, 0
    v_mov_b32 v202, 0x3f803f80
    v_mov_b32 v203, 0x3f80
    v_mov_b32 v206, 0x3f803f80
    v_mov_b32 v207, 0x3f80
    v_mov_b32 v210, 0x3f803f80
    v_mov_b32 v211, 0x3f80
    v_mov_b32 v214, 0x3f803f80
    v_mov_b32 v215, 0x3f80
    s_waitcnt lgkmcnt(8)
    v_mfma_f32_16x16x32_bf16 v[112:115], v[32:35], v[224:227], v[112:115]
    ds_read_b64_tr_b16 v[24:25], v13 offset:54896
    v_mfma_f32_16x16x32_bf16 v[120:123], v[32:35], v[228:231], v[120:123]
    ds_read_b64_tr_b16 v[26:27], v13 offset:55072
    v_mfma_f32_16x16x32_bf16 v[116:119], v[36:39], v[224:227], v[116:119]
    ds_read_b64_tr_b16 v[28:29], v13 offset:54928
    v_mfma_f32_16x16x32_bf16 v[124:127], v[36:39], v[228:231], v[124:127]
    ds_read_b64_tr_b16 v[30:31], v13 offset:55104
    s_waitcnt lgkmcnt(8)
    v_mfma_f32_16x16x32_bf16 v[80:83], v[40:43], v[232:235], v[80:83]
    v_mfma_f32_16x16x32_bf16 v[88:91], v[40:43], v[236:239], v[88:91]
    v_mfma_f32_16x16x32_bf16 v[84:87], v[44:47], v[232:235], v[84:87]
    v_mfma_f32_16x16x32_bf16 v[92:95], v[44:47], v[236:239], v[92:95]
    s_waitcnt lgkmcnt(4)
    v_mfma_f32_16x16x32_bf16 v[96:99], v[16:19], v[232:235], v[96:99]
    v_mfma_f32_16x16x32_bf16 v[104:107], v[16:19], v[236:239], v[104:107]
    v_mfma_f32_16x16x32_bf16 v[100:103], v[20:23], v[232:235], v[100:103]
    v_mfma_f32_16x16x32_bf16 v[108:111], v[20:23], v[236:239], v[108:111]
    s_nop 1
    s_waitcnt lgkmcnt(0)
    v_mfma_f32_16x16x32_bf16 v[112:115], v[24:27], v[232:235], v[112:115]
    v_mfma_f32_16x16x32_bf16 v[120:123], v[24:27], v[236:239], v[120:123]
    v_mfma_f32_16x16x32_bf16 v[116:119], v[28:31], v[232:235], v[116:119]
    v_mfma_f32_16x16x32_bf16 v[124:127], v[28:31], v[236:239], v[124:127]
    v_mul_f32 v80, s50, v80
    v_mul_f32 v81, s50, v81
    v_mul_f32 v82, s50, v82
    v_mul_f32 v83, s50, v83
    v_mul_f32 v84, s50, v84
    v_mul_f32 v85, s50, v85
    v_mul_f32 v86, s50, v86
    v_mul_f32 v87, s50, v87
    v_mul_f32 v88, s50, v88
    v_mul_f32 v89, s50, v89
    v_mul_f32 v90, s50, v90
    v_mul_f32 v91, s50, v91
    v_mul_f32 v92, s50, v92
    v_mul_f32 v93, s50, v93
    v_mul_f32 v94, s50, v94
    v_mul_f32 v95, s50, v95
    v_cvt_pk_bf16_f32 v192, v80, v81
    v_cvt_pk_bf16_f32 v193, v82, v83
    v_cvt_pk_bf16_f32 v196, v88, v89
    v_cvt_pk_bf16_f32 v197, v90, v91
    s_mov_b32 exec_hi, 0xffff
    v_cvt_pk_bf16_f32 v194, v84, v85
    v_cvt_pk_bf16_f32 v195, v86, v87
    v_cvt_pk_bf16_f32 v198, v92, v93
    v_cvt_pk_bf16_f32 v199, v94, v95
    s_mov_b32 exec_hi, -1
    v_cvt_pk_bf16_f32 v200, v96, v97
    v_cvt_pk_bf16_f32 v201, v98, v99
    v_cvt_pk_bf16_f32 v204, v104, v105
    v_cvt_pk_bf16_f32 v205, v106, v107
    s_mov_b32 exec_hi, 0xffff
    v_cvt_pk_bf16_f32 v202, v100, v101
    v_cvt_pk_bf16_f32 v203, v102, v103
    v_cvt_pk_bf16_f32 v206, v108, v109
    v_cvt_pk_bf16_f32 v207, v110, v111
    s_mov_b32 exec_hi, -1
    v_cvt_pk_bf16_f32 v208, v112, v113
    v_cvt_pk_bf16_f32 v209, v114, v115
    v_cvt_pk_bf16_f32 v212, v120, v121
    v_cvt_pk_bf16_f32 v213, v122, v123
    s_mov_b32 exec_hi, 0xffff
    v_cvt_pk_bf16_f32 v210, v116, v117
    v_cvt_pk_bf16_f32 v211, v118, v119
    v_cvt_pk_bf16_f32 v214, v124, v125
    v_cvt_pk_bf16_f32 v215, v126, v127
    s_mov_b32 exec_hi, -1
    v_mov_b32 v216, v14
    s_branch L_a_attn
P1B_KKK:
    s_mul_i32 s36, s33, 168
    s_and_b32 s37, s36, 15
    s_sub_u32 s36, s36, s37
    v_and_b32 v3, 15, v1
    v_lshrrev_b32 v4, 4, v1
    v_lshrrev_b32 v5, 1, v3
    v_xor_b32 v5, v5, v4
    s_lshl_b32 s40, s34, 12
    v_lshl_add_u32 v6, v3, 7, s40
    v_lshl_add_u32 v8, v5, 4, v6
    v_xor_b32 v9, 64, v8
    v_bfe_u32 v5, v1, 2, 2
    v_lshl_add_u32 v5, v4, 2, v5
    v_mul_u32_u24 v5, 352, v5
    v_and_b32 v6, 3, v1
    v_lshl_add_u32 v5, v6, 3, v5
    s_add_u32 s40, s37, 98304
    v_add_u32 v12, s40, v5
    v_lshlrev_b32 v79, 4, v4
    v_add_u32 v79, 159744, v79
    v_mov_b32 v2, 163840
    s_mov_b32 vcc_lo, 0x00010001
    s_mov_b32 vcc_hi, 0x00010001
    v_cndmask_b32 v79, v2, v79, vcc
    s_waitcnt lgkmcnt(0)
    s_mov_b32 s96, s20
    s_and_b32 s97, s21, 0xffff
    s_mov_b32 s98, 256
    s_mov_b32 s99, 0x20000
    s_or_b32 s53, s2, s34
    s_cbranch_scc1 notag_61
    s_memrealtime s[100:101]
    s_waitcnt lgkmcnt(0)
    s_lshl_b64 s[100:101], s[100:101], 1
    s_or_b32 s100, s100, 1
    v_mov_b32 v76, s100
    v_mov_b32 v77, s101
    s_mov_b64 exec, 1
    buffer_store_dwordx2 v[76:77], off, s[96:99], 0 sc1
    s_mov_b64 exec, -1
notag_61:
    s_xor_b32 s62, s33, 1
    s_lshr_b32 s40, s33, 1
    s_cmp_eq_u32 s40, 2
    s_cselect_b32 s62, s33, s62
    s_cmp_eq_u32 s40, 5
    s_cselect_b32 s62, s33, s62
    s_mul_i32 s38, s62, 168
    s_and_b32 s39, s38, 15
    s_sub_u32 s38, s38, s39
    v_add_u32 v5, s39, v5
    v_add_u32 v13, 98304, v5
    v_add_u32 v6, 65536, v5
    v_lshlrev_b32 v2, 4, v3
    v_lshl_add_u32 v14, v4, 9, v2
    v_cmp_eq_u32 vcc, 12, v3
    v_mov_b32 v2, 0x3f803f80
    s_mov_b32 s50, 1049335798
    s_mov_b32 s51, 1049335798
    v_cndmask_b32 v7, 0, v2, vcc
    s_lshl_b32 s39, s35, 12
    s_lshl_b32 s40, s32, 2
    s_add_u32 s40, s40, s35
    s_mov_b32 s60, 0
    s_lshl_b32 s41, s33, 6
    s_add_u32 s41, s41, s40
    s_lshl_b32 s41, s41, 11
    s_add_u32 s41, s41, 8388608
    s_add_u32 s42, s41, 2097152
    s_lshl_b32 s45, s40, 5
    s_add_u32 s45, s45, s33
    s_lshl_b32 s43, s45, 11
    s_add_u32 s43, s43, 12582912
    s_add_u32 s44, s43, 32768
    s_lshl_b32 s45, s45, 7
    s_add_u32 s45, s45, 21233664
    s_mov_b32 s56, 1400897536
    s_mov_b32 s57, 729808896
    s_lshr_b32 s38, s2, 3
    s_mul_i32 s36, s38, 37
    s_lshr_b32 s36, s36, 8
    s_mul_i32 s37, s36, 7
    s_sub_u32 s37, s38, s37
    s_and_b32 s46, s2, 1
    s_lshl_b32 s46, s46, 4
    s_add_u32 s36, s36, s46
    s_and_b32 s46, s2, 6
    s_lshl_b32 s46, s46, 1
    s_add_u32 s36, s36, s46
    s_cmp_eq_u32 s35, 3
    s_cselect_b32 s49, 4294952960, 0
    s_lshl_b32 s46, s62, 6
    s_add_u32 s46, s46, s40
    s_lshl_b32 s46, s46, 7
    s_add_u32 s3, s46, 20971520
    s_lshl_b32 s46, s33, 6
    s_add_u32 s46, s46, s40
    s_lshl_b32 s46, s46, 7
    s_add_u32 s52, s46, 21102592
    s_mov_b32 s28, s22
    s_and_b32 s29, s23, 0xffff
    s_mov_b32 s30, 22020096
    s_mov_b32 s31, 0x20000
    s_lshl_b32 s46, s33, 18
    s_add_u32 s10, s22, s46
    s_addc_u32 s11, s23, 0
    s_mov_b32 s64, s10
    s_and_b32 s65, s11, 0xffff
    s_mov_b32 s66, 262144
    s_mov_b32 s67, 0x20000
    s_add_u32 s10, s10, 4194304
    s_addc_u32 s11, s11, 0
    s_mov_b32 s68, s10
    s_and_b32 s69, s11, 0xffff
    s_mov_b32 s70, 262144
    s_mov_b32 s71, 0x20000
    s_mov_b32 s24, s14
    s_and_b32 s25, s15, 0xffff
    s_mov_b32 s26, 401408
    s_mov_b32 s27, 0x20000
    s_and_b32 s4, s34, 1
    s_lshr_b32 s5, s34, 1
    s_lshl_b32 s46, s36, 1
    s_add_u32 s46, s46, s4
    s_lshl_b32 s47, s46, 5
    s_xor_b32 s48, s5, 2
    s_lshl_b32 s48, s48, 3
    s_add_u32 s47, s47, s48
    s_lshl_b32 s6, s47, 11
    s_add_u32 s6, s6, 12582912
    s_lshl_b32 s7, s47, 7
    s_add_u32 s7, s7, 21233664
    s_mul_i32 s58, s33, 3
    s_add_u32 s61, s58, 0
    s_and_b32 s61, s61, 15
    s_lshl_b32 s61, s61, 6
    s_add_u32 s61, s61, s40
    s_lshl_b32 s61, s61, 12
    s_add_u32 s54, s61, 4194304
    s_add_u32 s61, s58, 1
    s_and_b32 s61, s61, 15
    s_lshl_b32 s61, s61, 6
    s_add_u32 s61, s61, s40
    s_lshl_b32 s61, s61, 12
    s_add_u32 s55, s61, 4194304
    s_add_u32 s61, s58, 2
    s_and_b32 s61, s61, 15
    s_lshl_b32 s61, s61, 6
    s_add_u32 s61, s61, s40
    s_lshl_b32 s61, s61, 12
    s_add_u32 s17, s61, 4194304
    s_mul_i32 s58, s62, 3
    s_add_u32 s61, s58, 0
    s_and_b32 s61, s61, 15
    s_lshl_b32 s61, s61, 6
    s_add_u32 s61, s61, s40
    s_lshl_b32 s61, s61, 12
    s_add_u32 s47, s61, 0
    s_add_u32 s61, s58, 1
    s_and_b32 s61, s61, 15
    s_lshl_b32 s61, s61, 6
    s_add_u32 s61, s61, s40
    s_lshl_b32 s61, s61, 12
    s_add_u32 s59, s61, 0
    s_add_u32 s61, s58, 2
    s_and_b32 s61, s61, 15
    s_lshl_b32 s61, s61, 6
    s_add_u32 s61, s61, s40
    s_lshl_b32 s61, s61, 12
    s_add_u32 s16, s61, 0
    v_mov_b32 v54, 0x3f803f80
    v_mov_b32 v55, 0x3f80
    v_mov_b32 v58, 0x3f803f80
    v_mov_b32 v59, 0x3f80
    v_mov_b32 v62, 0x3f803f80
    v_mov_b32 v63, 0x3f80
    v_mov_b32 v66, 0x3f803f80
    v_mov_b32 v67, 0x3f80
    v_mov_b32 v70, 0x3f803f80
    v_mov_b32 v71, 0x3f80
    v_mov_b32 v74, 0x3f803f80
    v_mov_b32 v75, 0x3f80
    s_barrier
    ds_read_b128 v[128:131], v8 offset:0
    ds_read_b128 v[132:135], v8 offset:2048
    ds_read_b64_tr_b16 v[16:17], v12 offset:0
    ds_read_b64_tr_b16 v[18:19], v12 offset:176
    ds_read_b64_tr_b16 v[20:21], v12 offset:32
    ds_read_b64_tr_b16 v[22:23], v12 offset:208
    ds_read_b64_tr_b16 v[24:25], v12 offset:56
    ds_read_b64_tr_b16 v[26:27], v12 offset:232
    ds_read_b64_tr_b16 v[28:29], v12 offset:88
    ds_read_b64_tr_b16 v[30:31], v12 offset:264
    ds_read_b64_tr_b16 v[32:33], v12 offset:112
    ds_read_b64_tr_b16 v[34:35], v12 offset:288
    ds_read_b64_tr_b16 v[36:37], v12 offset:144
    ds_read_b64_tr_b16 v[38:39], v12 offset:320
    ds_read_b128 v[160:163], v79 offset:0
    s_waitcnt lgkmcnt(9)
    v_mfma_f32_16x16x32_bf16 v[80:83], v[16:19], v[128:131], 0
    ds_read_b128 v[136:139], v9 offset:0
    ds_read_b128 v[140:143], v9 offset:2048
    v_mfma_f32_16x16x32_bf16 v[88:91], v[16:19], v[132:135], 0
    ds_read_b64_tr_b16 v[40:41], v12 offset:5632
    ds_read_b64_tr_b16 v[42:43], v12 offset:5808
    v_mfma_f32_16x16x32_bf16 v[84:87], v[20:23], v[128:131], 0
    ds_read_b64_tr_b16 v[44:45], v12 offset:5664
    v_mfma_f32_16x16x32_bf16 v[92:95], v[20:23], v[132:135], 0
    ds_read_b64_tr_b16 v[46:47], v12 offset:5840
    s_waitcnt lgkmcnt(11)
    v_mfma_f32_16x16x32_bf16 v[96:99], v[24:27], v[128:131], 0
    ds_read_b64_tr_b16 v[16:17], v12 offset:5688
    v_mfma_f32_16x16x32_bf16 v[104:107], v[24:27], v[132:135], 0
    ds_read_b64_tr_b16 v[18:19], v12 offset:5864
    v_mfma_f32_16x16x32_bf16 v[100:103], v[28:31], v[128:131], 0
    ds_read_b64_tr_b16 v[20:21], v12 offset:5720
    v_mfma_f32_16x16x32_bf16 v[108:111], v[28:31], v[132:135], 0
    ds_read_b64_tr_b16 v[22:23], v12 offset:5896
    s_waitcnt lgkmcnt(10)
    v_mfma_f32_16x16x32_bf16 v[112:115], v[32:35], v[128:131], 0
    ds_read_b64_tr_b16 v[24:25], v12 offset:5744
    ds_read_b64_tr_b16 v[26:27], v12 offset:5920
    v_mfma_f32_16x16x32_bf16 v[120:123], v[32:35], v[132:135], 0
    ds_read_b64_tr_b16 v[28:29], v12 offset:5776
    v_mfma_f32_16x16x32_bf16 v[116:119], v[36:39], v[128:131], 0
    ds_read_b64_tr_b16 v[30:31], v12 offset:5952
    v_mfma_f32_16x16x32_bf16 v[124:127], v[36:39], v[132:135], 0
    ds_read_b128 v[168:171], v79 offset:64
    v_mfma_f32_16x16x32_bf16 v[240:243], v[160:163], v[128:131], 0
    v_mfma_f32_16x16x32_bf16 v[244:247], v[160:163], v[132:135], 0
    s_waitcnt lgkmcnt(9)
    s_barrier
    v_mfma_f32_16x16x32_bf16 v[80:83], v[40:43], v[136:139], v[80:83]
    ds_read_b128 v[144:147], v8 offset:16384
    ds_read_b128 v[148:151], v8 offset:18432
    v_mfma_f32_16x16x32_bf16 v[88:91], v[40:43], v[140:143], v[88:91]
    ds_read_b64_tr_b16 v[32:33], v12 offset:12288
    ds_read_b64_tr_b16 v[34:35], v12 offset:12464
    v_mfma_f32_16x16x32_bf16 v[84:87], v[44:47], v[136:139], v[84:87]
    ds_read_b64_tr_b16 v[36:37], v12 offset:12320
    v_mfma_f32_16x16x32_bf16 v[92:95], v[44:47], v[140:143], v[92:95]
    ds_read_b64_tr_b16 v[38:39], v12 offset:12496
    s_waitcnt lgkmcnt(11)
    v_mfma_f32_16x16x32_bf16 v[96:99], v[16:19], v[136:139], v[96:99]
    ds_read_b64_tr_b16 v[40:41], v12 offset:12344
    v_mfma_f32_16x16x32_bf16 v[104:107], v[16:19], v[140:143], v[104:107]
    ds_read_b64_tr_b16 v[42:43], v12 offset:12520
    v_mfma_f32_16x16x32_bf16 v[100:103], v[20:23], v[136:139], v[100:103]
    ds_read_b64_tr_b16 v[44:45], v12 offset:12376
    v_mfma_f32_16x16x32_bf16 v[108:111], v[20:23], v[140:143], v[108:111]
    ds_read_b64_tr_b16 v[46:47], v12 offset:12552
    s_waitcnt lgkmcnt(10)
    v_mfma_f32_16x16x32_bf16 v[112:115], v[24:27], v[136:139], v[112:115]
    ds_read_b64_tr_b16 v[16:17], v12 offset:12400
    ds_read_b64_tr_b16 v[18:19], v12 offset:12576
    v_mfma_f32_16x16x32_bf16 v[120:123], v[24:27], v[140:143], v[120:123]
    ds_read_b64_tr_b16 v[20:21], v12 offset:12432
    v_mfma_f32_16x16x32_bf16 v[116:119], v[28:31], v[136:139], v[116:119]
    ds_read_b64_tr_b16 v[22:23], v12 offset:12608
    v_mfma_f32_16x16x32_bf16 v[124:127], v[28:31], v[140:143], v[124:127]
    ds_read_b128 v[176:179], v79 offset:128
    v_mfma_f32_16x16x32_bf16 v[240:243], v[168:171], v[136:139], v[240:243]
    v_mfma_f32_16x16x32_bf16 v[244:247], v[168:171], v[140:143], v[244:247]
    s_waitcnt lgkmcnt(9)
    v_mfma_f32_16x16x32_bf16 v[80:83], v[32:35], v[144:147], v[80:83]
    ds_read_b128 v[152:155], v9 offset:16384
    ds_read_b128 v[156:159], v9 offset:18432
    v_mfma_f32_16x16x32_bf16 v[88:91], v[32:35], v[148:151], v[88:91]
    ds_read_b64_tr_b16 v[24:25], v12 offset:17920
    ds_read_b64_tr_b16 v[26:27], v12 offset:18096
    v_mfma_f32_16x16x32_bf16 v[84:87], v[36:39], v[144:147], v[84:87]
    ds_read_b64_tr_b16 v[28:29], v12 offset:17952
    v_mfma_f32_16x16x32_bf16 v[92:95], v[36:39], v[148:151], v[92:95]
    ds_read_b64_tr_b16 v[30:31], v12 offset:18128
    s_waitcnt lgkmcnt(11)
    v_mfma_f32_16x16x32_bf16 v[96:99], v[40:43], v[144:147], v[96:99]
    ds_read_b64_tr_b16 v[32:33], v12 offset:17976
    v_mfma_f32_16x16x32_bf16 v[104:107], v[40:43], v[148:151], v[104:107]
    ds_read_b64_tr_b16 v[34:35], v12 offset:18152
    v_mfma_f32_16x16x32_bf16 v[100:103], v[44:47], v[144:147], v[100:103]
    ds_read_b64_tr_b16 v[36:37], v12 offset:18008
    v_mfma_f32_16x16x32_bf16 v[108:111], v[44:47], v[148:151], v[108:111]
    ds_read_b64_tr_b16 v[38:39], v12 offset:18184
    s_waitcnt lgkmcnt(10)
    v_mfma_f32_16x16x32_bf16 v[112:115], v[16:19], v[144:147], v[112:115]
    ds_read_b64_tr_b16 v[40:41], v12 offset:18032
    ds_read_b64_tr_b16 v[42:43], v12 offset:18208
    v_mfma_f32_16x16x32_bf16 v[120:123], v[16:19], v[148:151], v[120:123]
    ds_read_b64_tr_b16 v[44:45], v12 offset:18064
    v_mfma_f32_16x16x32_bf16 v[116:119], v[20:23], v[144:147], v[116:119]
    ds_read_b64_tr_b16 v[46:47], v12 offset:18240
    v_mfma_f32_16x16x32_bf16 v[124:127], v[20:23], v[148:151], v[124:127]
    ds_read_b128 v[184:187], v79 offset:192
    v_mfma_f32_16x16x32_bf16 v[240:243], v[176:179], v[144:147], v[240:243]
    v_mfma_f32_16x16x32_bf16 v[244:247], v[176:179], v[148:151], v[244:247]
    s_waitcnt lgkmcnt(9)
    s_barrier
    v_mfma_f32_16x16x32_bf16 v[80:83], v[24:27], v[152:155], v[80:83]
    ds_read_b128 v[160:163], v8 offset:32768
    ds_read_b128 v[164:167], v8 offset:34816
    v_mfma_f32_16x16x32_bf16 v[88:91], v[24:27], v[156:159], v[88:91]
    ds_read_b64_tr_b16 v[16:17], v12 offset:24576
    ds_read_b64_tr_b16 v[18:19], v12 offset:24752
    v_mfma_f32_16x16x32_bf16 v[84:87], v[28:31], v[152:155], v[84:87]
    ds_read_b64_tr_b16 v[20:21], v12 offset:24608
    v_mfma_f32_16x16x32_bf16 v[92:95], v[28:31], v[156:159], v[92:95]
    ds_read_b64_tr_b16 v[22:23], v12 offset:24784
    s_waitcnt lgkmcnt(11)
    v_mfma_f32_16x16x32_bf16 v[96:99], v[32:35], v[152:155], v[96:99]
    ds_read_b64_tr_b16 v[24:25], v12 offset:24632
    v_mfma_f32_16x16x32_bf16 v[104:107], v[32:35], v[156:159], v[104:107]
    ds_read_b64_tr_b16 v[26:27], v12 offset:24808
    v_mfma_f32_16x16x32_bf16 v[100:103], v[36:39], v[152:155], v[100:103]
    ds_read_b64_tr_b16 v[28:29], v12 offset:24664
    v_mfma_f32_16x16x32_bf16 v[108:111], v[36:39], v[156:159], v[108:111]
    ds_read_b64_tr_b16 v[30:31], v12 offset:24840
    s_waitcnt lgkmcnt(10)
    v_mfma_f32_16x16x32_bf16 v[112:115], v[40:43], v[152:155], v[112:115]
    ds_read_b64_tr_b16 v[32:33], v12 offset:24688
    ds_read_b64_tr_b16 v[34:35], v12 offset:24864
    v_mfma_f32_16x16x32_bf16 v[120:123], v[40:43], v[156:159], v[120:123]
    ds_read_b64_tr_b16 v[36:37], v12 offset:24720
    v_mfma_f32_16x16x32_bf16 v[116:119], v[44:47], v[152:155], v[116:119]
    ds_read_b64_tr_b16 v[38:39], v12 offset:24896
    v_mfma_f32_16x16x32_bf16 v[124:127], v[44:47], v[156:159], v[124:127]
    ds_read_b128 v[192:195], v79 offset:256
    v_mfma_f32_16x16x32_bf16 v[240:243], v[184:187], v[152:155], v[240:243]
    v_mfma_f32_16x16x32_bf16 v[244:247], v[184:187], v[156:159], v[244:247]
    s_waitcnt lgkmcnt(9)
    v_mfma_f32_16x16x32_bf16 v[80:83], v[16:19], v[160:163], v[80:83]
    ds_read_b128 v[168:171], v9 offset:32768
    ds_read_b128 v[172:175], v9 offset:34816
    v_mfma_f32_16x16x32_bf16 v[88:91], v[16:19], v[164:167], v[88:91]
    ds_read_b64_tr_b16 v[40:41], v12 offset:30208
    ds_read_b64_tr_b16 v[42:43], v12 offset:30384
    v_mfma_f32_16x16x32_bf16 v[84:87], v[20:23], v[160:163], v[84:87]
    ds_read_b64_tr_b16 v[44:45], v12 offset:30240
    v_mfma_f32_16x16x32_bf16 v[92:95], v[20:23], v[164:167], v[92:95]
    ds_read_b64_tr_b16 v[46:47], v12 offset:30416
    s_waitcnt lgkmcnt(11)
    v_mfma_f32_16x16x32_bf16 v[96:99], v[24:27], v[160:163], v[96:99]
    ds_read_b64_tr_b16 v[16:17], v12 offset:30264
    v_mfma_f32_16x16x32_bf16 v[104:107], v[24:27], v[164:167], v[104:107]
    ds_read_b64_tr_b16 v[18:19], v12 offset:30440
    v_mfma_f32_16x16x32_bf16 v[100:103], v[28:31], v[160:163], v[100:103]
    ds_read_b64_tr_b16 v[20:21], v12 offset:30296
    v_mfma_f32_16x16x32_bf16 v[108:111], v[28:31], v[164:167], v[108:111]
    ds_read_b64_tr_b16 v[22:23], v12 offset:30472
    s_waitcnt lgkmcnt(10)
    v_mfma_f32_16x16x32_bf16 v[112:115], v[32:35], v[160:163], v[112:115]
    ds_read_b64_tr_b16 v[24:25], v12 offset:30320
    ds_read_b64_tr_b16 v[26:27], v12 offset:30496
    v_mfma_f32_16x16x32_bf16 v[120:123], v[32:35], v[164:167], v[120:123]
    ds_read_b64_tr_b16 v[28:29], v12 offset:30352
    v_mfma_f32_16x16x32_bf16 v[116:119], v[36:39], v[160:163], v[116:119]
    ds_read_b64_tr_b16 v[30:31], v12 offset:30528
    v_mfma_f32_16x16x32_bf16 v[124:127], v[36:39], v[164:167], v[124:127]
    ds_read_b128 v[200:203], v79 offset:320
    v_mfma_f32_16x16x32_bf16 v[240:243], v[192:195], v[160:163], v[240:243]
    v_mfma_f32_16x16x32_bf16 v[244:247], v[192:195], v[164:167], v[244:247]
    v_lshlrev_b32 v2, 3, v1
    v_mov_b32 v76, 0
    v_mov_b32 v77, 0
    s_add_u32 s46, s45, 2048
    s_mov_b64 exec, 0xffff
    buffer_store_dwordx2 v[76:77], v2, s[28:31], s45 offen sc1
    s_mov_b64 exec, -1
    s_mov_b64 exec, 0xffff
    buffer_store_dwordx2 v[76:77], v2, s[28:31], s46 offen sc1
    s_mov_b64 exec, -1
    s_waitcnt lgkmcnt(9)
    s_barrier
    v_mfma_f32_16x16x32_bf16 v[80:83], v[40:43], v[168:171], v[80:83]
    ds_read_b128 v[176:179], v8 offset:49152
    ds_read_b128 v[180:183], v8 offset:51200
    v_mfma_f32_16x16x32_bf16 v[88:91], v[40:43], v[172:175], v[88:91]
    ds_read_b64_tr_b16 v[32:33], v12 offset:36864
    ds_read_b64_tr_b16 v[34:35], v12 offset:37040
    v_mfma_f32_16x16x32_bf16 v[84:87], v[44:47], v[168:171], v[84:87]
    ds_read_b64_tr_b16 v[36:37], v12 offset:36896
    v_mfma_f32_16x16x32_bf16 v[92:95], v[44:47], v[172:175], v[92:95]
    ds_read_b64_tr_b16 v[38:39], v12 offset:37072
    s_waitcnt lgkmcnt(11)
    v_mfma_f32_16x16x32_bf16 v[96:99], v[16:19], v[168:171], v[96:99]
    ds_read_b64_tr_b16 v[40:41], v12 offset:36920
    v_mfma_f32_16x16x32_bf16 v[104:107], v[16:19], v[172:175], v[104:107]
    ds_read_b64_tr_b16 v[42:43], v12 offset:37096
    v_mfma_f32_16x16x32_bf16 v[100:103], v[20:23], v[168:171], v[100:103]
    ds_read_b64_tr_b16 v[44:45], v12 offset:36952
    v_mfma_f32_16x16x32_bf16 v[108:111], v[20:23], v[172:175], v[108:111]
    ds_read_b64_tr_b16 v[46:47], v12 offset:37128
    s_waitcnt lgkmcnt(10)
    v_mfma_f32_16x16x32_bf16 v[112:115], v[24:27], v[168:171], v[112:115]
    ds_read_b64_tr_b16 v[16:17], v12 offset:36976
    ds_read_b64_tr_b16 v[18:19], v12 offset:37152
    v_mfma_f32_16x16x32_bf16 v[120:123], v[24:27], v[172:175], v[120:123]
    ds_read_b64_tr_b16 v[20:21], v12 offset:37008
    v_mfma_f32_16x16x32_bf16 v[116:119], v[28:31], v[168:171], v[116:119]
    ds_read_b64_tr_b16 v[22:23], v12 offset:37184
    v_mfma_f32_16x16x32_bf16 v[124:127], v[28:31], v[172:175], v[124:127]
    ds_read_b128 v[208:211], v79 offset:384
    v_mfma_f32_16x16x32_bf16 v[240:243], v[200:203], v[168:171], v[240:243]
    v_mfma_f32_16x16x32_bf16 v[244:247], v[200:203], v[172:175], v[244:247]
    s_waitcnt lgkmcnt(9)
    v_mfma_f32_16x16x32_bf16 v[80:83], v[32:35], v[176:179], v[80:83]
    ds_read_b128 v[184:187], v9 offset:49152
    ds_read_b128 v[188:191], v9 offset:51200
    v_mfma_f32_16x16x32_bf16 v[88:91], v[32:35], v[180:183], v[88:91]
    ds_read_b64_tr_b16 v[24:25], v12 offset:42496
    ds_read_b64_tr_b16 v[26:27], v12 offset:42672
    v_mfma_f32_16x16x32_bf16 v[84:87], v[36:39], v[176:179], v[84:87]
    ds_read_b64_tr_b16 v[28:29], v12 offset:42528
    v_mfma_f32_16x16x32_bf16 v[92:95], v[36:39], v[180:183], v[92:95]
    ds_read_b64_tr_b16 v[30:31], v12 offset:42704
    s_waitcnt lgkmcnt(11)
    v_mfma_f32_16x16x32_bf16 v[96:99], v[40:43], v[176:179], v[96:99]
    ds_read_b64_tr_b16 v[32:33], v12 offset:42552
    v_mfma_f32_16x16x32_bf16 v[104:107], v[40:43], v[180:183], v[104:107]
    ds_read_b64_tr_b16 v[34:35], v12 offset:42728
    v_mfma_f32_16x16x32_bf16 v[100:103], v[44:47], v[176:179], v[100:103]
    ds_read_b64_tr_b16 v[36:37], v12 offset:42584
    v_mfma_f32_16x16x32_bf16 v[108:111], v[44:47], v[180:183], v[108:111]
    ds_read_b64_tr_b16 v[38:39], v12 offset:42760
    s_waitcnt lgkmcnt(10)
    v_mfma_f32_16x16x32_bf16 v[112:115], v[16:19], v[176:179], v[112:115]
    ds_read_b64_tr_b16 v[40:41], v12 offset:42608
    ds_read_b64_tr_b16 v[42:43], v12 offset:42784
    v_mfma_f32_16x16x32_bf16 v[120:123], v[16:19], v[180:183], v[120:123]
    ds_read_b64_tr_b16 v[44:45], v12 offset:42640
    v_mfma_f32_16x16x32_bf16 v[116:119], v[20:23], v[176:179], v[116:119]
    ds_read_b64_tr_b16 v[46:47], v12 offset:42816
    v_mfma_f32_16x16x32_bf16 v[124:127], v[20:23], v[180:183], v[124:127]
    ds_read_b128 v[216:219], v79 offset:448
    v_mfma_f32_16x16x32_bf16 v[240:243], v[208:211], v[176:179], v[240:243]
    v_mfma_f32_16x16x32_bf16 v[244:247], v[208:211], v[180:183], v[244:247]
    s_waitcnt lgkmcnt(9)
    s_barrier
    v_mfma_f32_16x16x32_bf16 v[80:83], v[24:27], v[184:187], v[80:83]
    ds_read_b128 v[192:195], v8 offset:0
    ds_read_b128 v[196:199], v8 offset:2048
    v_mfma_f32_16x16x32_bf16 v[88:91], v[24:27], v[188:191], v[88:91]
    ds_read_b64_tr_b16 v[16:17], v12 offset:49152
    ds_read_b64_tr_b16 v[18:19], v12 offset:49328
    v_mfma_f32_16x16x32_bf16 v[84:87], v[28:31], v[184:187], v[84:87]
    ds_read_b64_tr_b16 v[20:21], v12 offset:49184
    v_mfma_f32_16x16x32_bf16 v[92:95], v[28:31], v[188:191], v[92:95]
    ds_read_b64_tr_b16 v[22:23], v12 offset:49360
    s_waitcnt lgkmcnt(11)
    v_mfma_f32_16x16x32_bf16 v[96:99], v[32:35], v[184:187], v[96:99]
    ds_read_b64_tr_b16 v[24:25], v12 offset:49208
    v_mfma_f32_16x16x32_bf16 v[104:107], v[32:35], v[188:191], v[104:107]
    ds_read_b64_tr_b16 v[26:27], v12 offset:49384
    v_mfma_f32_16x16x32_bf16 v[100:103], v[36:39], v[184:187], v[100:103]
    ds_read_b64_tr_b16 v[28:29], v12 offset:49240
    v_mfma_f32_16x16x32_bf16 v[108:111], v[36:39], v[188:191], v[108:111]
    ds_read_b64_tr_b16 v[30:31], v12 offset:49416
    buffer_load_dwordx2 v[76:77], off, s[96:99], 0 sc1
    s_waitcnt lgkmcnt(10)
    v_mfma_f32_16x16x32_bf16 v[112:115], v[40:43], v[184:187], v[112:115]
    ds_read_b64_tr_b16 v[32:33], v12 offset:49264
    ds_read_b64_tr_b16 v[34:35], v12 offset:49440
    v_mfma_f32_16x16x32_bf16 v[120:123], v[40:43], v[188:191], v[120:123]
    ds_read_b64_tr_b16 v[36:37], v12 offset:49296
    v_mfma_f32_16x16x32_bf16 v[116:119], v[44:47], v[184:187], v[116:119]
    ds_read_b64_tr_b16 v[38:39], v12 offset:49472
    v_mfma_f32_16x16x32_bf16 v[124:127], v[44:47], v[188:191], v[124:127]
    ds_read_b128 v[224:227], v79 offset:512
    v_mfma_f32_16x16x32_bf16 v[240:243], v[216:219], v[184:187], v[240:243]
    v_mfma_f32_16x16x32_bf16 v[244:247], v[216:219], v[188:191], v[244:247]
    s_waitcnt lgkmcnt(9)
    v_mfma_f32_16x16x32_bf16 v[80:83], v[16:19], v[192:195], v[80:83]
    ds_read_b128 v[200:203], v9 offset:0
    ds_read_b128 v[204:207], v9 offset:2048
    v_mfma_f32_16x16x32_bf16 v[88:91], v[16:19], v[196:199], v[88:91]
    ds_read_b64_tr_b16 v[40:41], v12 offset:54784
    ds_read_b64_tr_b16 v[42:43], v12 offset:54960
    v_mfma_f32_16x16x32_bf16 v[84:87], v[20:23], v[192:195], v[84:87]
    ds_read_b64_tr_b16 v[44:45], v12 offset:54816
    v_mfma_f32_16x16x32_bf16 v[92:95], v[20:23], v[196:199], v[92:95]
    ds_read_b64_tr_b16 v[46:47], v12 offset:54992
    s_waitcnt lgkmcnt(11)
    v_mfma_f32_16x16x32_bf16 v[96:99], v[24:27], v[192:195], v[96:99]
    ds_read_b64_tr_b16 v[16:17], v12 offset:54840
    v_mfma_f32_16x16x32_bf16 v[104:107], v[24:27], v[196:199], v[104:107]
    ds_read_b64_tr_b16 v[18:19], v12 offset:55016
    v_mfma_f32_16x16x32_bf16 v[100:103], v[28:31], v[192:195], v[100:103]
    ds_read_b64_tr_b16 v[20:21], v12 offset:54872
    v_mfma_f32_16x16x32_bf16 v[108:111], v[28:31], v[196:199], v[108:111]
    ds_read_b64_tr_b16 v[22:23], v12 offset:55048
    s_waitcnt lgkmcnt(10)
    v_mfma_f32_16x16x32_bf16 v[112:115], v[32:35], v[192:195], v[112:115]
    ds_read_b64_tr_b16 v[24:25], v12 offset:54896
    ds_read_b64_tr_b16 v[26:27], v12 offset:55072
    v_mfma_f32_16x16x32_bf16 v[120:123], v[32:35], v[196:199], v[120:123]
    ds_read_b64_tr_b16 v[28:29], v12 offset:54928
    v_mfma_f32_16x16x32_bf16 v[116:119], v[36:39], v[192:195], v[116:119]
    ds_read_b64_tr_b16 v[30:31], v12 offset:55104
    v_mfma_f32_16x16x32_bf16 v[124:127], v[36:39], v[196:199], v[124:127]
    ds_read_b128 v[232:235], v79 offset:576
    v_mfma_f32_16x16x32_bf16 v[240:243], v[224:227], v[192:195], v[240:243]
    v_mfma_f32_16x16x32_bf16 v[244:247], v[224:227], v[196:199], v[244:247]
    s_waitcnt lgkmcnt(9)
    s_barrier
    v_mfma_f32_16x16x32_bf16 v[80:83], v[40:43], v[200:203], v[80:83]
    ds_read_b128 v[208:211], v8 offset:16384
    ds_read_b128 v[212:215], v8 offset:18432
    v_mfma_f32_16x16x32_bf16 v[88:91], v[40:43], v[204:207], v[88:91]
    ds_read_b64_tr_b16 v[32:33], v12 offset:0
    ds_read_b64_tr_b16 v[34:35], v12 offset:176
    v_mfma_f32_16x16x32_bf16 v[84:87], v[44:47], v[200:203], v[84:87]
    ds_read_b64_tr_b16 v[36:37], v12 offset:32
    v_mfma_f32_16x16x32_bf16 v[92:95], v[44:47], v[204:207], v[92:95]
    ds_read_b64_tr_b16 v[38:39], v12 offset:208
    s_waitcnt lgkmcnt(11)
    v_mfma_f32_16x16x32_bf16 v[96:99], v[16:19], v[200:203], v[96:99]
    ds_read_b64_tr_b16 v[40:41], v12 offset:56
    v_mfma_f32_16x16x32_bf16 v[104:107], v[16:19], v[204:207], v[104:107]
    ds_read_b64_tr_b16 v[42:43], v12 offset:232
    v_mfma_f32_16x16x32_bf16 v[100:103], v[20:23], v[200:203], v[100:103]
    ds_read_b64_tr_b16 v[44:45], v12 offset:88
    v_mfma_f32_16x16x32_bf16 v[108:111], v[20:23], v[204:207], v[108:111]
    ds_read_b64_tr_b16 v[46:47], v12 offset:264
    s_waitcnt lgkmcnt(10)
    v_mfma_f32_16x16x32_bf16 v[112:115], v[24:27], v[200:203], v[112:115]
    ds_read_b64_tr_b16 v[16:17], v12 offset:112
    v_mfma_f32_16x16x32_bf16 v[120:123], v[24:27], v[204:207], v[120:123]
    ds_read_b64_tr_b16 v[18:19], v12 offset:288
    v_mfma_f32_16x16x32_bf16 v[116:119], v[28:31], v[200:203], v[116:119]
    ds_read_b64_tr_b16 v[20:21], v12 offset:144
    v_mfma_f32_16x16x32_bf16 v[124:127], v[28:31], v[204:207], v[124:127]
    ds_read_b64_tr_b16 v[22:23], v12 offset:320
    v_mfma_f32_16x16x32_bf16 v[240:243], v[232:235], v[200:203], v[240:243]
    v_mfma_f32_16x16x32_bf16 v[244:247], v[232:235], v[204:207], v[244:247]
    s_waitcnt lgkmcnt(8)
    v_mfma_f32_16x16x32_bf16 v[80:83], v[32:35], v[208:211], v[80:83]
    ds_read_b128 v[216:219], v9 offset:16384
    ds_read_b128 v[220:223], v9 offset:18432
    v_mfma_f32_16x16x32_bf16 v[88:91], v[32:35], v[212:215], v[88:91]
    ds_read_b64_tr_b16 v[24:25], v12 offset:5632
    ds_read_b64_tr_b16 v[26:27], v12 offset:5808
    v_mfma_f32_16x16x32_bf16 v[84:87], v[36:39], v[208:211], v[84:87]
    ds_read_b64_tr_b16 v[28:29], v12 offset:5664
    v_mfma_f32_16x16x32_bf16 v[92:95], v[36:39], v[212:215], v[92:95]
    ds_read_b64_tr_b16 v[30:31], v12 offset:5840
    s_waitcnt lgkmcnt(10)
    v_mfma_f32_16x16x32_bf16 v[96:99], v[40:43], v[208:211], v[96:99]
    ds_read_b64_tr_b16 v[32:33], v12 offset:5688
    v_mfma_f32_16x16x32_bf16 v[104:107], v[40:43], v[212:215], v[104:107]
    ds_read_b64_tr_b16 v[34:35], v12 offset:5864
    v_mfma_f32_16x16x32_bf16 v[100:103], v[44:47], v[208:211], v[100:103]
    ds_read_b64_tr_b16 v[36:37], v12 offset:5720
    v_mfma_f32_16x16x32_bf16 v[108:111], v[44:47], v[212:215], v[108:111]
    ds_read_b64_tr_b16 v[38:39], v12 offset:5896
    s_waitcnt lgkmcnt(10)
    v_mfma_f32_16x16x32_bf16 v[112:115], v[16:19], v[208:211], v[112:115]
    ds_read_b64_tr_b16 v[40:41], v12 offset:5744
    v_mfma_f32_16x16x32_bf16 v[120:123], v[16:19], v[212:215], v[120:123]
    ds_read_b64_tr_b16 v[42:43], v12 offset:5920
    v_mfma_f32_16x16x32_bf16 v[116:119], v[20:23], v[208:211], v[116:119]
    ds_read_b64_tr_b16 v[44:45], v12 offset:5776
    v_mfma_f32_16x16x32_bf16 v[124:127], v[20:23], v[212:215], v[124:127]
    ds_read_b64_tr_b16 v[46:47], v12 offset:5952
    s_waitcnt lgkmcnt(8)
    s_barrier
    v_mfma_f32_16x16x32_bf16 v[80:83], v[24:27], v[216:219], v[80:83]
    ds_read_b128 v[224:227], v8 offset:32768
    ds_read_b128 v[228:231], v8 offset:34816
    v_mfma_f32_16x16x32_bf16 v[88:91], v[24:27], v[220:223], v[88:91]
    ds_read_b64_tr_b16 v[16:17], v12 offset:12288
    ds_read_b64_tr_b16 v[18:19], v12 offset:12464
    v_mfma_f32_16x16x32_bf16 v[84:87], v[28:31], v[216:219], v[84:87]
    ds_read_b64_tr_b16 v[20:21], v12 offset:12320
    v_mfma_f32_16x16x32_bf16 v[92:95], v[28:31], v[220:223], v[92:95]
    ds_read_b64_tr_b16 v[22:23], v12 offset:12496
    s_waitcnt lgkmcnt(10)
    v_mfma_f32_16x16x32_bf16 v[96:99], v[32:35], v[216:219], v[96:99]
    ds_read_b64_tr_b16 v[24:25], v12 offset:12344
    v_mfma_f32_16x16x32_bf16 v[104:107], v[32:35], v[220:223], v[104:107]
    ds_read_b64_tr_b16 v[26:27], v12 offset:12520
    v_mfma_f32_16x16x32_bf16 v[100:103], v[36:39], v[216:219], v[100:103]
    ds_read_b64_tr_b16 v[28:29], v12 offset:12376
    v_mfma_f32_16x16x32_bf16 v[108:111], v[36:39], v[220:223], v[108:111]
    ds_read_b64_tr_b16 v[30:31], v12 offset:12552
    s_waitcnt lgkmcnt(10)
    v_mfma_f32_16x16x32_bf16 v[112:115], v[40:43], v[216:219], v[112:115]
    ds_read_b64_tr_b16 v[32:33], v12 offset:12400
    v_mfma_f32_16x16x32_bf16 v[120:123], v[40:43], v[220:223], v[120:123]
    ds_read_b64_tr_b16 v[34:35], v12 offset:12576
    v_mfma_f32_16x16x32_bf16 v[116:119], v[44:47], v[216:219], v[116:119]
    ds_read_b64_tr_b16 v[36:37], v12 offset:12432
    v_mfma_f32_16x16x32_bf16 v[124:127], v[44:47], v[220:223], v[124:127]
    ds_read_b64_tr_b16 v[38:39], v12 offset:12608
    s_waitcnt lgkmcnt(8)
    v_mfma_f32_16x16x32_bf16 v[80:83], v[16:19], v[224:227], v[80:83]
    ds_read_b128 v[232:235], v9 offset:32768
    ds_read_b128 v[236:239], v9 offset:34816
    v_mfma_f32_16x16x32_bf16 v[88:91], v[16:19], v[228:231], v[88:91]
    ds_read_b64_tr_b16 v[40:41], v12 offset:17920
    ds_read_b64_tr_b16 v[42:43], v12 offset:18096
    v_mfma_f32_16x16x32_bf16 v[84:87], v[20:23], v[224:227], v[84:87]
    ds_read_b64_tr_b16 v[44:45], v12 offset:17952
    v_mfma_f32_16x16x32_bf16 v[92:95], v[20:23], v[228:231], v[92:95]
    ds_read_b64_tr_b16 v[46:47], v12 offset:18128
    s_waitcnt lgkmcnt(10)
    v_mfma_f32_16x16x32_bf16 v[96:99], v[24:27], v[224:227], v[96:99]
    ds_read_b64_tr_b16 v[16:17], v12 offset:17976
    v_mfma_f32_16x16x32_bf16 v[104:107], v[24:27], v[228:231], v[104:107]
    ds_read_b64_tr_b16 v[18:19], v12 offset:18152
    v_mfma_f32_16x16x32_bf16 v[100:103], v[28:31], v[224:227], v[100:103]
    ds_read_b64_tr_b16 v[20:21], v12 offset:18008
    v_mfma_f32_16x16x32_bf16 v[108:111], v[28:31], v[228:231], v[108:111]
    ds_read_b64_tr_b16 v[22:23], v12 offset:18184
    s_waitcnt lgkmcnt(10)
    v_mfma_f32_16x16x32_bf16 v[112:115], v[32:35], v[224:227], v[112:115]
    ds_read_b64_tr_b16 v[24:25], v12 offset:18032
    v_mfma_f32_16x16x32_bf16 v[120:123], v[32:35], v[228:231], v[120:123]
    ds_read_b64_tr_b16 v[26:27], v12 offset:18208
    v_mfma_f32_16x16x32_bf16 v[116:119], v[36:39], v[224:227], v[116:119]
    ds_read_b64_tr_b16 v[28:29], v12 offset:18064
    v_mfma_f32_16x16x32_bf16 v[124:127], v[36:39], v[228:231], v[124:127]
    ds_read_b64_tr_b16 v[30:31], v12 offset:18240
    s_waitcnt lgkmcnt(8)
    v_mfma_f32_16x16x32_bf16 v[80:83], v[40:43], v[232:235], v[80:83]
    v_mfma_f32_16x16x32_bf16 v[88:91], v[40:43], v[236:239], v[88:91]
    v_mfma_f32_16x16x32_bf16 v[84:87], v[44:47], v[232:235], v[84:87]
    v_mfma_f32_16x16x32_bf16 v[92:95], v[44:47], v[236:239], v[92:95]
    s_waitcnt lgkmcnt(4)
    v_mfma_f32_16x16x32_bf16 v[96:99], v[16:19], v[232:235], v[96:99]
    v_mfma_f32_16x16x32_bf16 v[104:107], v[16:19], v[236:239], v[104:107]
    v_mfma_f32_16x16x32_bf16 v[100:103], v[20:23], v[232:235], v[100:103]
    v_mfma_f32_16x16x32_bf16 v[108:111], v[20:23], v[236:239], v[108:111]
    s_nop 1
    s_waitcnt lgkmcnt(0)
    v_mfma_f32_16x16x32_bf16 v[112:115], v[24:27], v[232:235], v[112:115]
    v_mfma_f32_16x16x32_bf16 v[120:123], v[24:27], v[236:239], v[120:123]
    v_mfma_f32_16x16x32_bf16 v[116:119], v[28:31], v[232:235], v[116:119]
    v_mfma_f32_16x16x32_bf16 v[124:127], v[28:31], v[236:239], v[124:127]
    ds_read_b128 v[32:35], v79 offset:640
    ds_read_b128 v[36:39], v79 offset:704
    ds_read_b128 v[40:43], v79 offset:768
    ds_read_b128 v[44:47], v79 offset:832
    v_cvt_pk_bf16_f32 v52, v80, v81
    v_cvt_pk_bf16_f32 v53, v82, v83
    v_cvt_pk_bf16_f32 v56, v88, v89
    v_cvt_pk_bf16_f32 v57, v90, v91
    s_mov_b32 exec_hi, 0xffff
    v_cvt_pk_bf16_f32 v54, v84, v85
    v_cvt_pk_bf16_f32 v55, v86, v87
    v_cvt_pk_bf16_f32 v58, v92, v93
    v_cvt_pk_bf16_f32 v59, v94, v95
    s_mov_b32 exec_hi, -1
    buffer_store_dwordx4 v[52:55], v14, s[28:31], s54 offen sc1
    buffer_store_dwordx4 v[56:59], v14, s[28:31], s54 offen offset:256 sc1
    v_cvt_pk_bf16_f32 v60, v96, v97
    v_cvt_pk_bf16_f32 v61, v98, v99
    v_cvt_pk_bf16_f32 v64, v104, v105
    v_cvt_pk_bf16_f32 v65, v106, v107
    s_mov_b32 exec_hi, 0xffff
    v_cvt_pk_bf16_f32 v62, v100, v101
    v_cvt_pk_bf16_f32 v63, v102, v103
    v_cvt_pk_bf16_f32 v66, v108, v109
    v_cvt_pk_bf16_f32 v67, v110, v111
    s_mov_b32 exec_hi, -1
    buffer_store_dwordx4 v[60:63], v14, s[28:31], s55 offen sc1
    buffer_store_dwordx4 v[64:67], v14, s[28:31], s55 offen offset:256 sc1
    v_cvt_pk_bf16_f32 v68, v112, v113
    v_cvt_pk_bf16_f32 v69, v114, v115
    v_cvt_pk_bf16_f32 v72, v120, v121
    v_cvt_pk_bf16_f32 v73, v122, v123
    s_mov_b32 exec_hi, 0xffff
    v_cvt_pk_bf16_f32 v70, v116, v117
    v_cvt_pk_bf16_f32 v71, v118, v119
    v_cvt_pk_bf16_f32 v74, v124, v125
    v_cvt_pk_bf16_f32 v75, v126, v127
    s_mov_b32 exec_hi, -1
    buffer_store_dwordx4 v[68:71], v14, s[28:31], s17 offen sc1
    buffer_store_dwordx4 v[72:75], v14, s[28:31], s17 offen offset:256 sc1
    s_waitcnt lgkmcnt(0)
    v_mfma_f32_16x16x32_bf16 v[240:243], v[32:35], v[208:211], v[240:243]
    v_mfma_f32_16x16x32_bf16 v[244:247], v[32:35], v[212:215], v[244:247]
    v_mfma_f32_16x16x32_bf16 v[240:243], v[36:39], v[216:219], v[240:243]
    v_mfma_f32_16x16x32_bf16 v[244:247], v[36:39], v[220:223], v[244:247]
    v_mfma_f32_16x16x32_bf16 v[240:243], v[40:43], v[224:227], v[240:243]
    v_mfma_f32_16x16x32_bf16 v[244:247], v[40:43], v[228:231], v[244:247]
    v_mfma_f32_16x16x32_bf16 v[240:243], v[44:47], v[232:235], v[240:243]
    v_mfma_f32_16x16x32_bf16 v[244:247], v[44:47], v[236:239], v[244:247]
    s_barrier
    ds_read_b64_tr_b16 v[16:17], v6 offset:0
    ds_read_b64_tr_b16 v[18:19], v6 offset:176
    ds_read_b64_tr_b16 v[20:21], v6 offset:32
    ds_read_b64_tr_b16 v[22:23], v6 offset:208
    ds_read_b64_tr_b16 v[24:25], v6 offset:56
    ds_read_b64_tr_b16 v[26:27], v6 offset:232
    ds_read_b64_tr_b16 v[28:29], v6 offset:88
    ds_read_b64_tr_b16 v[30:31], v6 offset:264
    ds_read_b64_tr_b16 v[32:33], v6 offset:112
    ds_read_b64_tr_b16 v[34:35], v6 offset:288
    ds_read_b64_tr_b16 v[36:37], v6 offset:144
    ds_read_b64_tr_b16 v[38:39], v6 offset:320
    s_waitcnt lgkmcnt(8)
    v_mfma_f32_16x16x32_bf16 v[80:83], v[16:19], v[128:131], 0
    ds_read_b64_tr_b16 v[40:41], v6 offset:5632
    v_mfma_f32_16x16x32_bf16 v[88:91], v[16:19], v[132:135], 0
    ds_read_b64_tr_b16 v[42:43], v6 offset:5808
    v_mfma_f32_16x16x32_bf16 v[84:87], v[20:23], v[128:131], 0
    ds_read_b64_tr_b16 v[44:45], v6 offset:5664
    v_mfma_f32_16x16x32_bf16 v[92:95], v[20:23], v[132:135], 0
    ds_read_b64_tr_b16 v[46:47], v6 offset:5840
    s_waitcnt lgkmcnt(8)
    v_mfma_f32_16x16x32_bf16 v[96:99], v[24:27], v[128:131], 0
    ds_read_b64_tr_b16 v[16:17], v6 offset:5688
    v_mfma_f32_16x16x32_bf16 v[104:107], v[24:27], v[132:135], 0
    ds_read_b64_tr_b16 v[18:19], v6 offset:5864
    v_mfma_f32_16x16x32_bf16 v[100:103], v[28:31], v[128:131], 0
    ds_read_b64_tr_b16 v[20:21], v6 offset:5720
    v_mfma_f32_16x16x32_bf16 v[108:111], v[28:31], v[132:135], 0
    ds_read_b64_tr_b16 v[22:23], v6 offset:5896
    s_waitcnt lgkmcnt(8)
    v_mfma_f32_16x16x32_bf16 v[112:115], v[32:35], v[128:131], 0
    ds_read_b64_tr_b16 v[24:25], v6 offset:5744
    v_mfma_f32_16x16x32_bf16 v[120:123], v[32:35], v[132:135], 0
    ds_read_b64_tr_b16 v[26:27], v6 offset:5920
    v_mfma_f32_16x16x32_bf16 v[116:119], v[36:39], v[128:131], 0
    ds_read_b64_tr_b16 v[28:29], v6 offset:5776
    v_mfma_f32_16x16x32_bf16 v[124:127], v[36:39], v[132:135], 0
    ds_read_b64_tr_b16 v[30:31], v6 offset:5952
    s_waitcnt lgkmcnt(8)
    v_mfma_f32_16x16x32_bf16 v[80:83], v[40:43], v[136:139], v[80:83]
    ds_read_b64_tr_b16 v[32:33], v6 offset:12288
    v_mfma_f32_16x16x32_bf16 v[88:91], v[40:43], v[140:143], v[88:91]
    ds_read_b64_tr_b16 v[34:35], v6 offset:12464
    v_mfma_f32_16x16x32_bf16 v[84:87], v[44:47], v[136:139], v[84:87]
    ds_read_b64_tr_b16 v[36:37], v6 offset:12320
    v_mfma_f32_16x16x32_bf16 v[92:95], v[44:47], v[140:143], v[92:95]
    ds_read_b64_tr_b16 v[38:39], v6 offset:12496
    s_waitcnt lgkmcnt(8)
    v_mfma_f32_16x16x32_bf16 v[96:99], v[16:19], v[136:139], v[96:99]
    ds_read_b64_tr_b16 v[40:41], v6 offset:12344
    v_mfma_f32_16x16x32_bf16 v[104:107], v[16:19], v[140:143], v[104:107]
    ds_read_b64_tr_b16 v[42:43], v6 offset:12520
    v_mfma_f32_16x16x32_bf16 v[100:103], v[20:23], v[136:139], v[100:103]
    ds_read_b64_tr_b16 v[44:45], v6 offset:12376
    v_mfma_f32_16x16x32_bf16 v[108:111], v[20:23], v[140:143], v[108:111]
    ds_read_b64_tr_b16 v[46:47], v6 offset:12552
    s_waitcnt lgkmcnt(8)
    v_mfma_f32_16x16x32_bf16 v[112:115], v[24:27], v[136:139], v[112:115]
    ds_read_b64_tr_b16 v[16:17], v6 offset:12400
    v_mfma_f32_16x16x32_bf16 v[120:123], v[24:27], v[140:143], v[120:123]
    ds_read_b64_tr_b16 v[18:19], v6 offset:12576
    v_mfma_f32_16x16x32_bf16 v[116:119], v[28:31], v[136:139], v[116:119]
    ds_read_b64_tr_b16 v[20:21], v6 offset:12432
    v_mfma_f32_16x16x32_bf16 v[124:127], v[28:31], v[140:143], v[124:127]
    ds_read_b64_tr_b16 v[22:23], v6 offset:12608
    s_waitcnt lgkmcnt(8)
    v_mfma_f32_16x16x32_bf16 v[80:83], v[32:35], v[144:147], v[80:83]
    ds_read_b64_tr_b16 v[24:25], v6 offset:17920
    v_mfma_f32_16x16x32_bf16 v[88:91], v[32:35], v[148:151], v[88:91]
    ds_read_b64_tr_b16 v[26:27], v6 offset:18096
    v_mfma_f32_16x16x32_bf16 v[84:87], v[36:39], v[144:147], v[84:87]
    ds_read_b64_tr_b16 v[28:29], v6 offset:17952
    v_mfma_f32_16x16x32_bf16 v[92:95], v[36:39], v[148:151], v[92:95]
    ds_read_b64_tr_b16 v[30:31], v6 offset:18128
    s_waitcnt lgkmcnt(8)
    v_mfma_f32_16x16x32_bf16 v[96:99], v[40:43], v[144:147], v[96:99]
    ds_read_b64_tr_b16 v[32:33], v6 offset:17976
    v_mfma_f32_16x16x32_bf16 v[104:107], v[40:43], v[148:151], v[104:107]
    ds_read_b64_tr_b16 v[34:35], v6 offset:18152
    v_mfma_f32_16x16x32_bf16 v[100:103], v[44:47], v[144:147], v[100:103]
    ds_read_b64_tr_b16 v[36:37], v6 offset:18008
    v_mfma_f32_16x16x32_bf16 v[108:111], v[44:47], v[148:151], v[108:111]
    ds_read_b64_tr_b16 v[38:39], v6 offset:18184
    s_waitcnt lgkmcnt(8)
    v_mfma_f32_16x16x32_bf16 v[112:115], v[16:19], v[144:147], v[112:115]
    ds_read_b64_tr_b16 v[40:41], v6 offset:18032
    v_mfma_f32_16x16x32_bf16 v[120:123], v[16:19], v[148:151], v[120:123]
    ds_read_b64_tr_b16 v[42:43], v6 offset:18208
    v_mfma_f32_16x16x32_bf16 v[116:119], v[20:23], v[144:147], v[116:119]
    ds_read_b64_tr_b16 v[44:45], v6 offset:18064
    v_mfma_f32_16x16x32_bf16 v[124:127], v[20:23], v[148:151], v[124:127]
    ds_read_b64_tr_b16 v[46:47], v6 offset:18240
    s_waitcnt vmcnt(0)
    s_mov_b32 s61, 65536
go_a_lp_63:
    v_cmp_eq_u32 vcc, 0, v76
    s_sub_u32 s61, s61, 1
    s_cselect_b64 vcc, 0, vcc
    s_cbranch_vccz go_a_ok_62
    s_sleep 8
    buffer_load_dwordx2 v[76:77], off, s[96:99], 0 sc1
    s_waitcnt vmcnt(0)
    s_branch go_a_lp_63
go_a_ok_62:
    v_readfirstlane_b32 s100, v76
    v_readfirstlane_b32 s101, v77
    s_nop 1
    v_lshlrev_b32 v2, 3, v1
    v_mov_b32 v76, s100
    v_mov_b32 v77, s101
    s_mov_b64 exec, 0xffff
    buffer_store_dwordx2 v[76:77], v2, s[28:31], s52 offen sc1
    s_mov_b64 exec, -1
    s_waitcnt lgkmcnt(8)
    v_mfma_f32_16x16x32_bf16 v[80:83], v[24:27], v[152:155], v[80:83]
    ds_read_b64_tr_b16 v[16:17], v13 offset:24576
    v_mfma_f32_16x16x32_bf16 v[88:91], v[24:27], v[156:159], v[88:91]
    ds_read_b64_tr_b16 v[18:19], v13 offset:24752
    v_mfma_f32_16x16x32_bf16 v[84:87], v[28:31], v[152:155], v[84:87]
    ds_read_b64_tr_b16 v[20:21], v13 offset:24608
    v_mfma_f32_16x16x32_bf16 v[92:95], v[28:31], v[156:159], v[92:95]
    ds_read_b64_tr_b16 v[22:23], v13 offset:24784
    s_waitcnt lgkmcnt(8)
    v_mfma_f32_16x16x32_bf16 v[96:99], v[32:35], v[152:155], v[96:99]
    ds_read_b64_tr_b16 v[24:25], v13 offset:24632
    v_mfma_f32_16x16x32_bf16 v[104:107], v[32:35], v[156:159], v[104:107]
    ds_read_b64_tr_b16 v[26:27], v13 offset:24808
    v_mfma_f32_16x16x32_bf16 v[100:103], v[36:39], v[152:155], v[100:103]
    ds_read_b64_tr_b16 v[28:29], v13 offset:24664
    v_mfma_f32_16x16x32_bf16 v[108:111], v[36:39], v[156:159], v[108:111]
    ds_read_b64_tr_b16 v[30:31], v13 offset:24840
    s_waitcnt lgkmcnt(8)
    v_mfma_f32_16x16x32_bf16 v[112:115], v[40:43], v[152:155], v[112:115]
    ds_read_b64_tr_b16 v[32:33], v13 offset:24688
    v_mfma_f32_16x16x32_bf16 v[120:123], v[40:43], v[156:159], v[120:123]
    ds_read_b64_tr_b16 v[34:35], v13 offset:24864
    v_mfma_f32_16x16x32_bf16 v[116:119], v[44:47], v[152:155], v[116:119]
    ds_read_b64_tr_b16 v[36:37], v13 offset:24720
    v_mfma_f32_16x16x32_bf16 v[124:127], v[44:47], v[156:159], v[124:127]
    ds_read_b64_tr_b16 v[38:39], v13 offset:24896
    s_waitcnt lgkmcnt(8)
    v_mfma_f32_16x16x32_bf16 v[80:83], v[16:19], v[160:163], v[80:83]
    ds_read_b64_tr_b16 v[40:41], v13 offset:30208
    v_mfma_f32_16x16x32_bf16 v[88:91], v[16:19], v[164:167], v[88:91]
    ds_read_b64_tr_b16 v[42:43], v13 offset:30384
    v_mfma_f32_16x16x32_bf16 v[84:87], v[20:23], v[160:163], v[84:87]
    ds_read_b64_tr_b16 v[44:45], v13 offset:30240
    v_mfma_f32_16x16x32_bf16 v[92:95], v[20:23], v[164:167], v[92:95]
    ds_read_b64_tr_b16 v[46:47], v13 offset:30416
    s_waitcnt lgkmcnt(8)
    v_mfma_f32_16x16x32_bf16 v[96:99], v[24:27], v[160:163], v[96:99]
    ds_read_b64_tr_b16 v[16:17], v13 offset:30264
    v_mfma_f32_16x16x32_bf16 v[104:107], v[24:27], v[164:167], v[104:107]
    ds_read_b64_tr_b16 v[18:19], v13 offset:30440
    v_mfma_f32_16x16x32_bf16 v[100:103], v[28:31], v[160:163], v[100:103]
    ds_read_b64_tr_b16 v[20:21], v13 offset:30296
    v_mfma_f32_16x16x32_bf16 v[108:111], v[28:31], v[164:167], v[108:111]
    ds_read_b64_tr_b16 v[22:23], v13 offset:30472
    s_waitcnt lgkmcnt(8)
    v_mfma_f32_16x16x32_bf16 v[112:115], v[32:35], v[160:163], v[112:115]
    ds_read_b64_tr_b16 v[24:25], v13 offset:30320
    v_mfma_f32_16x16x32_bf16 v[120:123], v[32:35], v[164:167], v[120:123]
    ds_read_b64_tr_b16 v[26:27], v13 offset:30496
    v_mfma_f32_16x16x32_bf16 v[116:119], v[36:39], v[160:163], v[116:119]
    ds_read_b64_tr_b16 v[28:29], v13 offset:30352
    v_mfma_f32_16x16x32_bf16 v[124:127], v[36:39], v[164:167], v[124:127]
    ds_read_b64_tr_b16 v[30:31], v13 offset:30528
    s_waitcnt lgkmcnt(8)
    s_barrier
    v_mfma_f32_16x16x32_bf16 v[80:83], v[40:43], v[168:171], v[80:83]
    ds_read_b64_tr_b16 v[32:33], v5 offset:0
    v_mfma_f32_16x16x32_bf16 v[88:91], v[40:43], v[172:175], v[88:91]
    ds_read_b64_tr_b16 v[34:35], v5 offset:176
    v_mfma_f32_16x16x32_bf16 v[84:87], v[44:47], v[168:171], v[84:87]
    ds_read_b64_tr_b16 v[36:37], v5 offset:32
    v_mfma_f32_16x16x32_bf16 v[92:95], v[44:47], v[172:175], v[92:95]
    ds_read_b64_tr_b16 v[38:39], v5 offset:208
    s_waitcnt lgkmcnt(8)
    v_mfma_f32_16x16x32_bf16 v[96:99], v[16:19], v[168:171], v[96:99]
    ds_read_b64_tr_b16 v[40:41], v5 offset:56
    v_mfma_f32_16x16x32_bf16 v[104:107], v[16:19], v[172:175], v[104:107]
    ds_read_b64_tr_b16 v[42:43], v5 offset:232
    v_mfma_f32_16x16x32_bf16 v[100:103], v[20:23], v[168:171], v[100:103]
    ds_read_b64_tr_b16 v[44:45], v5 offset:88
    v_mfma_f32_16x16x32_bf16 v[108:111], v[20:23], v[172:175], v[108:111]
    ds_read_b64_tr_b16 v[46:47], v5 offset:264
    s_waitcnt lgkmcnt(8)
    v_mfma_f32_16x16x32_bf16 v[112:115], v[24:27], v[168:171], v[112:115]
    ds_read_b64_tr_b16 v[16:17], v5 offset:112
    v_mfma_f32_16x16x32_bf16 v[120:123], v[24:27], v[172:175], v[120:123]
    ds_read_b64_tr_b16 v[18:19], v5 offset:288
    v_mfma_f32_16x16x32_bf16 v[116:119], v[28:31], v[168:171], v[116:119]
    ds_read_b64_tr_b16 v[20:21], v5 offset:144
    v_mfma_f32_16x16x32_bf16 v[124:127], v[28:31], v[172:175], v[124:127]
    ds_read_b64_tr_b16 v[22:23], v5 offset:320
    s_waitcnt lgkmcnt(8)
    v_mfma_f32_16x16x32_bf16 v[80:83], v[32:35], v[176:179], v[80:83]
    ds_read_b64_tr_b16 v[24:25], v5 offset:5632
    v_mfma_f32_16x16x32_bf16 v[88:91], v[32:35], v[180:183], v[88:91]
    ds_read_b64_tr_b16 v[26:27], v5 offset:5808
    v_mfma_f32_16x16x32_bf16 v[84:87], v[36:39], v[176:179], v[84:87]
    ds_read_b64_tr_b16 v[28:29], v5 offset:5664
    v_mfma_f32_16x16x32_bf16 v[92:95], v[36:39], v[180:183], v[92:95]
    ds_read_b64_tr_b16 v[30:31], v5 offset:5840
    s_waitcnt lgkmcnt(8)
    v_mfma_f32_16x16x32_bf16 v[96:99], v[40:43], v[176:179], v[96:99]
    ds_read_b64_tr_b16 v[32:33], v5 offset:5688
    v_mfma_f32_16x16x32_bf16 v[104:107], v[40:43], v[180:183], v[104:107]
    ds_read_b64_tr_b16 v[34:35], v5 offset:5864
    v_mfma_f32_16x16x32_bf16 v[100:103], v[44:47], v[176:179], v[100:103]
    ds_read_b64_tr_b16 v[36:37], v5 offset:5720
    v_mfma_f32_16x16x32_bf16 v[108:111], v[44:47], v[180:183], v[108:111]
    ds_read_b64_tr_b16 v[38:39], v5 offset:5896
    s_waitcnt lgkmcnt(8)
    v_mfma_f32_16x16x32_bf16 v[112:115], v[16:19], v[176:179], v[112:115]
    ds_read_b64_tr_b16 v[40:41], v5 offset:5744
    v_mfma_f32_16x16x32_bf16 v[120:123], v[16:19], v[180:183], v[120:123]
    ds_read_b64_tr_b16 v[42:43], v5 offset:5920
    v_mfma_f32_16x16x32_bf16 v[116:119], v[20:23], v[176:179], v[116:119]
    ds_read_b64_tr_b16 v[44:45], v5 offset:5776
    v_mfma_f32_16x16x32_bf16 v[124:127], v[20:23], v[180:183], v[124:127]
    ds_read_b64_tr_b16 v[46:47], v5 offset:5952
    s_waitcnt lgkmcnt(8)
    v_mfma_f32_16x16x32_bf16 v[80:83], v[24:27], v[184:187], v[80:83]
    ds_read_b64_tr_b16 v[16:17], v13 offset:36864
    v_mfma_f32_16x16x32_bf16 v[88:91], v[24:27], v[188:191], v[88:91]
    ds_read_b64_tr_b16 v[18:19], v13 offset:37040
    v_mfma_f32_16x16x32_bf16 v[84:87], v[28:31], v[184:187], v[84:87]
    ds_read_b64_tr_b16 v[20:21], v13 offset:36896
    v_mfma_f32_16x16x32_bf16 v[92:95], v[28:31], v[188:191], v[92:95]
    ds_read_b64_tr_b16 v[22:23], v13 offset:37072
    s_waitcnt lgkmcnt(8)
    v_mfma_f32_16x16x32_bf16 v[96:99], v[32:35], v[184:187], v[96:99]
    ds_read_b64_tr_b16 v[24:25], v13 offset:36920
    v_mfma_f32_16x16x32_bf16 v[104:107], v[32:35], v[188:191], v[104:107]
    ds_read_b64_tr_b16 v[26:27], v13 offset:37096
    v_mfma_f32_16x16x32_bf16 v[100:103], v[36:39], v[184:187], v[100:103]
    ds_read_b64_tr_b16 v[28:29], v13 offset:36952
    v_mfma_f32_16x16x32_bf16 v[108:111], v[36:39], v[188:191], v[108:111]
    ds_read_b64_tr_b16 v[30:31], v13 offset:37128
    s_waitcnt lgkmcnt(8)
    v_mfma_f32_16x16x32_bf16 v[112:115], v[40:43], v[184:187], v[112:115]
    ds_read_b64_tr_b16 v[32:33], v13 offset:36976
    v_mfma_f32_16x16x32_bf16 v[120:123], v[40:43], v[188:191], v[120:123]
    ds_read_b64_tr_b16 v[34:35], v13 offset:37152
    v_mfma_f32_16x16x32_bf16 v[116:119], v[44:47], v[184:187], v[116:119]
    ds_read_b64_tr_b16 v[36:37], v13 offset:37008
    v_mfma_f32_16x16x32_bf16 v[124:127], v[44:47], v[188:191], v[124:127]
    ds_read_b64_tr_b16 v[38:39], v13 offset:37184
    s_waitcnt lgkmcnt(8)
    v_mfma_f32_16x16x32_bf16 v[80:83], v[16:19], v[192:195], v[80:83]
    ds_read_b64_tr_b16 v[40:41], v13 offset:42496
    v_mfma_f32_16x16x32_bf16 v[88:91], v[16:19], v[196:199], v[88:91]
    ds_read_b64_tr_b16 v[42:43], v13 offset:42672
    v_mfma_f32_16x16x32_bf16 v[84:87], v[20:23], v[192:195], v[84:87]
    ds_read_b64_tr_b16 v[44:45], v13 offset:42528
    v_mfma_f32_16x16x32_bf16 v[92:95], v[20:23], v[196:199], v[92:95]
    ds_read_b64_tr_b16 v[46:47], v13 offset:42704
    s_waitcnt lgkmcnt(8)
    v_mfma_f32_16x16x32_bf16 v[96:99], v[24:27], v[192:195], v[96:99]
    ds_read_b64_tr_b16 v[16:17], v13 offset:42552
    v_mfma_f32_16x16x32_bf16 v[104:107], v[24:27], v[196:199], v[104:107]
    ds_read_b64_tr_b16 v[18:19], v13 offset:42728
    v_mfma_f32_16x16x32_bf16 v[100:103], v[28:31], v[192:195], v[100:103]
    ds_read_b64_tr_b16 v[20:21], v13 offset:42584
    v_mfma_f32_16x16x32_bf16 v[108:111], v[28:31], v[196:199], v[108:111]
    ds_read_b64_tr_b16 v[22:23], v13 offset:42760
    s_waitcnt lgkmcnt(8)
    v_mfma_f32_16x16x32_bf16 v[112:115], v[32:35], v[192:195], v[112:115]
    ds_read_b64_tr_b16 v[24:25], v13 offset:42608
    v_mfma_f32_16x16x32_bf16 v[120:123], v[32:35], v[196:199], v[120:123]
    ds_read_b64_tr_b16 v[26:27], v13 offset:42784
    v_mfma_f32_16x16x32_bf16 v[116:119], v[36:39], v[192:195], v[116:119]
    ds_read_b64_tr_b16 v[28:29], v13 offset:42640
    v_mfma_f32_16x16x32_bf16 v[124:127], v[36:39], v[196:199], v[124:127]
    ds_read_b64_tr_b16 v[30:31], v13 offset:42816
    s_waitcnt lgkmcnt(8)
    s_barrier
    v_mfma_f32_16x16x32_bf16 v[80:83], v[40:43], v[200:203], v[80:83]
    ds_read_b64_tr_b16 v[32:33], v5 offset:32768
    v_mfma_f32_16x16x32_bf16 v[88:91], v[40:43], v[204:207], v[88:91]
    ds_read_b64_tr_b16 v[34:35], v5 offset:32944
    v_mfma_f32_16x16x32_bf16 v[84:87], v[44:47], v[200:203], v[84:87]
    ds_read_b64_tr_b16 v[36:37], v5 offset:32800
    v_mfma_f32_16x16x32_bf16 v[92:95], v[44:47], v[204:207], v[92:95]
    ds_read_b64_tr_b16 v[38:39], v5 offset:32976
    s_waitcnt lgkmcnt(8)
    v_mfma_f32_16x16x32_bf16 v[96:99], v[16:19], v[200:203], v[96:99]
    ds_read_b64_tr_b16 v[40:41], v5 offset:32824
    v_mfma_f32_16x16x32_bf16 v[104:107], v[16:19], v[204:207], v[104:107]
    ds_read_b64_tr_b16 v[42:43], v5 offset:33000
    v_mfma_f32_16x16x32_bf16 v[100:103], v[20:23], v[200:203], v[100:103]
    ds_read_b64_tr_b16 v[44:45], v5 offset:32856
    v_mfma_f32_16x16x32_bf16 v[108:111], v[20:23], v[204:207], v[108:111]
    ds_read_b64_tr_b16 v[46:47], v5 offset:33032
    s_waitcnt lgkmcnt(8)
    v_mfma_f32_16x16x32_bf16 v[112:115], v[24:27], v[200:203], v[112:115]
    ds_read_b64_tr_b16 v[16:17], v5 offset:32880
    v_mfma_f32_16x16x32_bf16 v[120:123], v[24:27], v[204:207], v[120:123]
    ds_read_b64_tr_b16 v[18:19], v5 offset:33056
    v_mfma_f32_16x16x32_bf16 v[116:119], v[28:31], v[200:203], v[116:119]
    ds_read_b64_tr_b16 v[20:21], v5 offset:32912
    v_mfma_f32_16x16x32_bf16 v[124:127], v[28:31], v[204:207], v[124:127]
    ds_read_b64_tr_b16 v[22:23], v5 offset:33088
    s_waitcnt lgkmcnt(8)
    v_mfma_f32_16x16x32_bf16 v[80:83], v[32:35], v[208:211], v[80:83]
    ds_read_b64_tr_b16 v[24:25], v5 offset:38400
    v_mfma_f32_16x16x32_bf16 v[88:91], v[32:35], v[212:215], v[88:91]
    ds_read_b64_tr_b16 v[26:27], v5 offset:38576
    v_mfma_f32_16x16x32_bf16 v[84:87], v[36:39], v[208:211], v[84:87]
    ds_read_b64_tr_b16 v[28:29], v5 offset:38432
    v_mfma_f32_16x16x32_bf16 v[92:95], v[36:39], v[212:215], v[92:95]
    ds_read_b64_tr_b16 v[30:31], v5 offset:38608
    s_waitcnt lgkmcnt(8)
    v_mfma_f32_16x16x32_bf16 v[96:99], v[40:43], v[208:211], v[96:99]
    ds_read_b64_tr_b16 v[32:33], v5 offset:38456
    v_mfma_f32_16x16x32_bf16 v[104:107], v[40:43], v[212:215], v[104:107]
    ds_read_b64_tr_b16 v[34:35], v5 offset:38632
    v_mfma_f32_16x16x32_bf16 v[100:103], v[44:47], v[208:211], v[100:103]
    ds_read_b64_tr_b16 v[36:37], v5 offset:38488
    v_mfma_f32_16x16x32_bf16 v[108:111], v[44:47], v[212:215], v[108:111]
    ds_read_b64_tr_b16 v[38:39], v5 offset:38664
    s_waitcnt lgkmcnt(8)
    v_mfma_f32_16x16x32_bf16 v[112:115], v[16:19], v[208:211], v[112:115]
    ds_read_b64_tr_b16 v[40:41], v5 offset:38512
    v_mfma_f32_16x16x32_bf16 v[120:123], v[16:19], v[212:215], v[120:123]
    ds_read_b64_tr_b16 v[42:43], v5 offset:38688
    v_mfma_f32_16x16x32_bf16 v[116:119], v[20:23], v[208:211], v[116:119]
    ds_read_b64_tr_b16 v[44:45], v5 offset:38544
    v_mfma_f32_16x16x32_bf16 v[124:127], v[20:23], v[212:215], v[124:127]
    ds_read_b64_tr_b16 v[46:47], v5 offset:38720
    s_waitcnt lgkmcnt(8)
    v_mfma_f32_16x16x32_bf16 v[80:83], v[24:27], v[216:219], v[80:83]
    ds_read_b64_tr_b16 v[16:17], v13 offset:49152
    v_mfma_f32_16x16x32_bf16 v[88:91], v[24:27], v[220:223], v[88:91]
    ds_read_b64_tr_b16 v[18:19], v13 offset:49328
    v_mfma_f32_16x16x32_bf16 v[84:87], v[28:31], v[216:219], v[84:87]
    ds_read_b64_tr_b16 v[20:21], v13 offset:49184
    v_mfma_f32_16x16x32_bf16 v[92:95], v[28:31], v[220:223], v[92:95]
    ds_read_b64_tr_b16 v[22:23], v13 offset:49360
    s_waitcnt lgkmcnt(8)
    v_mfma_f32_16x16x32_bf16 v[96:99], v[32:35], v[216:219], v[96:99]
    ds_read_b64_tr_b16 v[24:25], v13 offset:49208
    v_mfma_f32_16x16x32_bf16 v[104:107], v[32:35], v[220:223], v[104:107]
    ds_read_b64_tr_b16 v[26:27], v13 offset:49384
    v_mfma_f32_16x16x32_bf16 v[100:103], v[36:39], v[216:219], v[100:103]
    ds_read_b64_tr_b16 v[28:29], v13 offset:49240
    v_mfma_f32_16x16x32_bf16 v[108:111], v[36:39], v[220:223], v[108:111]
    ds_read_b64_tr_b16 v[30:31], v13 offset:49416
    s_waitcnt lgkmcnt(8)
    v_mfma_f32_16x16x32_bf16 v[112:115], v[40:43], v[216:219], v[112:115]
    ds_read_b64_tr_b16 v[32:33], v13 offset:49264
    v_mfma_f32_16x16x32_bf16 v[120:123], v[40:43], v[220:223], v[120:123]
    ds_read_b64_tr_b16 v[34:35], v13 offset:49440
    v_mfma_f32_16x16x32_bf16 v[116:119], v[44:47], v[216:219], v[116:119]
    ds_read_b64_tr_b16 v[36:37], v13 offset:49296
    v_mfma_f32_16x16x32_bf16 v[124:127], v[44:47], v[220:223], v[124:127]
    ds_read_b64_tr_b16 v[38:39], v13 offset:49472
    s_waitcnt lgkmcnt(8)
    v_mfma_f32_16x16x32_bf16 v[80:83], v[16:19], v[224:227], v[80:83]
    ds_read_b64_tr_b16 v[40:41], v13 offset:54784
    v_mfma_f32_16x16x32_bf16 v[88:91], v[16:19], v[228:231], v[88:91]
    ds_read_b64_tr_b16 v[42:43], v13 offset:54960
    v_mfma_f32_16x16x32_bf16 v[84:87], v[20:23], v[224:227], v[84:87]
    ds_read_b64_tr_b16 v[44:45], v13 offset:54816
    v_mfma_f32_16x16x32_bf16 v[92:95], v[20:23], v[228:231], v[92:95]
    ds_read_b64_tr_b16 v[46:47], v13 offset:54992
    s_waitcnt lgkmcnt(8)
    v_mfma_f32_16x16x32_bf16 v[96:99], v[24:27], v[224:227], v[96:99]
    ds_read_b64_tr_b16 v[16:17], v13 offset:54840
    v_mfma_f32_16x16x32_bf16 v[104:107], v[24:27], v[228:231], v[104:107]
    ds_read_b64_tr_b16 v[18:19], v13 offset:55016
    v_mfma_f32_16x16x32_bf16 v[100:103], v[28:31], v[224:227], v[100:103]
    ds_read_b64_tr_b16 v[20:21], v13 offset:54872
    v_mfma_f32_16x16x32_bf16 v[108:111], v[28:31], v[228:231], v[108:111]
    ds_read_b64_tr_b16 v[22:23], v13 offset:55048
    v_mov_b32 v194, 0x3f803f80
    v_mov_b32 v195, 0x3f80
    v_mov_b32 v198, 0x3f803f80
    v_mov_b32 v199, 0x3f80
    v_mov_b32 v202, 0x3f803f80
    v_mov_b32 v203, 0x3f80
    v_mov_b32 v206, 0x3f803f80
    v_mov_b32 v207, 0x3f80
    v_mov_b32 v210, 0x3f803f80
    v_mov_b32 v211, 0x3f80
    v_mov_b32 v214, 0x3f803f80
    v_mov_b32 v215, 0x3f80
    s_waitcnt lgkmcnt(8)
    v_mfma_f32_16x16x32_bf16 v[112:115], v[32:35], v[224:227], v[112:115]
    ds_read_b64_tr_b16 v[24:25], v13 offset:54896
    v_mfma_f32_16x16x32_bf16 v[120:123], v[32:35], v[228:231], v[120:123]
    ds_read_b64_tr_b16 v[26:27], v13 offset:55072
    v_mfma_f32_16x16x32_bf16 v[116:119], v[36:39], v[224:227], v[116:119]
    ds_read_b64_tr_b16 v[28:29], v13 offset:54928
    v_mfma_f32_16x16x32_bf16 v[124:127], v[36:39], v[228:231], v[124:127]
    ds_read_b64_tr_b16 v[30:31], v13 offset:55104
    s_waitcnt lgkmcnt(8)
    v_mfma_f32_16x16x32_bf16 v[80:83], v[40:43], v[232:235], v[80:83]
    v_mfma_f32_16x16x32_bf16 v[88:91], v[40:43], v[236:239], v[88:91]
    v_mfma_f32_16x16x32_bf16 v[84:87], v[44:47], v[232:235], v[84:87]
    v_mfma_f32_16x16x32_bf16 v[92:95], v[44:47], v[236:239], v[92:95]
    s_waitcnt lgkmcnt(4)
    v_mfma_f32_16x16x32_bf16 v[96:99], v[16:19], v[232:235], v[96:99]
    v_mfma_f32_16x16x32_bf16 v[104:107], v[16:19], v[236:239], v[104:107]
    v_mfma_f32_16x16x32_bf16 v[100:103], v[20:23], v[232:235], v[100:103]
    v_mfma_f32_16x16x32_bf16 v[108:111], v[20:23], v[236:239], v[108:111]
    s_nop 1
    s_waitcnt lgkmcnt(0)
    v_mfma_f32_16x16x32_bf16 v[112:115], v[24:27], v[232:235], v[112:115]
    v_mfma_f32_16x16x32_bf16 v[120:123], v[24:27], v[236:239], v[120:123]
    v_mfma_f32_16x16x32_bf16 v[116:119], v[28:31], v[232:235], v[116:119]
    v_mfma_f32_16x16x32_bf16 v[124:127], v[28:31], v[236:239], v[124:127]
    v_cvt_pk_bf16_f32 v192, v80, v81
    v_cvt_pk_bf16_f32 v193, v82, v83
    v_cvt_pk_bf16_f32 v196, v88, v89
    v_cvt_pk_bf16_f32 v197, v90, v91
    s_mov_b32 exec_hi, 0xffff
    v_cvt_pk_bf16_f32 v194, v84, v85
    v_cvt_pk_bf16_f32 v195, v86, v87
    v_cvt_pk_bf16_f32 v198, v92, v93
    v_cvt_pk_bf16_f32 v199, v94, v95
    s_mov_b32 exec_hi, -1
    v_cvt_pk_bf16_f32 v200, v96, v97
    v_cvt_pk_bf16_f32 v201, v98, v99
    v_cvt_pk_bf16_f32 v204, v104, v105
    v_cvt_pk_bf16_f32 v205, v106, v107
    s_mov_b32 exec_hi, 0xffff
    v_cvt_pk_bf16_f32 v202, v100, v101
    v_cvt_pk_bf16_f32 v203, v102, v103
    v_cvt_pk_bf16_f32 v206, v108, v109
    v_cvt_pk_bf16_f32 v207, v110, v111
    s_mov_b32 exec_hi, -1
    v_cvt_pk_bf16_f32 v208, v112, v113
    v_cvt_pk_bf16_f32 v209, v114, v115
    v_cvt_pk_bf16_f32 v212, v120, v121
    v_cvt_pk_bf16_f32 v213, v122, v123
    s_mov_b32 exec_hi, 0xffff
    v_cvt_pk_bf16_f32 v210, v116, v117
    v_cvt_pk_bf16_f32 v211, v118, v119
    v_cvt_pk_bf16_f32 v214, v124, v125
    v_cvt_pk_bf16_f32 v215, v126, v127
    s_mov_b32 exec_hi, -1
    v_mov_b32 v216, v14
    s_branch L_a_attn
P1B_KKV:
    s_mul_i32 s36, s33, 168
    s_and_b32 s37, s36, 15
    s_sub_u32 s36, s36, s37
    v_and_b32 v3, 15, v1
    v_lshrrev_b32 v4, 4, v1
    v_lshrrev_b32 v5, 1, v3
    v_xor_b32 v5, v5, v4
    s_lshl_b32 s40, s34, 12
    v_lshl_add_u32 v6, v3, 7, s40
    v_lshl_add_u32 v8, v5, 4, v6
    v_xor_b32 v9, 64, v8
    v_bfe_u32 v5, v1, 2, 2
    v_lshl_add_u32 v5, v4, 2, v5
    v_mul_u32_u24 v5, 352, v5
    v_and_b32 v6, 3, v1
    v_lshl_add_u32 v5, v6, 3, v5
    s_add_u32 s40, s37, 98304
    v_add_u32 v12, s40, v5
    v_lshlrev_b32 v79, 4, v4
    v_add_u32 v79, 159744, v79
    v_mov_b32 v2, 163840
    s_mov_b32 vcc_lo, 0x00010001
    s_mov_b32 vcc_hi, 0x00010001
    v_cndmask_b32 v79, v2, v79, vcc
    s_waitcnt lgkmcnt(0)
    s_mov_b32 s96, s20
    s_and_b32 s97, s21, 0xffff
    s_mov_b32 s98, 256
    s_mov_b32 s99, 0x20000
    s_or_b32 s53, s2, s34
    s_cbranch_scc1 notag_64
    s_memrealtime s[100:101]
    s_waitcnt lgkmcnt(0)
    s_lshl_b64 s[100:101], s[100:101], 1
    s_or_b32 s100, s100, 1
    v_mov_b32 v76, s100
    v_mov_b32 v77, s101
    s_mov_b64 exec, 1
    buffer_store_dwordx2 v[76:77], off, s[96:99], 0 sc1
    s_mov_b64 exec, -1
notag_64:
    s_xor_b32 s62, s33, 1
    s_lshr_b32 s40, s33, 1
    s_cmp_eq_u32 s40, 2
    s_cselect_b32 s62, s33, s62
    s_cmp_eq_u32 s40, 5
    s_cselect_b32 s62, s33, s62
    s_mul_i32 s38, s62, 168
    s_and_b32 s39, s38, 15
    s_sub_u32 s38, s38, s39
    v_add_u32 v5, s39, v5
    v_add_u32 v13, 98304, v5
    v_add_u32 v6, 65536, v5
    v_lshlrev_b32 v2, 4, v3
    v_lshl_add_u32 v14, v4, 9, v2
    v_cmp_eq_u32 vcc, 12, v3
    v_mov_b32 v2, 0x3f803f80
    s_mov_b32 s50, 1049335798
    s_mov_b32 s51, 1049335798
    v_cndmask_b32 v7, 0, v2, vcc
    s_lshl_b32 s39, s35, 12
    s_lshl_b32 s40, s32, 2
    s_add_u32 s40, s40, s35
    s_mov_b32 s60, 0
    s_lshl_b32 s41, s33, 6
    s_add_u32 s41, s41, s40
    s_lshl_b32 s41, s41, 11
    s_add_u32 s41, s41, 8388608
    s_add_u32 s42, s41, 2097152
    s_lshl_b32 s45, s40, 5
    s_add_u32 s45, s45, s33
    s_lshl_b32 s43, s45, 11
    s_add_u32 s43, s43, 12582912
    s_add_u32 s44, s43, 32768
    s_lshl_b32 s45, s45, 7
    s_add_u32 s45, s45, 21233664
    s_mov_b32 s56, 1400897536
    s_mov_b32 s57, 729808896
    s_lshr_b32 s38, s2, 3
    s_mul_i32 s36, s38, 37
    s_lshr_b32 s36, s36, 8
    s_mul_i32 s37, s36, 7
    s_sub_u32 s37, s38, s37
    s_and_b32 s46, s2, 1
    s_lshl_b32 s46, s46, 4
    s_add_u32 s36, s36, s46
    s_and_b32 s46, s2, 6
    s_lshl_b32 s46, s46, 1
    s_add_u32 s36, s36, s46
    s_cmp_eq_u32 s35, 3
    s_cselect_b32 s49, 4294952960, 0
    s_lshl_b32 s46, s62, 6
    s_add_u32 s46, s46, s40
    s_lshl_b32 s46, s46, 7
    s_add_u32 s3, s46, 20971520
    s_lshl_b32 s46, s33, 6
    s_add_u32 s46, s46, s40
    s_lshl_b32 s46, s46, 7
    s_add_u32 s52, s46, 21102592
    s_mov_b32 s28, s22
    s_and_b32 s29, s23, 0xffff
    s_mov_b32 s30, 22020096
    s_mov_b32 s31, 0x20000
    s_lshl_b32 s46, s33, 18
    s_add_u32 s10, s22, s46
    s_addc_u32 s11, s23, 0
    s_mov_b32 s64, s10
    s_and_b32 s65, s11, 0xffff
    s_mov_b32 s66, 262144
    s_mov_b32 s67, 0x20000
    s_add_u32 s10, s10, 4194304
    s_addc_u32 s11, s11, 0
    s_mov_b32 s68, s10
    s_and_b32 s69, s11, 0xffff
    s_mov_b32 s70, 262144
    s_mov_b32 s71, 0x20000
    s_mov_b32 s24, s14
    s_and_b32 s25, s15, 0xffff
    s_mov_b32 s26, 401408
    s_mov_b32 s27, 0x20000
    s_and_b32 s4, s34, 1
    s_lshr_b32 s5, s34, 1
    s_lshl_b32 s46, s36, 1
    s_add_u32 s46, s46, s4
    s_lshl_b32 s47, s46, 5
    s_xor_b32 s48, s5, 2
    s_lshl_b32 s48, s48, 3
    s_add_u32 s47, s47, s48
    s_lshl_b32 s6, s47, 11
    s_add_u32 s6, s6, 12582912
    s_lshl_b32 s7, s47, 7
    s_add_u32 s7, s7, 21233664
    s_mul_i32 s58, s33, 3
    s_add_u32 s61, s58, 0
    s_and_b32 s61, s61, 15
    s_lshl_b32 s61, s61, 6
    s_add_u32 s61, s61, s40
    s_lshl_b32 s61, s61, 12
    s_add_u32 s54, s61, 4194304
    s_add_u32 s61, s58, 1
    s_and_b32 s61, s61, 15
    s_lshl_b32 s61, s61, 6
    s_add_u32 s61, s61, s40
    s_lshl_b32 s61, s61, 12
    s_add_u32 s55, s61, 4194304
    s_add_u32 s61, s58, 2
    s_and_b32 s61, s61, 15
    s_lshl_b32 s61, s61, 6
    s_add_u32 s61, s61, s40
    s_lshl_b32 s61, s61, 12
    s_add_u32 s17, s61, 4196352
    s_mul_i32 s58, s62, 3
    s_add_u32 s61, s58, 0
    s_and_b32 s61, s61, 15
    s_lshl_b32 s61, s61, 6
    s_add_u32 s61, s61, s40
    s_lshl_b32 s61, s61, 12
    s_add_u32 s47, s61, 0
    s_add_u32 s61, s58, 1
    s_and_b32 s61, s61, 15
    s_lshl_b32 s61, s61, 6
    s_add_u32 s61, s61, s40
    s_lshl_b32 s61, s61, 12
    s_add_u32 s59, s61, 0
    s_add_u32 s61, s58, 2
    s_and_b32 s61, s61, 15
    s_lshl_b32 s61, s61, 6
    s_add_u32 s61, s61, s40
    s_lshl_b32 s61, s61, 12
    s_add_u32 s16, s61, 2048
    v_mov_b32 v54, 0x3f803f80
    v_mov_b32 v55, 0x3f80
    v_mov_b32 v58, 0x3f803f80
    v_mov_b32 v59, 0x3f80
    v_mov_b32 v62, 0x3f803f80
    v_mov_b32 v63, 0x3f80
    v_mov_b32 v66, 0x3f803f80
    v_mov_b32 v67, 0x3f80
    v_mov_b32 v72, v7
    v_mov_b32 v73, v7
    v_mov_b32 v74, v7
    v_mov_b32 v75, v7
    s_barrier
    ds_read_b128 v[128:131], v8 offset:0
    ds_read_b128 v[132:135], v8 offset:2048
    ds_read_b64_tr_b16 v[16:17], v12 offset:0
    ds_read_b64_tr_b16 v[18:19], v12 offset:176
    ds_read_b64_tr_b16 v[20:21], v12 offset:32
    ds_read_b64_tr_b16 v[22:23], v12 offset:208
    ds_read_b64_tr_b16 v[24:25], v12 offset:56
    ds_read_b64_tr_b16 v[26:27], v12 offset:232
    ds_read_b64_tr_b16 v[28:29], v12 offset:88
    ds_read_b64_tr_b16 v[30:31], v12 offset:264
    ds_read_b64_tr_b16 v[32:33], v12 offset:112
    ds_read_b64_tr_b16 v[34:35], v12 offset:288
    ds_read_b64_tr_b16 v[36:37], v12 offset:144
    ds_read_b64_tr_b16 v[38:39], v12 offset:320
    ds_read_b128 v[160:163], v79 offset:0
    s_waitcnt lgkmcnt(9)
    v_mfma_f32_16x16x32_bf16 v[80:83], v[16:19], v[128:131], 0
    ds_read_b128 v[136:139], v9 offset:0
    ds_read_b128 v[140:143], v9 offset:2048
    v_mfma_f32_16x16x32_bf16 v[88:91], v[16:19], v[132:135], 0
    ds_read_b64_tr_b16 v[40:41], v12 offset:5632
    ds_read_b64_tr_b16 v[42:43], v12 offset:5808
    v_mfma_f32_16x16x32_bf16 v[84:87], v[20:23], v[128:131], 0
    ds_read_b64_tr_b16 v[44:45], v12 offset:5664
    v_mfma_f32_16x16x32_bf16 v[92:95], v[20:23], v[132:135], 0
    ds_read_b64_tr_b16 v[46:47], v12 offset:5840
    s_waitcnt lgkmcnt(11)
    v_mfma_f32_16x16x32_bf16 v[96:99], v[24:27], v[128:131], 0
    ds_read_b64_tr_b16 v[16:17], v12 offset:5688
    v_mfma_f32_16x16x32_bf16 v[104:107], v[24:27], v[132:135], 0
    ds_read_b64_tr_b16 v[18:19], v12 offset:5864
    v_mfma_f32_16x16x32_bf16 v[100:103], v[28:31], v[128:131], 0
    ds_read_b64_tr_b16 v[20:21], v12 offset:5720
    v_mfma_f32_16x16x32_bf16 v[108:111], v[28:31], v[132:135], 0
    ds_read_b64_tr_b16 v[22:23], v12 offset:5896
    s_waitcnt lgkmcnt(10)
    v_mfma_f32_16x16x32_bf16 v[112:115], v[128:131], v[32:35], 0
    ds_read_b64_tr_b16 v[24:25], v12 offset:5744
    ds_read_b64_tr_b16 v[26:27], v12 offset:5920
    v_mfma_f32_16x16x32_bf16 v[116:119], v[132:135], v[32:35], 0
    ds_read_b64_tr_b16 v[28:29], v12 offset:5776
    v_mfma_f32_16x16x32_bf16 v[120:123], v[128:131], v[36:39], 0
    ds_read_b64_tr_b16 v[30:31], v12 offset:5952
    v_mfma_f32_16x16x32_bf16 v[124:127], v[132:135], v[36:39], 0
    ds_read_b128 v[168:171], v79 offset:64
    v_mfma_f32_16x16x32_bf16 v[240:243], v[160:163], v[128:131], 0
    v_mfma_f32_16x16x32_bf16 v[244:247], v[160:163], v[132:135], 0
    s_waitcnt lgkmcnt(9)
    s_barrier
    v_mfma_f32_16x16x32_bf16 v[80:83], v[40:43], v[136:139], v[80:83]
    ds_read_b128 v[144:147], v8 offset:16384
    ds_read_b128 v[148:151], v8 offset:18432
    v_mfma_f32_16x16x32_bf16 v[88:91], v[40:43], v[140:143], v[88:91]
    ds_read_b64_tr_b16 v[32:33], v12 offset:12288
    ds_read_b64_tr_b16 v[34:35], v12 offset:12464
    v_mfma_f32_16x16x32_bf16 v[84:87], v[44:47], v[136:139], v[84:87]
    ds_read_b64_tr_b16 v[36:37], v12 offset:12320
    v_mfma_f32_16x16x32_bf16 v[92:95], v[44:47], v[140:143], v[92:95]
    ds_read_b64_tr_b16 v[38:39], v12 offset:12496
    s_waitcnt lgkmcnt(11)
    v_mfma_f32_16x16x32_bf16 v[96:99], v[16:19], v[136:139], v[96:99]
    ds_read_b64_tr_b16 v[40:41], v12 offset:12344
    v_mfma_f32_16x16x32_bf16 v[104:107], v[16:19], v[140:143], v[104:107]
    ds_read_b64_tr_b16 v[42:43], v12 offset:12520
    v_mfma_f32_16x16x32_bf16 v[100:103], v[20:23], v[136:139], v[100:103]
    ds_read_b64_tr_b16 v[44:45], v12 offset:12376
    v_mfma_f32_16x16x32_bf16 v[108:111], v[20:23], v[140:143], v[108:111]
    ds_read_b64_tr_b16 v[46:47], v12 offset:12552
    s_waitcnt lgkmcnt(10)
    v_mfma_f32_16x16x32_bf16 v[112:115], v[136:139], v[24:27], v[112:115]
    ds_read_b64_tr_b16 v[16:17], v12 offset:12400
    ds_read_b64_tr_b16 v[18:19], v12 offset:12576
    v_mfma_f32_16x16x32_bf16 v[116:119], v[140:143], v[24:27], v[116:119]
    ds_read_b64_tr_b16 v[20:21], v12 offset:12432
    v_mfma_f32_16x16x32_bf16 v[120:123], v[136:139], v[28:31], v[120:123]
    ds_read_b64_tr_b16 v[22:23], v12 offset:12608
    v_mfma_f32_16x16x32_bf16 v[124:127], v[140:143], v[28:31], v[124:127]
    ds_read_b128 v[176:179], v79 offset:128
    v_mfma_f32_16x16x32_bf16 v[240:243], v[168:171], v[136:139], v[240:243]
    v_mfma_f32_16x16x32_bf16 v[244:247], v[168:171], v[140:143], v[244:247]
    s_waitcnt lgkmcnt(9)
    v_mfma_f32_16x16x32_bf16 v[80:83], v[32:35], v[144:147], v[80:83]
    ds_read_b128 v[152:155], v9 offset:16384
    ds_read_b128 v[156:159], v9 offset:18432
    v_mfma_f32_16x16x32_bf16 v[88:91], v[32:35], v[148:151], v[88:91]
    ds_read_b64_tr_b16 v[24:25], v12 offset:17920
    ds_read_b64_tr_b16 v[26:27], v12 offset:18096
    v_mfma_f32_16x16x32_bf16 v[84:87], v[36:39], v[144:147], v[84:87]
    ds_read_b64_tr_b16 v[28:29], v12 offset:17952
    v_mfma_f32_16x16x32_bf16 v[92:95], v[36:39], v[148:151], v[92:95]
    ds_read_b64_tr_b16 v[30:31], v12 offset:18128
    s_waitcnt lgkmcnt(11)
    v_mfma_f32_16x16x32_bf16 v[96:99], v[40:43], v[144:147], v[96:99]
    ds_read_b64_tr_b16 v[32:33], v12 offset:17976
    v_mfma_f32_16x16x32_bf16 v[104:107], v[40:43], v[148:151], v[104:107]
    ds_read_b64_tr_b16 v[34:35], v12 offset:18152
    v_mfma_f32_16x16x32_bf16 v[100:103], v[44:47], v[144:147], v[100:103]
    ds_read_b64_tr_b16 v[36:37], v12 offset:18008
    v_mfma_f32_16x16x32_bf16 v[108:111], v[44:47], v[148:151], v[108:111]
    ds_read_b64_tr_b16 v[38:39], v12 offset:18184
    s_waitcnt lgkmcnt(10)
    v_mfma_f32_16x16x32_bf16 v[112:115], v[144:147], v[16:19], v[112:115]
    ds_read_b64_tr_b16 v[40:41], v12 offset:18032
    ds_read_b64_tr_b16 v[42:43], v12 offset:18208
    v_mfma_f32_16x16x32_bf16 v[116:119], v[148:151], v[16:19], v[116:119]
    ds_read_b64_tr_b16 v[44:45], v12 offset:18064
    v_mfma_f32_16x16x32_bf16 v[120:123], v[144:147], v[20:23], v[120:123]
    ds_read_b64_tr_b16 v[46:47], v12 offset:18240
    v_mfma_f32_16x16x32_bf16 v[124:127], v[148:151], v[20:23], v[124:127]
    ds_read_b128 v[184:187], v79 offset:192
    v_mfma_f32_16x16x32_bf16 v[240:243], v[176:179], v[144:147], v[240:243]
    v_mfma_f32_16x16x32_bf16 v[244:247], v[176:179], v[148:151], v[244:247]
    s_waitcnt lgkmcnt(9)
    s_barrier
    v_mfma_f32_16x16x32_bf16 v[80:83], v[24:27], v[152:155], v[80:83]
    ds_read_b128 v[160:163], v8 offset:32768
    ds_read_b128 v[164:167], v8 offset:34816
    v_mfma_f32_16x16x32_bf16 v[88:91], v[24:27], v[156:159], v[88:91]
    ds_read_b64_tr_b16 v[16:17], v12 offset:24576
    ds_read_b64_tr_b16 v[18:19], v12 offset:24752
    v_mfma_f32_16x16x32_bf16 v[84:87], v[28:31], v[152:155], v[84:87]
    ds_read_b64_tr_b16 v[20:21], v12 offset:24608
    v_mfma_f32_16x16x32_bf16 v[92:95], v[28:31], v[156:159], v[92:95]
    ds_read_b64_tr_b16 v[22:23], v12 offset:24784
    s_waitcnt lgkmcnt(11)
    v_mfma_f32_16x16x32_bf16 v[96:99], v[32:35], v[152:155], v[96:99]
    ds_read_b64_tr_b16 v[24:25], v12 offset:24632
    v_mfma_f32_16x16x32_bf16 v[104:107], v[32:35], v[156:159], v[104:107]
    ds_read_b64_tr_b16 v[26:27], v12 offset:24808
    v_mfma_f32_16x16x32_bf16 v[100:103], v[36:39], v[152:155], v[100:103]
    ds_read_b64_tr_b16 v[28:29], v12 offset:24664
    v_mfma_f32_16x16x32_bf16 v[108:111], v[36:39], v[156:159], v[108:111]
    ds_read_b64_tr_b16 v[30:31], v12 offset:24840
    s_waitcnt lgkmcnt(10)
    v_mfma_f32_16x16x32_bf16 v[112:115], v[152:155], v[40:43], v[112:115]
    ds_read_b64_tr_b16 v[32:33], v12 offset:24688
    ds_read_b64_tr_b16 v[34:35], v12 offset:24864
    v_mfma_f32_16x16x32_bf16 v[116:119], v[156:159], v[40:43], v[116:119]
    ds_read_b64_tr_b16 v[36:37], v12 offset:24720
    v_mfma_f32_16x16x32_bf16 v[120:123], v[152:155], v[44:47], v[120:123]
    ds_read_b64_tr_b16 v[38:39], v12 offset:24896
    v_mfma_f32_16x16x32_bf16 v[124:127], v[156:159], v[44:47], v[124:127]
    ds_read_b128 v[192:195], v79 offset:256
    v_mfma_f32_16x16x32_bf16 v[240:243], v[184:187], v[152:155], v[240:243]
    v_mfma_f32_16x16x32_bf16 v[244:247], v[184:187], v[156:159], v[244:247]
    s_waitcnt lgkmcnt(9)
    v_mfma_f32_16x16x32_bf16 v[80:83], v[16:19], v[160:163], v[80:83]
    ds_read_b128 v[168:171], v9 offset:32768
    ds_read_b128 v[172:175], v9 offset:34816
    v_mfma_f32_16x16x32_bf16 v[88:91], v[16:19], v[164:167], v[88:91]
    ds_read_b64_tr_b16 v[40:41], v12 offset:30208
    ds_read_b64_tr_b16 v[42:43], v12 offset:30384
    v_mfma_f32_16x16x32_bf16 v[84:87], v[20:23], v[160:163], v[84:87]
    ds_read_b64_tr_b16 v[44:45], v12 offset:30240
    v_mfma_f32_16x16x32_bf16 v[92:95], v[20:23], v[164:167], v[92:95]
    ds_read_b64_tr_b16 v[46:47], v12 offset:30416
    s_waitcnt lgkmcnt(11)
    v_mfma_f32_16x16x32_bf16 v[96:99], v[24:27], v[160:163], v[96:99]
    ds_read_b64_tr_b16 v[16:17], v12 offset:30264
    v_mfma_f32_16x16x32_bf16 v[104:107], v[24:27], v[164:167], v[104:107]
    ds_read_b64_tr_b16 v[18:19], v12 offset:30440
    v_mfma_f32_16x16x32_bf16 v[100:103], v[28:31], v[160:163], v[100:103]
    ds_read_b64_tr_b16 v[20:21], v12 offset:30296
    v_mfma_f32_16x16x32_bf16 v[108:111], v[28:31], v[164:167], v[108:111]
    ds_read_b64_tr_b16 v[22:23], v12 offset:30472
    s_waitcnt lgkmcnt(10)
    v_mfma_f32_16x16x32_bf16 v[112:115], v[160:163], v[32:35], v[112:115]
    ds_read_b64_tr_b16 v[24:25], v12 offset:30320
    ds_read_b64_tr_b16 v[26:27], v12 offset:30496
    v_mfma_f32_16x16x32_bf16 v[116:119], v[164:167], v[32:35], v[116:119]
    ds_read_b64_tr_b16 v[28:29], v12 offset:30352
    v_mfma_f32_16x16x32_bf16 v[120:123], v[160:163], v[36:39], v[120:123]
    ds_read_b64_tr_b16 v[30:31], v12 offset:30528
    v_mfma_f32_16x16x32_bf16 v[124:127], v[164:167], v[36:39], v[124:127]
    ds_read_b128 v[200:203], v79 offset:320
    v_mfma_f32_16x16x32_bf16 v[240:243], v[192:195], v[160:163], v[240:243]
    v_mfma_f32_16x16x32_bf16 v[244:247], v[192:195], v[164:167], v[244:247]
    v_lshlrev_b32 v2, 3, v1
    v_mov_b32 v76, 0
    v_mov_b32 v77, 0
    s_add_u32 s46, s45, 2048
    s_mov_b64 exec, 0xffff
    buffer_store_dwordx2 v[76:77], v2, s[28:31], s45 offen sc1
    s_mov_b64 exec, -1
    s_mov_b64 exec, 0xffff
    buffer_store_dwordx2 v[76:77], v2, s[28:31], s46 offen sc1
    s_mov_b64 exec, -1
    s_waitcnt lgkmcnt(9)
    s_barrier
    v_mfma_f32_16x16x32_bf16 v[80:83], v[40:43], v[168:171], v[80:83]
    ds_read_b128 v[176:179], v8 offset:49152
    ds_read_b128 v[180:183], v8 offset:51200
    v_mfma_f32_16x16x32_bf16 v[88:91], v[40:43], v[172:175], v[88:91]
    ds_read_b64_tr_b16 v[32:33], v12 offset:36864
    ds_read_b64_tr_b16 v[34:35], v12 offset:37040
    v_mfma_f32_16x16x32_bf16 v[84:87], v[44:47], v[168:171], v[84:87]
    ds_read_b64_tr_b16 v[36:37], v12 offset:36896
    v_mfma_f32_16x16x32_bf16 v[92:95], v[44:47], v[172:175], v[92:95]
    ds_read_b64_tr_b16 v[38:39], v12 offset:37072
    s_waitcnt lgkmcnt(11)
    v_mfma_f32_16x16x32_bf16 v[96:99], v[16:19], v[168:171], v[96:99]
    ds_read_b64_tr_b16 v[40:41], v12 offset:36920
    v_mfma_f32_16x16x32_bf16 v[104:107], v[16:19], v[172:175], v[104:107]
    ds_read_b64_tr_b16 v[42:43], v12 offset:37096
    v_mfma_f32_16x16x32_bf16 v[100:103], v[20:23], v[168:171], v[100:103]
    ds_read_b64_tr_b16 v[44:45], v12 offset:36952
    v_mfma_f32_16x16x32_bf16 v[108:111], v[20:23], v[172:175], v[108:111]
    ds_read_b64_tr_b16 v[46:47], v12 offset:37128
    s_waitcnt lgkmcnt(10)
    v_mfma_f32_16x16x32_bf16 v[112:115], v[168:171], v[24:27], v[112:115]
    ds_read_b64_tr_b16 v[16:17], v12 offset:36976
    ds_read_b64_tr_b16 v[18:19], v12 offset:37152
    v_mfma_f32_16x16x32_bf16 v[116:119], v[172:175], v[24:27], v[116:119]
    ds_read_b64_tr_b16 v[20:21], v12 offset:37008
    v_mfma_f32_16x16x32_bf16 v[120:123], v[168:171], v[28:31], v[120:123]
    ds_read_b64_tr_b16 v[22:23], v12 offset:37184
    v_mfma_f32_16x16x32_bf16 v[124:127], v[172:175], v[28:31], v[124:127]
    ds_read_b128 v[208:211], v79 offset:384
    v_mfma_f32_16x16x32_bf16 v[240:243], v[200:203], v[168:171], v[240:243]
    v_mfma_f32_16x16x32_bf16 v[244:247], v[200:203], v[172:175], v[244:247]
    s_waitcnt lgkmcnt(9)
    v_mfma_f32_16x16x32_bf16 v[80:83], v[32:35], v[176:179], v[80:83]
    ds_read_b128 v[184:187], v9 offset:49152
    ds_read_b128 v[188:191], v9 offset:51200
    v_mfma_f32_16x16x32_bf16 v[88:91], v[32:35], v[180:183], v[88:91]
    ds_read_b64_tr_b16 v[24:25], v12 offset:42496
    ds_read_b64_tr_b16 v[26:27], v12 offset:42672
    v_mfma_f32_16x16x32_bf16 v[84:87], v[36:39], v[176:179], v[84:87]
    ds_read_b64_tr_b16 v[28:29], v12 offset:42528
    v_mfma_f32_16x16x32_bf16 v[92:95], v[36:39], v[180:183], v[92:95]
    ds_read_b64_tr_b16 v[30:31], v12 offset:42704
    s_waitcnt lgkmcnt(11)
    v_mfma_f32_16x16x32_bf16 v[96:99], v[40:43], v[176:179], v[96:99]
    ds_read_b64_tr_b16 v[32:33], v12 offset:42552
    v_mfma_f32_16x16x32_bf16 v[104:107], v[40:43], v[180:183], v[104:107]
    ds_read_b64_tr_b16 v[34:35], v12 offset:42728
    v_mfma_f32_16x16x32_bf16 v[100:103], v[44:47], v[176:179], v[100:103]
    ds_read_b64_tr_b16 v[36:37], v12 offset:42584
    v_mfma_f32_16x16x32_bf16 v[108:111], v[44:47], v[180:183], v[108:111]
    ds_read_b64_tr_b16 v[38:39], v12 offset:42760
    s_waitcnt lgkmcnt(10)
    v_mfma_f32_16x16x32_bf16 v[112:115], v[176:179], v[16:19], v[112:115]
    ds_read_b64_tr_b16 v[40:41], v12 offset:42608
    ds_read_b64_tr_b16 v[42:43], v12 offset:42784
    v_mfma_f32_16x16x32_bf16 v[116:119], v[180:183], v[16:19], v[116:119]
    ds_read_b64_tr_b16 v[44:45], v12 offset:42640
    v_mfma_f32_16x16x32_bf16 v[120:123], v[176:179], v[20:23], v[120:123]
    ds_read_b64_tr_b16 v[46:47], v12 offset:42816
    v_mfma_f32_16x16x32_bf16 v[124:127], v[180:183], v[20:23], v[124:127]
    ds_read_b128 v[216:219], v79 offset:448
    v_mfma_f32_16x16x32_bf16 v[240:243], v[208:211], v[176:179], v[240:243]
    v_mfma_f32_16x16x32_bf16 v[244:247], v[208:211], v[180:183], v[244:247]
    s_waitcnt lgkmcnt(9)
    s_barrier
    v_mfma_f32_16x16x32_bf16 v[80:83], v[24:27], v[184:187], v[80:83]
    ds_read_b128 v[192:195], v8 offset:0
    ds_read_b128 v[196:199], v8 offset:2048
    v_mfma_f32_16x16x32_bf16 v[88:91], v[24:27], v[188:191], v[88:91]
    ds_read_b64_tr_b16 v[16:17], v12 offset:49152
    ds_read_b64_tr_b16 v[18:19], v12 offset:49328
    v_mfma_f32_16x16x32_bf16 v[84:87], v[28:31], v[184:187], v[84:87]
    ds_read_b64_tr_b16 v[20:21], v12 offset:49184
    v_mfma_f32_16x16x32_bf16 v[92:95], v[28:31], v[188:191], v[92:95]
    ds_read_b64_tr_b16 v[22:23], v12 offset:49360
    s_waitcnt lgkmcnt(11)
    v_mfma_f32_16x16x32_bf16 v[96:99], v[32:35], v[184:187], v[96:99]
    ds_read_b64_tr_b16 v[24:25], v12 offset:49208
    v_mfma_f32_16x16x32_bf16 v[104:107], v[32:35], v[188:191], v[104:107]
    ds_read_b64_tr_b16 v[26:27], v12 offset:49384
    v_mfma_f32_16x16x32_bf16 v[100:103], v[36:39], v[184:187], v[100:103]
    ds_read_b64_tr_b16 v[28:29], v12 offset:49240
    v_mfma_f32_16x16x32_bf16 v[108:111], v[36:39], v[188:191], v[108:111]
    ds_read_b64_tr_b16 v[30:31], v12 offset:49416
    buffer_load_dwordx2 v[76:77], off, s[96:99], 0 sc1
    s_waitcnt lgkmcnt(10)
    v_mfma_f32_16x16x32_bf16 v[112:115], v[184:187], v[40:43], v[112:115]
    ds_read_b64_tr_b16 v[32:33], v12 offset:49264
    ds_read_b64_tr_b16 v[34:35], v12 offset:49440
    v_mfma_f32_16x16x32_bf16 v[116:119], v[188:191], v[40:43], v[116:119]
    ds_read_b64_tr_b16 v[36:37], v12 offset:49296
    v_mfma_f32_16x16x32_bf16 v[120:123], v[184:187], v[44:47], v[120:123]
    ds_read_b64_tr_b16 v[38:39], v12 offset:49472
    v_mfma_f32_16x16x32_bf16 v[124:127], v[188:191], v[44:47], v[124:127]
    ds_read_b128 v[224:227], v79 offset:512
    v_mfma_f32_16x16x32_bf16 v[240:243], v[216:219], v[184:187], v[240:243]
    v_mfma_f32_16x16x32_bf16 v[244:247], v[216:219], v[188:191], v[244:247]
    s_waitcnt lgkmcnt(9)
    v_mfma_f32_16x16x32_bf16 v[80:83], v[16:19], v[192:195], v[80:83]
    ds_read_b128 v[200:203], v9 offset:0
    ds_read_b128 v[204:207], v9 offset:2048
    v_mfma_f32_16x16x32_bf16 v[88:91], v[16:19], v[196:199], v[88:91]
    ds_read_b64_tr_b16 v[40:41], v12 offset:54784
    ds_read_b64_tr_b16 v[42:43], v12 offset:54960
    v_mfma_f32_16x16x32_bf16 v[84:87], v[20:23], v[192:195], v[84:87]
    ds_read_b64_tr_b16 v[44:45], v12 offset:54816
    v_mfma_f32_16x16x32_bf16 v[92:95], v[20:23], v[196:199], v[92:95]
    ds_read_b64_tr_b16 v[46:47], v12 offset:54992
    s_waitcnt lgkmcnt(11)
    v_mfma_f32_16x16x32_bf16 v[96:99], v[24:27], v[192:195], v[96:99]
    ds_read_b64_tr_b16 v[16:17], v12 offset:54840
    v_mfma_f32_16x16x32_bf16 v[104:107], v[24:27], v[196:199], v[104:107]
    ds_read_b64_tr_b16 v[18:19], v12 offset:55016
    v_mfma_f32_16x16x32_bf16 v[100:103], v[28:31], v[192:195], v[100:103]
    ds_read_b64_tr_b16 v[20:21], v12 offset:54872
    v_mfma_f32_16x16x32_bf16 v[108:111], v[28:31], v[196:199], v[108:111]
    ds_read_b64_tr_b16 v[22:23], v12 offset:55048
    s_waitcnt lgkmcnt(10)
    v_mfma_f32_16x16x32_bf16 v[112:115], v[192:195], v[32:35], v[112:115]
    ds_read_b64_tr_b16 v[24:25], v12 offset:54896
    ds_read_b64_tr_b16 v[26:27], v12 offset:55072
    v_mfma_f32_16x16x32_bf16 v[116:119], v[196:199], v[32:35], v[116:119]
    ds_read_b64_tr_b16 v[28:29], v12 offset:54928
    v_mfma_f32_16x16x32_bf16 v[120:123], v[192:195], v[36:39], v[120:123]
    ds_read_b64_tr_b16 v[30:31], v12 offset:55104
    v_mfma_f32_16x16x32_bf16 v[124:127], v[196:199], v[36:39], v[124:127]
    ds_read_b128 v[232:235], v79 offset:576
    v_mfma_f32_16x16x32_bf16 v[240:243], v[224:227], v[192:195], v[240:243]
    v_mfma_f32_16x16x32_bf16 v[244:247], v[224:227], v[196:199], v[244:247]
    s_waitcnt lgkmcnt(9)
    s_barrier
    v_mfma_f32_16x16x32_bf16 v[80:83], v[40:43], v[200:203], v[80:83]
    ds_read_b128 v[208:211], v8 offset:16384
    ds_read_b128 v[212:215], v8 offset:18432
    v_mfma_f32_16x16x32_bf16 v[88:91], v[40:43], v[204:207], v[88:91]
    ds_read_b64_tr_b16 v[32:33], v12 offset:0
    ds_read_b64_tr_b16 v[34:35], v12 offset:176
    v_mfma_f32_16x16x32_bf16 v[84:87], v[44:47], v[200:203], v[84:87]
    ds_read_b64_tr_b16 v[36:37], v12 offset:32
    v_mfma_f32_16x16x32_bf16 v[92:95], v[44:47], v[204:207], v[92:95]
    ds_read_b64_tr_b16 v[38:39], v12 offset:208
    s_waitcnt lgkmcnt(11)
    v_mfma_f32_16x16x32_bf16 v[96:99], v[16:19], v[200:203], v[96:99]
    ds_read_b64_tr_b16 v[40:41], v12 offset:56
    v_mfma_f32_16x16x32_bf16 v[104:107], v[16:19], v[204:207], v[104:107]
    ds_read_b64_tr_b16 v[42:43], v12 offset:232
    v_mfma_f32_16x16x32_bf16 v[100:103], v[20:23], v[200:203], v[100:103]
    ds_read_b64_tr_b16 v[44:45], v12 offset:88
    v_mfma_f32_16x16x32_bf16 v[108:111], v[20:23], v[204:207], v[108:111]
    ds_read_b64_tr_b16 v[46:47], v12 offset:264
    s_waitcnt lgkmcnt(10)
    v_mfma_f32_16x16x32_bf16 v[112:115], v[200:203], v[24:27], v[112:115]
    ds_read_b64_tr_b16 v[16:17], v12 offset:112
    v_mfma_f32_16x16x32_bf16 v[116:119], v[204:207], v[24:27], v[116:119]
    ds_read_b64_tr_b16 v[18:19], v12 offset:288
    v_mfma_f32_16x16x32_bf16 v[120:123], v[200:203], v[28:31], v[120:123]
    ds_read_b64_tr_b16 v[20:21], v12 offset:144
    v_mfma_f32_16x16x32_bf16 v[124:127], v[204:207], v[28:31], v[124:127]
    ds_read_b64_tr_b16 v[22:23], v12 offset:320
    v_mfma_f32_16x16x32_bf16 v[240:243], v[232:235], v[200:203], v[240:243]
    v_mfma_f32_16x16x32_bf16 v[244:247], v[232:235], v[204:207], v[244:247]
    s_waitcnt lgkmcnt(8)
    v_mfma_f32_16x16x32_bf16 v[80:83], v[32:35], v[208:211], v[80:83]
    ds_read_b128 v[216:219], v9 offset:16384
    ds_read_b128 v[220:223], v9 offset:18432
    v_mfma_f32_16x16x32_bf16 v[88:91], v[32:35], v[212:215], v[88:91]
    ds_read_b64_tr_b16 v[24:25], v12 offset:5632
    ds_read_b64_tr_b16 v[26:27], v12 offset:5808
    v_mfma_f32_16x16x32_bf16 v[84:87], v[36:39], v[208:211], v[84:87]
    ds_read_b64_tr_b16 v[28:29], v12 offset:5664
    v_mfma_f32_16x16x32_bf16 v[92:95], v[36:39], v[212:215], v[92:95]
    ds_read_b64_tr_b16 v[30:31], v12 offset:5840
    s_waitcnt lgkmcnt(10)
    v_mfma_f32_16x16x32_bf16 v[96:99], v[40:43], v[208:211], v[96:99]
    ds_read_b64_tr_b16 v[32:33], v12 offset:5688
    v_mfma_f32_16x16x32_bf16 v[104:107], v[40:43], v[212:215], v[104:107]
    ds_read_b64_tr_b16 v[34:35], v12 offset:5864
    v_mfma_f32_16x16x32_bf16 v[100:103], v[44:47], v[208:211], v[100:103]
    ds_read_b64_tr_b16 v[36:37], v12 offset:5720
    v_mfma_f32_16x16x32_bf16 v[108:111], v[44:47], v[212:215], v[108:111]
    ds_read_b64_tr_b16 v[38:39], v12 offset:5896
    s_waitcnt lgkmcnt(10)
    v_mfma_f32_16x16x32_bf16 v[112:115], v[208:211], v[16:19], v[112:115]
    ds_read_b64_tr_b16 v[40:41], v12 offset:5744
    v_mfma_f32_16x16x32_bf16 v[116:119], v[212:215], v[16:19], v[116:119]
    ds_read_b64_tr_b16 v[42:43], v12 offset:5920
    v_mfma_f32_16x16x32_bf16 v[120:123], v[208:211], v[20:23], v[120:123]
    ds_read_b64_tr_b16 v[44:45], v12 offset:5776
    v_mfma_f32_16x16x32_bf16 v[124:127], v[212:215], v[20:23], v[124:127]
    ds_read_b64_tr_b16 v[46:47], v12 offset:5952
    s_waitcnt lgkmcnt(8)
    s_barrier
    v_mfma_f32_16x16x32_bf16 v[80:83], v[24:27], v[216:219], v[80:83]
    ds_read_b128 v[224:227], v8 offset:32768
    ds_read_b128 v[228:231], v8 offset:34816
    v_mfma_f32_16x16x32_bf16 v[88:91], v[24:27], v[220:223], v[88:91]
    ds_read_b64_tr_b16 v[16:17], v12 offset:12288
    ds_read_b64_tr_b16 v[18:19], v12 offset:12464
    v_mfma_f32_16x16x32_bf16 v[84:87], v[28:31], v[216:219], v[84:87]
    ds_read_b64_tr_b16 v[20:21], v12 offset:12320
    v_mfma_f32_16x16x32_bf16 v[92:95], v[28:31], v[220:223], v[92:95]
    ds_read_b64_tr_b16 v[22:23], v12 offset:12496
    s_waitcnt lgkmcnt(10)
    v_mfma_f32_16x16x32_bf16 v[96:99], v[32:35], v[216:219], v[96:99]
    ds_read_b64_tr_b16 v[24:25], v12 offset:12344
    v_mfma_f32_16x16x32_bf16 v[104:107], v[32:35], v[220:223], v[104:107]
    ds_read_b64_tr_b16 v[26:27], v12 offset:12520
    v_mfma_f32_16x16x32_bf16 v[100:103], v[36:39], v[216:219], v[100:103]
    ds_read_b64_tr_b16 v[28:29], v12 offset:12376
    v_mfma_f32_16x16x32_bf16 v[108:111], v[36:39], v[220:223], v[108:111]
    ds_read_b64_tr_b16 v[30:31], v12 offset:12552
    s_waitcnt lgkmcnt(10)
    v_mfma_f32_16x16x32_bf16 v[112:115], v[216:219], v[40:43], v[112:115]
    ds_read_b64_tr_b16 v[32:33], v12 offset:12400
    v_mfma_f32_16x16x32_bf16 v[116:119], v[220:223], v[40:43], v[116:119]
    ds_read_b64_tr_b16 v[34:35], v12 offset:12576
    v_mfma_f32_16x16x32_bf16 v[120:123], v[216:219], v[44:47], v[120:123]
    ds_read_b64_tr_b16 v[36:37], v12 offset:12432
    v_mfma_f32_16x16x32_bf16 v[124:127], v[220:223], v[44:47], v[124:127]
    ds_read_b64_tr_b16 v[38:39], v12 offset:12608
    s_waitcnt lgkmcnt(8)
    v_mfma_f32_16x16x32_bf16 v[80:83], v[16:19], v[224:227], v[80:83]
    ds_read_b128 v[232:235], v9 offset:32768
    ds_read_b128 v[236:239], v9 offset:34816
    v_mfma_f32_16x16x32_bf16 v[88:91], v[16:19], v[228:231], v[88:91]
    ds_read_b64_tr_b16 v[40:41], v12 offset:17920
    ds_read_b64_tr_b16 v[42:43], v12 offset:18096
    v_mfma_f32_16x16x32_bf16 v[84:87], v[20:23], v[224:227], v[84:87]
    ds_read_b64_tr_b16 v[44:45], v12 offset:17952
    v_mfma_f32_16x16x32_bf16 v[92:95], v[20:23], v[228:231], v[92:95]
    ds_read_b64_tr_b16 v[46:47], v12 offset:18128
    s_waitcnt lgkmcnt(10)
    v_mfma_f32_16x16x32_bf16 v[96:99], v[24:27], v[224:227], v[96:99]
    ds_read_b64_tr_b16 v[16:17], v12 offset:17976
    v_mfma_f32_16x16x32_bf16 v[104:107], v[24:27], v[228:231], v[104:107]
    ds_read_b64_tr_b16 v[18:19], v12 offset:18152
    v_mfma_f32_16x16x32_bf16 v[100:103], v[28:31], v[224:227], v[100:103]
    ds_read_b64_tr_b16 v[20:21], v12 offset:18008
    v_mfma_f32_16x16x32_bf16 v[108:111], v[28:31], v[228:231], v[108:111]
    ds_read_b64_tr_b16 v[22:23], v12 offset:18184
    s_waitcnt lgkmcnt(10)
    v_mfma_f32_16x16x32_bf16 v[112:115], v[224:227], v[32:35], v[112:115]
    ds_read_b64_tr_b16 v[24:25], v12 offset:18032
    v_mfma_f32_16x16x32_bf16 v[116:119], v[228:231], v[32:35], v[116:119]
    ds_read_b64_tr_b16 v[26:27], v12 offset:18208
    v_mfma_f32_16x16x32_bf16 v[120:123], v[224:227], v[36:39], v[120:123]
    ds_read_b64_tr_b16 v[28:29], v12 offset:18064
    v_mfma_f32_16x16x32_bf16 v[124:127], v[228:231], v[36:39], v[124:127]
    ds_read_b64_tr_b16 v[30:31], v12 offset:18240
    s_waitcnt lgkmcnt(8)
    v_mfma_f32_16x16x32_bf16 v[80:83], v[40:43], v[232:235], v[80:83]
    v_mfma_f32_16x16x32_bf16 v[88:91], v[40:43], v[236:239], v[88:91]
    v_mfma_f32_16x16x32_bf16 v[84:87], v[44:47], v[232:235], v[84:87]
    v_mfma_f32_16x16x32_bf16 v[92:95], v[44:47], v[236:239], v[92:95]
    s_waitcnt lgkmcnt(4)
    v_mfma_f32_16x16x32_bf16 v[96:99], v[16:19], v[232:235], v[96:99]
    v_mfma_f32_16x16x32_bf16 v[104:107], v[16:19], v[236:239], v[104:107]
    v_mfma_f32_16x16x32_bf16 v[100:103], v[20:23], v[232:235], v[100:103]
    v_mfma_f32_16x16x32_bf16 v[108:111], v[20:23], v[236:239], v[108:111]
    s_nop 1
    s_waitcnt lgkmcnt(0)
    v_mfma_f32_16x16x32_bf16 v[112:115], v[232:235], v[24:27], v[112:115]
    v_mfma_f32_16x16x32_bf16 v[116:119], v[236:239], v[24:27], v[116:119]
    v_mfma_f32_16x16x32_bf16 v[120:123], v[232:235], v[28:31], v[120:123]
    v_mfma_f32_16x16x32_bf16 v[124:127], v[236:239], v[28:31], v[124:127]
    ds_read_b128 v[32:35], v79 offset:640
    ds_read_b128 v[36:39], v79 offset:704
    ds_read_b128 v[40:43], v79 offset:768
    ds_read_b128 v[44:47], v79 offset:832
    v_cvt_pk_bf16_f32 v52, v80, v81
    v_cvt_pk_bf16_f32 v53, v82, v83
    v_cvt_pk_bf16_f32 v56, v88, v89
    v_cvt_pk_bf16_f32 v57, v90, v91
    s_mov_b32 exec_hi, 0xffff
    v_cvt_pk_bf16_f32 v54, v84, v85
    v_cvt_pk_bf16_f32 v55, v86, v87
    v_cvt_pk_bf16_f32 v58, v92, v93
    v_cvt_pk_bf16_f32 v59, v94, v95
    s_mov_b32 exec_hi, -1
    buffer_store_dwordx4 v[52:55], v14, s[28:31], s54 offen sc1
    buffer_store_dwordx4 v[56:59], v14, s[28:31], s54 offen offset:256 sc1
    v_cvt_pk_bf16_f32 v60, v96, v97
    v_cvt_pk_bf16_f32 v61, v98, v99
    v_cvt_pk_bf16_f32 v64, v104, v105
    v_cvt_pk_bf16_f32 v65, v106, v107
    s_mov_b32 exec_hi, 0xffff
    v_cvt_pk_bf16_f32 v62, v100, v101
    v_cvt_pk_bf16_f32 v63, v102, v103
    v_cvt_pk_bf16_f32 v66, v108, v109
    v_cvt_pk_bf16_f32 v67, v110, v111
    s_mov_b32 exec_hi, -1
    buffer_store_dwordx4 v[60:63], v14, s[28:31], s55 offen sc1
    buffer_store_dwordx4 v[64:67], v14, s[28:31], s55 offen offset:256 sc1
    v_cvt_pk_bf16_f32 v68, v112, v113
    v_cvt_pk_bf16_f32 v69, v114, v115
    v_cvt_pk_bf16_f32 v70, v116, v117
    v_cvt_pk_bf16_f32 v71, v118, v119
    s_mov_b32 exec_lo, 0x0fff0fff
    s_mov_b32 exec_hi, 0x0fff0fff
    v_cvt_pk_bf16_f32 v72, v120, v121
    v_cvt_pk_bf16_f32 v73, v122, v123
    v_cvt_pk_bf16_f32 v74, v124, v125
    v_cvt_pk_bf16_f32 v75, v126, v127
    s_mov_b64 exec, -1
    buffer_store_dwordx4 v[68:71], v14, s[28:31], s17 offen sc1
    buffer_store_dwordx4 v[72:75], v14, s[28:31], s17 offen offset:256 sc1
    s_waitcnt lgkmcnt(0)
    v_mfma_f32_16x16x32_bf16 v[240:243], v[32:35], v[208:211], v[240:243]
    v_mfma_f32_16x16x32_bf16 v[244:247], v[32:35], v[212:215], v[244:247]
    v_mfma_f32_16x16x32_bf16 v[240:243], v[36:39], v[216:219], v[240:243]
    v_mfma_f32_16x16x32_bf16 v[244:247], v[36:39], v[220:223], v[244:247]
    v_mfma_f32_16x16x32_bf16 v[240:243], v[40:43], v[224:227], v[240:243]
    v_mfma_f32_16x16x32_bf16 v[244:247], v[40:43], v[228:231], v[244:247]
    v_mfma_f32_16x16x32_bf16 v[240:243], v[44:47], v[232:235], v[240:243]
    v_mfma_f32_16x16x32_bf16 v[244:247], v[44:47], v[236:239], v[244:247]
    s_barrier
    ds_read_b64_tr_b16 v[16:17], v6 offset:0
    ds_read_b64_tr_b16 v[18:19], v6 offset:176
    ds_read_b64_tr_b16 v[20:21], v6 offset:32
    ds_read_b64_tr_b16 v[22:23], v6 offset:208
    ds_read_b64_tr_b16 v[24:25], v6 offset:56
    ds_read_b64_tr_b16 v[26:27], v6 offset:232
    ds_read_b64_tr_b16 v[28:29], v6 offset:88
    ds_read_b64_tr_b16 v[30:31], v6 offset:264
    ds_read_b64_tr_b16 v[32:33], v6 offset:112
    ds_read_b64_tr_b16 v[34:35], v6 offset:288
    ds_read_b64_tr_b16 v[36:37], v6 offset:144
    ds_read_b64_tr_b16 v[38:39], v6 offset:320
    s_waitcnt lgkmcnt(8)
    v_mfma_f32_16x16x32_bf16 v[80:83], v[16:19], v[128:131], 0
    ds_read_b64_tr_b16 v[40:41], v6 offset:5632
    v_mfma_f32_16x16x32_bf16 v[88:91], v[16:19], v[132:135], 0
    ds_read_b64_tr_b16 v[42:43], v6 offset:5808
    v_mfma_f32_16x16x32_bf16 v[84:87], v[20:23], v[128:131], 0
    ds_read_b64_tr_b16 v[44:45], v6 offset:5664
    v_mfma_f32_16x16x32_bf16 v[92:95], v[20:23], v[132:135], 0
    ds_read_b64_tr_b16 v[46:47], v6 offset:5840
    s_waitcnt lgkmcnt(8)
    v_mfma_f32_16x16x32_bf16 v[96:99], v[24:27], v[128:131], 0
    ds_read_b64_tr_b16 v[16:17], v6 offset:5688
    v_mfma_f32_16x16x32_bf16 v[104:107], v[24:27], v[132:135], 0
    ds_read_b64_tr_b16 v[18:19], v6 offset:5864
    v_mfma_f32_16x16x32_bf16 v[100:103], v[28:31], v[128:131], 0
    ds_read_b64_tr_b16 v[20:21], v6 offset:5720
    v_mfma_f32_16x16x32_bf16 v[108:111], v[28:31], v[132:135], 0
    ds_read_b64_tr_b16 v[22:23], v6 offset:5896
    s_waitcnt lgkmcnt(8)
    v_mfma_f32_16x16x32_bf16 v[112:115], v[128:131], v[32:35], 0
    ds_read_b64_tr_b16 v[24:25], v6 offset:5744
    v_mfma_f32_16x16x32_bf16 v[116:119], v[132:135], v[32:35], 0
    ds_read_b64_tr_b16 v[26:27], v6 offset:5920
    v_mfma_f32_16x16x32_bf16 v[120:123], v[128:131], v[36:39], 0
    ds_read_b64_tr_b16 v[28:29], v6 offset:5776
    v_mfma_f32_16x16x32_bf16 v[124:127], v[132:135], v[36:39], 0
    ds_read_b64_tr_b16 v[30:31], v6 offset:5952
    s_waitcnt lgkmcnt(8)
    v_mfma_f32_16x16x32_bf16 v[80:83], v[40:43], v[136:139], v[80:83]
    ds_read_b64_tr_b16 v[32:33], v6 offset:12288
    v_mfma_f32_16x16x32_bf16 v[88:91], v[40:43], v[140:143], v[88:91]
    ds_read_b64_tr_b16 v[34:35], v6 offset:12464
    v_mfma_f32_16x16x32_bf16 v[84:87], v[44:47], v[136:139], v[84:87]
    ds_read_b64_tr_b16 v[36:37], v6 offset:12320
    v_mfma_f32_16x16x32_bf16 v[92:95], v[44:47], v[140:143], v[92:95]
    ds_read_b64_tr_b16 v[38:39], v6 offset:12496
    s_waitcnt lgkmcnt(8)
    v_mfma_f32_16x16x32_bf16 v[96:99], v[16:19], v[136:139], v[96:99]
    ds_read_b64_tr_b16 v[40:41], v6 offset:12344
    v_mfma_f32_16x16x32_bf16 v[104:107], v[16:19], v[140:143], v[104:107]
    ds_read_b64_tr_b16 v[42:43], v6 offset:12520
    v_mfma_f32_16x16x32_bf16 v[100:103], v[20:23], v[136:139], v[100:103]
    ds_read_b64_tr_b16 v[44:45], v6 offset:12376
    v_mfma_f32_16x16x32_bf16 v[108:111], v[20:23], v[140:143], v[108:111]
    ds_read_b64_tr_b16 v[46:47], v6 offset:12552
    s_waitcnt lgkmcnt(8)
    v_mfma_f32_16x16x32_bf16 v[112:115], v[136:139], v[24:27], v[112:115]
    ds_read_b64_tr_b16 v[16:17], v6 offset:12400
    v_mfma_f32_16x16x32_bf16 v[116:119], v[140:143], v[24:27], v[116:119]
    ds_read_b64_tr_b16 v[18:19], v6 offset:12576
    v_mfma_f32_16x16x32_bf16 v[120:123], v[136:139], v[28:31], v[120:123]
    ds_read_b64_tr_b16 v[20:21], v6 offset:12432
    v_mfma_f32_16x16x32_bf16 v[124:127], v[140:143], v[28:31], v[124:127]
    ds_read_b64_tr_b16 v[22:23], v6 offset:12608
    s_waitcnt lgkmcnt(8)
    v_mfma_f32_16x16x32_bf16 v[80:83], v[32:35], v[144:147], v[80:83]
    ds_read_b64_tr_b16 v[24:25], v6 offset:17920
    v_mfma_f32_16x16x32_bf16 v[88:91], v[32:35], v[148:151], v[88:91]
    ds_read_b64_tr_b16 v[26:27], v6 offset:18096
    v_mfma_f32_16x16x32_bf16 v[84:87], v[36:39], v[144:147], v[84:87]
    ds_read_b64_tr_b16 v[28:29], v6 offset:17952
    v_mfma_f32_16x16x32_bf16 v[92:95], v[36:39], v[148:151], v[92:95]
    ds_read_b64_tr_b16 v[30:31], v6 offset:18128
    s_waitcnt lgkmcnt(8)
    v_mfma_f32_16x16x32_bf16 v[96:99], v[40:43], v[144:147], v[96:99]
    ds_read_b64_tr_b16 v[32:33], v6 offset:17976
    v_mfma_f32_16x16x32_bf16 v[104:107], v[40:43], v[148:151], v[104:107]
    ds_read_b64_tr_b16 v[34:35], v6 offset:18152
    v_mfma_f32_16x16x32_bf16 v[100:103], v[44:47], v[144:147], v[100:103]
    ds_read_b64_tr_b16 v[36:37], v6 offset:18008
    v_mfma_f32_16x16x32_bf16 v[108:111], v[44:47], v[148:151], v[108:111]
    ds_read_b64_tr_b16 v[38:39], v6 offset:18184
    s_waitcnt lgkmcnt(8)
    v_mfma_f32_16x16x32_bf16 v[112:115], v[144:147], v[16:19], v[112:115]
    ds_read_b64_tr_b16 v[40:41], v6 offset:18032
    v_mfma_f32_16x16x32_bf16 v[116:119], v[148:151], v[16:19], v[116:119]
    ds_read_b64_tr_b16 v[42:43], v6 offset:18208
    v_mfma_f32_16x16x32_bf16 v[120:123], v[144:147], v[20:23], v[120:123]
    ds_read_b64_tr_b16 v[44:45], v6 offset:18064
    v_mfma_f32_16x16x32_bf16 v[124:127], v[148:151], v[20:23], v[124:127]
    ds_read_b64_tr_b16 v[46:47], v6 offset:18240
    s_waitcnt vmcnt(0)
    s_mov_b32 s61, 65536
go_a_lp_66:
    v_cmp_eq_u32 vcc, 0, v76
    s_sub_u32 s61, s61, 1
    s_cselect_b64 vcc, 0, vcc
    s_cbranch_vccz go_a_ok_65
    s_sleep 8
    buffer_load_dwordx2 v[76:77], off, s[96:99], 0 sc1
    s_waitcnt vmcnt(0)
    s_branch go_a_lp_66
go_a_ok_65:
    v_readfirstlane_b32 s100, v76
    v_readfirstlane_b32 s101, v77
    s_nop 1
    v_lshlrev_b32 v2, 3, v1
    v_mov_b32 v76, s100
    v_mov_b32 v77, s101
    s_mov_b64 exec, 0xffff
    buffer_store_dwordx2 v[76:77], v2, s[28:31], s52 offen sc1
    s_mov_b64 exec, -1
    s_waitcnt lgkmcnt(8)
    v_mfma_f32_16x16x32_bf16 v[80:83], v[24:27], v[152:155], v[80:83]
    ds_read_b64_tr_b16 v[16:17], v13 offset:24576
    v_mfma_f32_16x16x32_bf16 v[88:91], v[24:27], v[156:159], v[88:91]
    ds_read_b64_tr_b16 v[18:19], v13 offset:24752
    v_mfma_f32_16x16x32_bf16 v[84:87], v[28:31], v[152:155], v[84:87]
    ds_read_b64_tr_b16 v[20:21], v13 offset:24608
    v_mfma_f32_16x16x32_bf16 v[92:95], v[28:31], v[156:159], v[92:95]
    ds_read_b64_tr_b16 v[22:23], v13 offset:24784
    s_waitcnt lgkmcnt(8)
    v_mfma_f32_16x16x32_bf16 v[96:99], v[32:35], v[152:155], v[96:99]
    ds_read_b64_tr_b16 v[24:25], v13 offset:24632
    v_mfma_f32_16x16x32_bf16 v[104:107], v[32:35], v[156:159], v[104:107]
    ds_read_b64_tr_b16 v[26:27], v13 offset:24808
    v_mfma_f32_16x16x32_bf16 v[100:103], v[36:39], v[152:155], v[100:103]
    ds_read_b64_tr_b16 v[28:29], v13 offset:24664
    v_mfma_f32_16x16x32_bf16 v[108:111], v[36:39], v[156:159], v[108:111]
    ds_read_b64_tr_b16 v[30:31], v13 offset:24840
    s_waitcnt lgkmcnt(8)
    v_mfma_f32_16x16x32_bf16 v[112:115], v[152:155], v[40:43], v[112:115]
    ds_read_b64_tr_b16 v[32:33], v13 offset:24688
    v_mfma_f32_16x16x32_bf16 v[116:119], v[156:159], v[40:43], v[116:119]
    ds_read_b64_tr_b16 v[34:35], v13 offset:24864
    v_mfma_f32_16x16x32_bf16 v[120:123], v[152:155], v[44:47], v[120:123]
    ds_read_b64_tr_b16 v[36:37], v13 offset:24720
    v_mfma_f32_16x16x32_bf16 v[124:127], v[156:159], v[44:47], v[124:127]
    ds_read_b64_tr_b16 v[38:39], v13 offset:24896
    s_waitcnt lgkmcnt(8)
    v_mfma_f32_16x16x32_bf16 v[80:83], v[16:19], v[160:163], v[80:83]
    ds_read_b64_tr_b16 v[40:41], v13 offset:30208
    v_mfma_f32_16x16x32_bf16 v[88:91], v[16:19], v[164:167], v[88:91]
    ds_read_b64_tr_b16 v[42:43], v13 offset:30384
    v_mfma_f32_16x16x32_bf16 v[84:87], v[20:23], v[160:163], v[84:87]
    ds_read_b64_tr_b16 v[44:45], v13 offset:30240
    v_mfma_f32_16x16x32_bf16 v[92:95], v[20:23], v[164:167], v[92:95]
    ds_read_b64_tr_b16 v[46:47], v13 offset:30416
    s_waitcnt lgkmcnt(8)
    v_mfma_f32_16x16x32_bf16 v[96:99], v[24:27], v[160:163], v[96:99]
    ds_read_b64_tr_b16 v[16:17], v13 offset:30264
    v_mfma_f32_16x16x32_bf16 v[104:107], v[24:27], v[164:167], v[104:107]
    ds_read_b64_tr_b16 v[18:19], v13 offset:30440
    v_mfma_f32_16x16x32_bf16 v[100:103], v[28:31], v[160:163], v[100:103]
    ds_read_b64_tr_b16 v[20:21], v13 offset:30296
    v_mfma_f32_16x16x32_bf16 v[108:111], v[28:31], v[164:167], v[108:111]
    ds_read_b64_tr_b16 v[22:23], v13 offset:30472
    s_waitcnt lgkmcnt(8)
    v_mfma_f32_16x16x32_bf16 v[112:115], v[160:163], v[32:35], v[112:115]
    ds_read_b64_tr_b16 v[24:25], v13 offset:30320
    v_mfma_f32_16x16x32_bf16 v[116:119], v[164:167], v[32:35], v[116:119]
    ds_read_b64_tr_b16 v[26:27], v13 offset:30496
    v_mfma_f32_16x16x32_bf16 v[120:123], v[160:163], v[36:39], v[120:123]
    ds_read_b64_tr_b16 v[28:29], v13 offset:30352
    v_mfma_f32_16x16x32_bf16 v[124:127], v[164:167], v[36:39], v[124:127]
    ds_read_b64_tr_b16 v[30:31], v13 offset:30528
    s_waitcnt lgkmcnt(8)
    s_barrier
    v_mfma_f32_16x16x32_bf16 v[80:83], v[40:43], v[168:171], v[80:83]
    ds_read_b64_tr_b16 v[32:33], v5 offset:0
    v_mfma_f32_16x16x32_bf16 v[88:91], v[40:43], v[172:175], v[88:91]
    ds_read_b64_tr_b16 v[34:35], v5 offset:176
    v_mfma_f32_16x16x32_bf16 v[84:87], v[44:47], v[168:171], v[84:87]
    ds_read_b64_tr_b16 v[36:37], v5 offset:32
    v_mfma_f32_16x16x32_bf16 v[92:95], v[44:47], v[172:175], v[92:95]
    ds_read_b64_tr_b16 v[38:39], v5 offset:208
    s_waitcnt lgkmcnt(8)
    v_mfma_f32_16x16x32_bf16 v[96:99], v[16:19], v[168:171], v[96:99]
    ds_read_b64_tr_b16 v[40:41], v5 offset:56
    v_mfma_f32_16x16x32_bf16 v[104:107], v[16:19], v[172:175], v[104:107]
    ds_read_b64_tr_b16 v[42:43], v5 offset:232
    v_mfma_f32_16x16x32_bf16 v[100:103], v[20:23], v[168:171], v[100:103]
    ds_read_b64_tr_b16 v[44:45], v5 offset:88
    v_mfma_f32_16x16x32_bf16 v[108:111], v[20:23], v[172:175], v[108:111]
    ds_read_b64_tr_b16 v[46:47], v5 offset:264
    s_waitcnt lgkmcnt(8)
    v_mfma_f32_16x16x32_bf16 v[112:115], v[168:171], v[24:27], v[112:115]
    ds_read_b64_tr_b16 v[16:17], v5 offset:112
    v_mfma_f32_16x16x32_bf16 v[116:119], v[172:175], v[24:27], v[116:119]
    ds_read_b64_tr_b16 v[18:19], v5 offset:288
    v_mfma_f32_16x16x32_bf16 v[120:123], v[168:171], v[28:31], v[120:123]
    ds_read_b64_tr_b16 v[20:21], v5 offset:144
    v_mfma_f32_16x16x32_bf16 v[124:127], v[172:175], v[28:31], v[124:127]
    ds_read_b64_tr_b16 v[22:23], v5 offset:320
    s_waitcnt lgkmcnt(8)
    v_mfma_f32_16x16x32_bf16 v[80:83], v[32:35], v[176:179], v[80:83]
    ds_read_b64_tr_b16 v[24:25], v5 offset:5632
    v_mfma_f32_16x16x32_bf16 v[88:91], v[32:35], v[180:183], v[88:91]
    ds_read_b64_tr_b16 v[26:27], v5 offset:5808
    v_mfma_f32_16x16x32_bf16 v[84:87], v[36:39], v[176:179], v[84:87]
    ds_read_b64_tr_b16 v[28:29], v5 offset:5664
    v_mfma_f32_16x16x32_bf16 v[92:95], v[36:39], v[180:183], v[92:95]
    ds_read_b64_tr_b16 v[30:31], v5 offset:5840
    s_waitcnt lgkmcnt(8)
    v_mfma_f32_16x16x32_bf16 v[96:99], v[40:43], v[176:179], v[96:99]
    ds_read_b64_tr_b16 v[32:33], v5 offset:5688
    v_mfma_f32_16x16x32_bf16 v[104:107], v[40:43], v[180:183], v[104:107]
    ds_read_b64_tr_b16 v[34:35], v5 offset:5864
    v_mfma_f32_16x16x32_bf16 v[100:103], v[44:47], v[176:179], v[100:103]
    ds_read_b64_tr_b16 v[36:37], v5 offset:5720
    v_mfma_f32_16x16x32_bf16 v[108:111], v[44:47], v[180:183], v[108:111]
    ds_read_b64_tr_b16 v[38:39], v5 offset:5896
    s_waitcnt lgkmcnt(8)
    v_mfma_f32_16x16x32_bf16 v[112:115], v[176:179], v[16:19], v[112:115]
    ds_read_b64_tr_b16 v[40:41], v5 offset:5744
    v_mfma_f32_16x16x32_bf16 v[116:119], v[180:183], v[16:19], v[116:119]
    ds_read_b64_tr_b16 v[42:43], v5 offset:5920
    v_mfma_f32_16x16x32_bf16 v[120:123], v[176:179], v[20:23], v[120:123]
    ds_read_b64_tr_b16 v[44:45], v5 offset:5776
    v_mfma_f32_16x16x32_bf16 v[124:127], v[180:183], v[20:23], v[124:127]
    ds_read_b64_tr_b16 v[46:47], v5 offset:5952
    s_waitcnt lgkmcnt(8)
    v_mfma_f32_16x16x32_bf16 v[80:83], v[24:27], v[184:187], v[80:83]
    ds_read_b64_tr_b16 v[16:17], v13 offset:36864
    v_mfma_f32_16x16x32_bf16 v[88:91], v[24:27], v[188:191], v[88:91]
    ds_read_b64_tr_b16 v[18:19], v13 offset:37040
    v_mfma_f32_16x16x32_bf16 v[84:87], v[28:31], v[184:187], v[84:87]
    ds_read_b64_tr_b16 v[20:21], v13 offset:36896
    v_mfma_f32_16x16x32_bf16 v[92:95], v[28:31], v[188:191], v[92:95]
    ds_read_b64_tr_b16 v[22:23], v13 offset:37072
    s_waitcnt lgkmcnt(8)
    v_mfma_f32_16x16x32_bf16 v[96:99], v[32:35], v[184:187], v[96:99]
    ds_read_b64_tr_b16 v[24:25], v13 offset:36920
    v_mfma_f32_16x16x32_bf16 v[104:107], v[32:35], v[188:191], v[104:107]
    ds_read_b64_tr_b16 v[26:27], v13 offset:37096
    v_mfma_f32_16x16x32_bf16 v[100:103], v[36:39], v[184:187], v[100:103]
    ds_read_b64_tr_b16 v[28:29], v13 offset:36952
    v_mfma_f32_16x16x32_bf16 v[108:111], v[36:39], v[188:191], v[108:111]
    ds_read_b64_tr_b16 v[30:31], v13 offset:37128
    s_waitcnt lgkmcnt(8)
    v_mfma_f32_16x16x32_bf16 v[112:115], v[184:187], v[40:43], v[112:115]
    ds_read_b64_tr_b16 v[32:33], v13 offset:36976
    v_mfma_f32_16x16x32_bf16 v[116:119], v[188:191], v[40:43], v[116:119]
    ds_read_b64_tr_b16 v[34:35], v13 offset:37152
    v_mfma_f32_16x16x32_bf16 v[120:123], v[184:187], v[44:47], v[120:123]
    ds_read_b64_tr_b16 v[36:37], v13 offset:37008
    v_mfma_f32_16x16x32_bf16 v[124:127], v[188:191], v[44:47], v[124:127]
    ds_read_b64_tr_b16 v[38:39], v13 offset:37184
    s_waitcnt lgkmcnt(8)
    v_mfma_f32_16x16x32_bf16 v[80:83], v[16:19], v[192:195], v[80:83]
    ds_read_b64_tr_b16 v[40:41], v13 offset:42496
    v_mfma_f32_16x16x32_bf16 v[88:91], v[16:19], v[196:199], v[88:91]
    ds_read_b64_tr_b16 v[42:43], v13 offset:42672
    v_mfma_f32_16x16x32_bf16 v[84:87], v[20:23], v[192:195], v[84:87]
    ds_read_b64_tr_b16 v[44:45], v13 offset:42528
    v_mfma_f32_16x16x32_bf16 v[92:95], v[20:23], v[196:199], v[92:95]
    ds_read_b64_tr_b16 v[46:47], v13 offset:42704
    s_waitcnt lgkmcnt(8)
    v_mfma_f32_16x16x32_bf16 v[96:99], v[24:27], v[192:195], v[96:99]
    ds_read_b64_tr_b16 v[16:17], v13 offset:42552
    v_mfma_f32_16x16x32_bf16 v[104:107], v[24:27], v[196:199], v[104:107]
    ds_read_b64_tr_b16 v[18:19], v13 offset:42728
    v_mfma_f32_16x16x32_bf16 v[100:103], v[28:31], v[192:195], v[100:103]
    ds_read_b64_tr_b16 v[20:21], v13 offset:42584
    v_mfma_f32_16x16x32_bf16 v[108:111], v[28:31], v[196:199], v[108:111]
    ds_read_b64_tr_b16 v[22:23], v13 offset:42760
    s_waitcnt lgkmcnt(8)
    v_mfma_f32_16x16x32_bf16 v[112:115], v[192:195], v[32:35], v[112:115]
    ds_read_b64_tr_b16 v[24:25], v13 offset:42608
    v_mfma_f32_16x16x32_bf16 v[116:119], v[196:199], v[32:35], v[116:119]
    ds_read_b64_tr_b16 v[26:27], v13 offset:42784
    v_mfma_f32_16x16x32_bf16 v[120:123], v[192:195], v[36:39], v[120:123]
    ds_read_b64_tr_b16 v[28:29], v13 offset:42640
    v_mfma_f32_16x16x32_bf16 v[124:127], v[196:199], v[36:39], v[124:127]
    ds_read_b64_tr_b16 v[30:31], v13 offset:42816
    s_waitcnt lgkmcnt(8)
    s_barrier
    v_mfma_f32_16x16x32_bf16 v[80:83], v[40:43], v[200:203], v[80:83]
    ds_read_b64_tr_b16 v[32:33], v5 offset:32768
    v_mfma_f32_16x16x32_bf16 v[88:91], v[40:43], v[204:207], v[88:91]
    ds_read_b64_tr_b16 v[34:35], v5 offset:32944
    v_mfma_f32_16x16x32_bf16 v[84:87], v[44:47], v[200:203], v[84:87]
    ds_read_b64_tr_b16 v[36:37], v5 offset:32800
    v_mfma_f32_16x16x32_bf16 v[92:95], v[44:47], v[204:207], v[92:95]
    ds_read_b64_tr_b16 v[38:39], v5 offset:32976
    s_waitcnt lgkmcnt(8)
    v_mfma_f32_16x16x32_bf16 v[96:99], v[16:19], v[200:203], v[96:99]
    ds_read_b64_tr_b16 v[40:41], v5 offset:32824
    v_mfma_f32_16x16x32_bf16 v[104:107], v[16:19], v[204:207], v[104:107]
    ds_read_b64_tr_b16 v[42:43], v5 offset:33000
    v_mfma_f32_16x16x32_bf16 v[100:103], v[20:23], v[200:203], v[100:103]
    ds_read_b64_tr_b16 v[44:45], v5 offset:32856
    v_mfma_f32_16x16x32_bf16 v[108:111], v[20:23], v[204:207], v[108:111]
    ds_read_b64_tr_b16 v[46:47], v5 offset:33032
    s_waitcnt lgkmcnt(8)
    v_mfma_f32_16x16x32_bf16 v[112:115], v[200:203], v[24:27], v[112:115]
    ds_read_b64_tr_b16 v[16:17], v5 offset:32880
    v_mfma_f32_16x16x32_bf16 v[116:119], v[204:207], v[24:27], v[116:119]
    ds_read_b64_tr_b16 v[18:19], v5 offset:33056
    v_mfma_f32_16x16x32_bf16 v[120:123], v[200:203], v[28:31], v[120:123]
    ds_read_b64_tr_b16 v[20:21], v5 offset:32912
    v_mfma_f32_16x16x32_bf16 v[124:127], v[204:207], v[28:31], v[124:127]
    ds_read_b64_tr_b16 v[22:23], v5 offset:33088
    s_waitcnt lgkmcnt(8)
    v_mfma_f32_16x16x32_bf16 v[80:83], v[32:35], v[208:211], v[80:83]
    ds_read_b64_tr_b16 v[24:25], v5 offset:38400
    v_mfma_f32_16x16x32_bf16 v[88:91], v[32:35], v[212:215], v[88:91]
    ds_read_b64_tr_b16 v[26:27], v5 offset:38576
    v_mfma_f32_16x16x32_bf16 v[84:87], v[36:39], v[208:211], v[84:87]
    ds_read_b64_tr_b16 v[28:29], v5 offset:38432
    v_mfma_f32_16x16x32_bf16 v[92:95], v[36:39], v[212:215], v[92:95]
    ds_read_b64_tr_b16 v[30:31], v5 offset:38608
    s_waitcnt lgkmcnt(8)
    v_mfma_f32_16x16x32_bf16 v[96:99], v[40:43], v[208:211], v[96:99]
    ds_read_b64_tr_b16 v[32:33], v5 offset:38456
    v_mfma_f32_16x16x32_bf16 v[104:107], v[40:43], v[212:215], v[104:107]
    ds_read_b64_tr_b16 v[34:35], v5 offset:38632
    v_mfma_f32_16x16x32_bf16 v[100:103], v[44:47], v[208:211], v[100:103]
    ds_read_b64_tr_b16 v[36:37], v5 offset:38488
    v_mfma_f32_16x16x32_bf16 v[108:111], v[44:47], v[212:215], v[108:111]
    ds_read_b64_tr_b16 v[38:39], v5 offset:38664
    s_waitcnt lgkmcnt(8)
    v_mfma_f32_16x16x32_bf16 v[112:115], v[208:211], v[16:19], v[112:115]
    ds_read_b64_tr_b16 v[40:41], v5 offset:38512
    v_mfma_f32_16x16x32_bf16 v[116:119], v[212:215], v[16:19], v[116:119]
    ds_read_b64_tr_b16 v[42:43], v5 offset:38688
    v_mfma_f32_16x16x32_bf16 v[120:123], v[208:211], v[20:23], v[120:123]
    ds_read_b64_tr_b16 v[44:45], v5 offset:38544
    v_mfma_f32_16x16x32_bf16 v[124:127], v[212:215], v[20:23], v[124:127]
    ds_read_b64_tr_b16 v[46:47], v5 offset:38720
    s_waitcnt lgkmcnt(8)
    v_mfma_f32_16x16x32_bf16 v[80:83], v[24:27], v[216:219], v[80:83]
    ds_read_b64_tr_b16 v[16:17], v13 offset:49152
    v_mfma_f32_16x16x32_bf16 v[88:91], v[24:27], v[220:223], v[88:91]
    ds_read_b64_tr_b16 v[18:19], v13 offset:49328
    v_mfma_f32_16x16x32_bf16 v[84:87], v[28:31], v[216:219], v[84:87]
    ds_read_b64_tr_b16 v[20:21], v13 offset:49184
    v_mfma_f32_16x16x32_bf16 v[92:95], v[28:31], v[220:223], v[92:95]
    ds_read_b64_tr_b16 v[22:23], v13 offset:49360
    s_waitcnt lgkmcnt(8)
    v_mfma_f32_16x16x32_bf16 v[96:99], v[32:35], v[216:219], v[96:99]
    ds_read_b64_tr_b16 v[24:25], v13 offset:49208
    v_mfma_f32_16x16x32_bf16 v[104:107], v[32:35], v[220:223], v[104:107]
    ds_read_b64_tr_b16 v[26:27], v13 offset:49384
    v_mfma_f32_16x16x32_bf16 v[100:103], v[36:39], v[216:219], v[100:103]
    ds_read_b64_tr_b16 v[28:29], v13 offset:49240
    v_mfma_f32_16x16x32_bf16 v[108:111], v[36:39], v[220:223], v[108:111]
    ds_read_b64_tr_b16 v[30:31], v13 offset:49416
    s_waitcnt lgkmcnt(8)
    v_mfma_f32_16x16x32_bf16 v[112:115], v[216:219], v[40:43], v[112:115]
    ds_read_b64_tr_b16 v[32:33], v13 offset:49264
    v_mfma_f32_16x16x32_bf16 v[116:119], v[220:223], v[40:43], v[116:119]
    ds_read_b64_tr_b16 v[34:35], v13 offset:49440
    v_mfma_f32_16x16x32_bf16 v[120:123], v[216:219], v[44:47], v[120:123]
    ds_read_b64_tr_b16 v[36:37], v13 offset:49296
    v_mfma_f32_16x16x32_bf16 v[124:127], v[220:223], v[44:47], v[124:127]
    ds_read_b64_tr_b16 v[38:39], v13 offset:49472
    s_waitcnt lgkmcnt(8)
    v_mfma_f32_16x16x32_bf16 v[80:83], v[16:19], v[224:227], v[80:83]
    ds_read_b64_tr_b16 v[40:41], v13 offset:54784
    v_mfma_f32_16x16x32_bf16 v[88:91], v[16:19], v[228:231], v[88:91]
    ds_read_b64_tr_b16 v[42:43], v13 offset:54960
    v_mfma_f32_16x16x32_bf16 v[84:87], v[20:23], v[224:227], v[84:87]
    ds_read_b64_tr_b16 v[44:45], v13 offset:54816
    v_mfma_f32_16x16x32_bf16 v[92:95], v[20:23], v[228:231], v[92:95]
    ds_read_b64_tr_b16 v[46:47], v13 offset:54992
    s_waitcnt lgkmcnt(8)
    v_mfma_f32_16x16x32_bf16 v[96:99], v[24:27], v[224:227], v[96:99]
    ds_read_b64_tr_b16 v[16:17], v13 offset:54840
    v_mfma_f32_16x16x32_bf16 v[104:107], v[24:27], v[228:231], v[104:107]
    ds_read_b64_tr_b16 v[18:19], v13 offset:55016
    v_mfma_f32_16x16x32_bf16 v[100:103], v[28:31], v[224:227], v[100:103]
    ds_read_b64_tr_b16 v[20:21], v13 offset:54872
    v_mfma_f32_16x16x32_bf16 v[108:111], v[28:31], v[228:231], v[108:111]
    ds_read_b64_tr_b16 v[22:23], v13 offset:55048
    v_mov_b32 v194, 0x3f803f80
    v_mov_b32 v195, 0x3f80
    v_mov_b32 v198, 0x3f803f80
    v_mov_b32 v199, 0x3f80
    v_mov_b32 v202, 0x3f803f80
    v_mov_b32 v203, 0x3f80
    v_mov_b32 v206, 0x3f803f80
    v_mov_b32 v207, 0x3f80
    v_mov_b32 v212, v7
    v_mov_b32 v213, v7
    v_mov_b32 v214, v7
    v_mov_b32 v215, v7
    s_waitcnt lgkmcnt(8)
    v_mfma_f32_16x16x32_bf16 v[112:115], v[224:227], v[32:35], v[112:115]
    ds_read_b64_tr_b16 v[24:25], v13 offset:54896
    v_mfma_f32_16x16x32_bf16 v[116:119], v[228:231], v[32:35], v[116:119]
    ds_read_b64_tr_b16 v[26:27], v13 offset:55072
    v_mfma_f32_16x16x32_bf16 v[120:123], v[224:227], v[36:39], v[120:123]
    ds_read_b64_tr_b16 v[28:29], v13 offset:54928
    v_mfma_f32_16x16x32_bf16 v[124:127], v[228:231], v[36:39], v[124:127]
    ds_read_b64_tr_b16 v[30:31], v13 offset:55104
    s_waitcnt lgkmcnt(8)
    v_mfma_f32_16x16x32_bf16 v[80:83], v[40:43], v[232:235], v[80:83]
    v_mfma_f32_16x16x32_bf16 v[88:91], v[40:43], v[236:239], v[88:91]
    v_mfma_f32_16x16x32_bf16 v[84:87], v[44:47], v[232:235], v[84:87]
    v_mfma_f32_16x16x32_bf16 v[92:95], v[44:47], v[236:239], v[92:95]
    s_waitcnt lgkmcnt(4)
    v_mfma_f32_16x16x32_bf16 v[96:99], v[16:19], v[232:235], v[96:99]
    v_mfma_f32_16x16x32_bf16 v[104:107], v[16:19], v[236:239], v[104:107]
    v_mfma_f32_16x16x32_bf16 v[100:103], v[20:23], v[232:235], v[100:103]
    v_mfma_f32_16x16x32_bf16 v[108:111], v[20:23], v[236:239], v[108:111]
    s_nop 1
    s_waitcnt lgkmcnt(0)
    v_mfma_f32_16x16x32_bf16 v[112:115], v[232:235], v[24:27], v[112:115]
    v_mfma_f32_16x16x32_bf16 v[116:119], v[236:239], v[24:27], v[116:119]
    v_mfma_f32_16x16x32_bf16 v[120:123], v[232:235], v[28:31], v[120:123]
    v_mfma_f32_16x16x32_bf16 v[124:127], v[236:239], v[28:31], v[124:127]
    v_cvt_pk_bf16_f32 v192, v80, v81
    v_cvt_pk_bf16_f32 v193, v82, v83
    v_cvt_pk_bf16_f32 v196, v88, v89
    v_cvt_pk_bf16_f32 v197, v90, v91
    s_mov_b32 exec_hi, 0xffff
    v_cvt_pk_bf16_f32 v194, v84, v85
    v_cvt_pk_bf16_f32 v195, v86, v87
    v_cvt_pk_bf16_f32 v198, v92, v93
    v_cvt_pk_bf16_f32 v199, v94, v95
    s_mov_b32 exec_hi, -1
    v_cvt_pk_bf16_f32 v200, v96, v97
    v_cvt_pk_bf16_f32 v201, v98, v99
    v_cvt_pk_bf16_f32 v204, v104, v105
    v_cvt_pk_bf16_f32 v205, v106, v107
    s_mov_b32 exec_hi, 0xffff
    v_cvt_pk_bf16_f32 v202, v100, v101
    v_cvt_pk_bf16_f32 v203, v102, v103
    v_cvt_pk_bf16_f32 v206, v108, v109
    v_cvt_pk_bf16_f32 v207, v110, v111
    s_mov_b32 exec_hi, -1
    v_cvt_pk_bf16_f32 v208, v112, v113
    v_cvt_pk_bf16_f32 v209, v114, v115
    v_cvt_pk_bf16_f32 v210, v116, v117
    v_cvt_pk_bf16_f32 v211, v118, v119
    s_mov_b32 exec_lo, 0x0fff0fff
    s_mov_b32 exec_hi, 0x0fff0fff
    v_cvt_pk_bf16_f32 v212, v120, v121
    v_cvt_pk_bf16_f32 v213, v122, v123
    v_cvt_pk_bf16_f32 v214, v124, v125
    v_cvt_pk_bf16_f32 v215, v126, v127
    s_mov_b64 exec, -1
    v_mov_b32 v216, v14
    s_branch L_a_attn
P1B_VVV:
    s_mul_i32 s36, s33, 168
    s_and_b32 s37, s36, 15
    s_sub_u32 s36, s36, s37
    v_and_b32 v3, 15, v1
    v_lshrrev_b32 v4, 4, v1
    v_lshrrev_b32 v5, 1, v3
    v_xor_b32 v5, v5, v4
    s_lshl_b32 s40, s34, 12
    v_lshl_add_u32 v6, v3, 7, s40
    v_lshl_add_u32 v8, v5, 4, v6
    v_xor_b32 v9, 64, v8
    v_bfe_u32 v5, v1, 2, 2
    v_lshl_add_u32 v5, v4, 2, v5
    v_mul_u32_u24 v5, 352, v5
    v_and_b32 v6, 3, v1
    v_lshl_add_u32 v5, v6, 3, v5
    s_add_u32 s40, s37, 98304
    v_add_u32 v12, s40, v5
    v_lshlrev_b32 v79, 4, v4
    v_add_u32 v79, 159744, v79
    v_mov_b32 v2, 163840
    s_mov_b32 vcc_lo, 0x00010001
    s_mov_b32 vcc_hi, 0x00010001
    v_cndmask_b32 v79, v2, v79, vcc
    s_waitcnt lgkmcnt(0)
    s_mov_b32 s96, s20
    s_and_b32 s97, s21, 0xffff
    s_mov_b32 s98, 256
    s_mov_b32 s99, 0x20000
    s_or_b32 s53, s2, s34
    s_cbranch_scc1 notag_67
    s_memrealtime s[100:101]
    s_waitcnt lgkmcnt(0)
    s_lshl_b64 s[100:101], s[100:101], 1
    s_or_b32 s100, s100, 1
    v_mov_b32 v76, s100
    v_mov_b32 v77, s101
    s_mov_b64 exec, 1
    buffer_store_dwordx2 v[76:77], off, s[96:99], 0 sc1
    s_mov_b64 exec, -1
notag_67:
    s_xor_b32 s62, s33, 1
    s_lshr_b32 s40, s33, 1
    s_cmp_eq_u32 s40, 2
    s_cselect_b32 s62, s33, s62
    s_cmp_eq_u32 s40, 5
    s_cselect_b32 s62, s33, s62
    s_mul_i32 s38, s62, 168
    s_and_b32 s39, s38, 15
    s_sub_u32 s38, s38, s39
    v_add_u32 v5, s39, v5
    v_add_u32 v13, 98304, v5
    v_add_u32 v6, 65536, v5
    v_lshlrev_b32 v2, 4, v3
    v_lshl_add_u32 v14, v4, 9, v2
    v_cmp_eq_u32 vcc, 12, v3
    v_mov_b32 v2, 0x3f803f80
    s_mov_b32 s50, 1049335798
    s_mov_b32 s51, 1049335798
    v_cndmask_b32 v7, 0, v2, vcc
    s_lshl_b32 s39, s35, 12
    s_lshl_b32 s40, s32, 2
    s_add_u32 s40, s40, s35
    s_mov_b32 s60, 0
    s_lshl_b32 s41, s33, 6
    s_add_u32 s41, s41, s40
    s_lshl_b32 s41, s41, 11
    s_add_u32 s41, s41, 8388608
    s_add_u32 s42, s41, 2097152
    s_lshl_b32 s45, s40, 5
    s_add_u32 s45, s45, s33
    s_lshl_b32 s43, s45, 11
    s_add_u32 s43, s43, 12582912
    s_add_u32 s44, s43, 32768
    s_lshl_b32 s45, s45, 7
    s_add_u32 s45, s45, 21233664
    s_mov_b32 s56, 1400897536
    s_mov_b32 s57, 729808896
    s_lshr_b32 s38, s2, 3
    s_mul_i32 s36, s38, 37
    s_lshr_b32 s36, s36, 8
    s_mul_i32 s37, s36, 7
    s_sub_u32 s37, s38, s37
    s_and_b32 s46, s2, 1
    s_lshl_b32 s46, s46, 4
    s_add_u32 s36, s36, s46
    s_and_b32 s46, s2, 6
    s_lshl_b32 s46, s46, 1
    s_add_u32 s36, s36, s46
    s_cmp_eq_u32 s35, 3
    s_cselect_b32 s49, 4294952960, 0
    s_lshl_b32 s46, s62, 6
    s_add_u32 s46, s46, s40
    s_lshl_b32 s46, s46, 7
    s_add_u32 s3, s46, 20971520
    s_lshl_b32 s46, s33, 6
    s_add_u32 s46, s46, s40
    s_lshl_b32 s46, s46, 7
    s_add_u32 s52, s46, 21102592
    s_mov_b32 s28, s22
    s_and_b32 s29, s23, 0xffff
    s_mov_b32 s30, 22020096
    s_mov_b32 s31, 0x20000
    s_lshl_b32 s46, s33, 18
    s_add_u32 s10, s22, s46
    s_addc_u32 s11, s23, 0
    s_mov_b32 s64, s10
    s_and_b32 s65, s11, 0xffff
    s_mov_b32 s66, 262144
    s_mov_b32 s67, 0x20000
    s_add_u32 s10, s10, 4194304
    s_addc_u32 s11, s11, 0
    s_mov_b32 s68, s10
    s_and_b32 s69, s11, 0xffff
    s_mov_b32 s70, 262144
    s_mov_b32 s71, 0x20000
    s_mov_b32 s24, s14
    s_and_b32 s25, s15, 0xffff
    s_mov_b32 s26, 401408
    s_mov_b32 s27, 0x20000
    s_and_b32 s4, s34, 1
    s_lshr_b32 s5, s34, 1
    s_lshl_b32 s46, s36, 1
    s_add_u32 s46, s46, s4
    s_lshl_b32 s47, s46, 5
    s_xor_b32 s48, s5, 2
    s_lshl_b32 s48, s48, 3
    s_add_u32 s47, s47, s48
    s_lshl_b32 s6, s47, 11
    s_add_u32 s6, s6, 12582912
    s_lshl_b32 s7, s47, 7
    s_add_u32 s7, s7, 21233664
    s_mul_i32 s58, s33, 3
    s_add_u32 s61, s58, 0
    s_and_b32 s61, s61, 15
    s_lshl_b32 s61, s61, 6
    s_add_u32 s61, s61, s40
    s_lshl_b32 s61, s61, 12
    s_add_u32 s54, s61, 4196352
    s_add_u32 s61, s58, 1
    s_and_b32 s61, s61, 15
    s_lshl_b32 s61, s61, 6
    s_add_u32 s61, s61, s40
    s_lshl_b32 s61, s61, 12
    s_add_u32 s55, s61, 4196352
    s_add_u32 s61, s58, 2
    s_and_b32 s61, s61, 15
    s_lshl_b32 s61, s61, 6
    s_add_u32 s61, s61, s40
    s_lshl_b32 s61, s61, 12
    s_add_u32 s17, s61, 4196352
    s_mul_i32 s58, s62, 3
    s_add_u32 s61, s58, 0
    s_and_b32 s61, s61, 15
    s_lshl_b32 s61, s61, 6
    s_add_u32 s61, s61, s40
    s_lshl_b32 s61, s61, 12
    s_add_u32 s47, s61, 2048
    s_add_u32 s61, s58, 1
    s_and_b32 s61, s61, 15
    s_lshl_b32 s61, s61, 6
    s_add_u32 s61, s61, s40
    s_lshl_b32 s61, s61, 12
    s_add_u32 s59, s61, 2048
    s_add_u32 s61, s58, 2
    s_and_b32 s61, s61, 15
    s_lshl_b32 s61, s61, 6
    s_add_u32 s61, s61, s40
    s_lshl_b32 s61, s61, 12
    s_add_u32 s16, s61, 2048
    v_mov_b32 v56, v7
    v_mov_b32 v57, v7
    v_mov_b32 v58, v7
    v_mov_b32 v59, v7
    v_mov_b32 v64, v7
    v_mov_b32 v65, v7
    v_mov_b32 v66, v7
    v_mov_b32 v67, v7
    v_mov_b32 v72, v7
    v_mov_b32 v73, v7
    v_mov_b32 v74, v7
    v_mov_b32 v75, v7
    s_barrier
    ds_read_b128 v[128:131], v8 offset:0
    ds_read_b128 v[132:135], v8 offset:2048
    ds_read_b64_tr_b16 v[16:17], v12 offset:0
    ds_read_b64_tr_b16 v[18:19], v12 offset:176
    ds_read_b64_tr_b16 v[20:21], v12 offset:32
    ds_read_b64_tr_b16 v[22:23], v12 offset:208
    ds_read_b64_tr_b16 v[24:25], v12 offset:56
    ds_read_b64_tr_b16 v[26:27], v12 offset:232
    ds_read_b64_tr_b16 v[28:29], v12 offset:88
    ds_read_b64_tr_b16 v[30:31], v12 offset:264
    ds_read_b64_tr_b16 v[32:33], v12 offset:112
    ds_read_b64_tr_b16 v[34:35], v12 offset:288
    ds_read_b64_tr_b16 v[36:37], v12 offset:144
    ds_read_b64_tr_b16 v[38:39], v12 offset:320
    ds_read_b128 v[160:163], v79 offset:0
    s_waitcnt lgkmcnt(9)
    v_mfma_f32_16x16x32_bf16 v[80:83], v[128:131], v[16:19], 0
    ds_read_b128 v[136:139], v9 offset:0
    ds_read_b128 v[140:143], v9 offset:2048
    v_mfma_f32_16x16x32_bf16 v[84:87], v[132:135], v[16:19], 0
    ds_read_b64_tr_b16 v[40:41], v12 offset:5632
    ds_read_b64_tr_b16 v[42:43], v12 offset:5808
    v_mfma_f32_16x16x32_bf16 v[88:91], v[128:131], v[20:23], 0
    ds_read_b64_tr_b16 v[44:45], v12 offset:5664
    v_mfma_f32_16x16x32_bf16 v[92:95], v[132:135], v[20:23], 0
    ds_read_b64_tr_b16 v[46:47], v12 offset:5840
    s_waitcnt lgkmcnt(11)
    v_mfma_f32_16x16x32_bf16 v[96:99], v[128:131], v[24:27], 0
    ds_read_b64_tr_b16 v[16:17], v12 offset:5688
    v_mfma_f32_16x16x32_bf16 v[100:103], v[132:135], v[24:27], 0
    ds_read_b64_tr_b16 v[18:19], v12 offset:5864
    v_mfma_f32_16x16x32_bf16 v[104:107], v[128:131], v[28:31], 0
    ds_read_b64_tr_b16 v[20:21], v12 offset:5720
    v_mfma_f32_16x16x32_bf16 v[108:111], v[132:135], v[28:31], 0
    ds_read_b64_tr_b16 v[22:23], v12 offset:5896
    s_waitcnt lgkmcnt(10)
    v_mfma_f32_16x16x32_bf16 v[112:115], v[128:131], v[32:35], 0
    ds_read_b64_tr_b16 v[24:25], v12 offset:5744
    ds_read_b64_tr_b16 v[26:27], v12 offset:5920
    v_mfma_f32_16x16x32_bf16 v[116:119], v[132:135], v[32:35], 0
    ds_read_b64_tr_b16 v[28:29], v12 offset:5776
    v_mfma_f32_16x16x32_bf16 v[120:123], v[128:131], v[36:39], 0
    ds_read_b64_tr_b16 v[30:31], v12 offset:5952
    v_mfma_f32_16x16x32_bf16 v[124:127], v[132:135], v[36:39], 0
    ds_read_b128 v[168:171], v79 offset:64
    v_mfma_f32_16x16x32_bf16 v[240:243], v[160:163], v[128:131], 0
    v_mfma_f32_16x16x32_bf16 v[244:247], v[160:163], v[132:135], 0
    s_waitcnt lgkmcnt(9)
    s_barrier
    v_mfma_f32_16x16x32_bf16 v[80:83], v[136:139], v[40:43], v[80:83]
    ds_read_b128 v[144:147], v8 offset:16384
    ds_read_b128 v[148:151], v8 offset:18432
    v_mfma_f32_16x16x32_bf16 v[84:87], v[140:143], v[40:43], v[84:87]
    ds_read_b64_tr_b16 v[32:33], v12 offset:12288
    ds_read_b64_tr_b16 v[34:35], v12 offset:12464
    v_mfma_f32_16x16x32_bf16 v[88:91], v[136:139], v[44:47], v[88:91]
    ds_read_b64_tr_b16 v[36:37], v12 offset:12320
    v_mfma_f32_16x16x32_bf16 v[92:95], v[140:143], v[44:47], v[92:95]
    ds_read_b64_tr_b16 v[38:39], v12 offset:12496
    s_waitcnt lgkmcnt(11)
    v_mfma_f32_16x16x32_bf16 v[96:99], v[136:139], v[16:19], v[96:99]
    ds_read_b64_tr_b16 v[40:41], v12 offset:12344
    v_mfma_f32_16x16x32_bf16 v[100:103], v[140:143], v[16:19], v[100:103]
    ds_read_b64_tr_b16 v[42:43], v12 offset:12520
    v_mfma_f32_16x16x32_bf16 v[104:107], v[136:139], v[20:23], v[104:107]
    ds_read_b64_tr_b16 v[44:45], v12 offset:12376
    v_mfma_f32_16x16x32_bf16 v[108:111], v[140:143], v[20:23], v[108:111]
    ds_read_b64_tr_b16 v[46:47], v12 offset:12552
    s_waitcnt lgkmcnt(10)
    v_mfma_f32_16x16x32_bf16 v[112:115], v[136:139], v[24:27], v[112:115]
    ds_read_b64_tr_b16 v[16:17], v12 offset:12400
    ds_read_b64_tr_b16 v[18:19], v12 offset:12576
    v_mfma_f32_16x16x32_bf16 v[116:119], v[140:143], v[24:27], v[116:119]
    ds_read_b64_tr_b16 v[20:21], v12 offset:12432
    v_mfma_f32_16x16x32_bf16 v[120:123], v[136:139], v[28:31], v[120:123]
    ds_read_b64_tr_b16 v[22:23], v12 offset:12608
    v_mfma_f32_16x16x32_bf16 v[124:127], v[140:143], v[28:31], v[124:127]
    ds_read_b128 v[176:179], v79 offset:128
    v_mfma_f32_16x16x32_bf16 v[240:243], v[168:171], v[136:139], v[240:243]
    v_mfma_f32_16x16x32_bf16 v[244:247], v[168:171], v[140:143], v[244:247]
    s_waitcnt lgkmcnt(9)
    v_mfma_f32_16x16x32_bf16 v[80:83], v[144:147], v[32:35], v[80:83]
    ds_read_b128 v[152:155], v9 offset:16384
    ds_read_b128 v[156:159], v9 offset:18432
    v_mfma_f32_16x16x32_bf16 v[84:87], v[148:151], v[32:35], v[84:87]
    ds_read_b64_tr_b16 v[24:25], v12 offset:17920
    ds_read_b64_tr_b16 v[26:27], v12 offset:18096
    v_mfma_f32_16x16x32_bf16 v[88:91], v[144:147], v[36:39], v[88:91]
    ds_read_b64_tr_b16 v[28:29], v12 offset:17952
    v_mfma_f32_16x16x32_bf16 v[92:95], v[148:151], v[36:39], v[92:95]
    ds_read_b64_tr_b16 v[30:31], v12 offset:18128
    s_waitcnt lgkmcnt(11)
    v_mfma_f32_16x16x32_bf16 v[96:99], v[144:147], v[40:43], v[96:99]
    ds_read_b64_tr_b16 v[32:33], v12 offset:17976
    v_mfma_f32_16x16x32_bf16 v[100:103], v[148:151], v[40:43], v[100:103]
    ds_read_b64_tr_b16 v[34:35], v12 offset:18152
    v_mfma_f32_16x16x32_bf16 v[104:107], v[144:147], v[44:47], v[104:107]
    ds_read_b64_tr_b16 v[36:37], v12 offset:18008
    v_mfma_f32_16x16x32_bf16 v[108:111], v[148:151], v[44:47], v[108:111]
    ds_read_b64_tr_b16 v[38:39], v12 offset:18184
    s_waitcnt lgkmcnt(10)
    v_mfma_f32_16x16x32_bf16 v[112:115], v[144:147], v[16:19], v[112:115]
    ds_read_b64_tr_b16 v[40:41], v12 offset:18032
    ds_read_b64_tr_b16 v[42:43], v12 offset:18208
    v_mfma_f32_16x16x32_bf16 v[116:119], v[148:151], v[16:19], v[116:119]
    ds_read_b64_tr_b16 v[44:45], v12 offset:18064
    v_mfma_f32_16x16x32_bf16 v[120:123], v[144:147], v[20:23], v[120:123]
    ds_read_b64_tr_b16 v[46:47], v12 offset:18240
    v_mfma_f32_16x16x32_bf16 v[124:127], v[148:151], v[20:23], v[124:127]
    ds_read_b128 v[184:187], v79 offset:192
    v_mfma_f32_16x16x32_bf16 v[240:243], v[176:179], v[144:147], v[240:243]
    v_mfma_f32_16x16x32_bf16 v[244:247], v[176:179], v[148:151], v[244:247]
    s_waitcnt lgkmcnt(9)
    s_barrier
    v_mfma_f32_16x16x32_bf16 v[80:83], v[152:155], v[24:27], v[80:83]
    ds_read_b128 v[160:163], v8 offset:32768
    ds_read_b128 v[164:167], v8 offset:34816
    v_mfma_f32_16x16x32_bf16 v[84:87], v[156:159], v[24:27], v[84:87]
    ds_read_b64_tr_b16 v[16:17], v12 offset:24576
    ds_read_b64_tr_b16 v[18:19], v12 offset:24752
    v_mfma_f32_16x16x32_bf16 v[88:91], v[152:155], v[28:31], v[88:91]
    ds_read_b64_tr_b16 v[20:21], v12 offset:24608
    v_mfma_f32_16x16x32_bf16 v[92:95], v[156:159], v[28:31], v[92:95]
    ds_read_b64_tr_b16 v[22:23], v12 offset:24784
    s_waitcnt lgkmcnt(11)
    v_mfma_f32_16x16x32_bf16 v[96:99], v[152:155], v[32:35], v[96:99]
    ds_read_b64_tr_b16 v[24:25], v12 offset:24632
    v_mfma_f32_16x16x32_bf16 v[100:103], v[156:159], v[32:35], v[100:103]
    ds_read_b64_tr_b16 v[26:27], v12 offset:24808
    v_mfma_f32_16x16x32_bf16 v[104:107], v[152:155], v[36:39], v[104:107]
    ds_read_b64_tr_b16 v[28:29], v12 offset:24664
    v_mfma_f32_16x16x32_bf16 v[108:111], v[156:159], v[36:39], v[108:111]
    ds_read_b64_tr_b16 v[30:31], v12 offset:24840
    s_waitcnt lgkmcnt(10)
    v_mfma_f32_16x16x32_bf16 v[112:115], v[152:155], v[40:43], v[112:115]
    ds_read_b64_tr_b16 v[32:33], v12 offset:24688
    ds_read_b64_tr_b16 v[34:35], v12 offset:24864
    v_mfma_f32_16x16x32_bf16 v[116:119], v[156:159], v[40:43], v[116:119]
    ds_read_b64_tr_b16 v[36:37], v12 offset:24720
    v_mfma_f32_16x16x32_bf16 v[120:123], v[152:155], v[44:47], v[120:123]
    ds_read_b64_tr_b16 v[38:39], v12 offset:24896
    v_mfma_f32_16x16x32_bf16 v[124:127], v[156:159], v[44:47], v[124:127]
    ds_read_b128 v[192:195], v79 offset:256
    v_mfma_f32_16x16x32_bf16 v[240:243], v[184:187], v[152:155], v[240:243]
    v_mfma_f32_16x16x32_bf16 v[244:247], v[184:187], v[156:159], v[244:247]
    s_waitcnt lgkmcnt(9)
    v_mfma_f32_16x16x32_bf16 v[80:83], v[160:163], v[16:19], v[80:83]
    ds_read_b128 v[168:171], v9 offset:32768
    ds_read_b128 v[172:175], v9 offset:34816
    v_mfma_f32_16x16x32_bf16 v[84:87], v[164:167], v[16:19], v[84:87]
    ds_read_b64_tr_b16 v[40:41], v12 offset:30208
    ds_read_b64_tr_b16 v[42:43], v12 offset:30384
    v_mfma_f32_16x16x32_bf16 v[88:91], v[160:163], v[20:23], v[88:91]
    ds_read_b64_tr_b16 v[44:45], v12 offset:30240
    v_mfma_f32_16x16x32_bf16 v[92:95], v[164:167], v[20:23], v[92:95]
    ds_read_b64_tr_b16 v[46:47], v12 offset:30416
    s_waitcnt lgkmcnt(11)
    v_mfma_f32_16x16x32_bf16 v[96:99], v[160:163], v[24:27], v[96:99]
    ds_read_b64_tr_b16 v[16:17], v12 offset:30264
    v_mfma_f32_16x16x32_bf16 v[100:103], v[164:167], v[24:27], v[100:103]
    ds_read_b64_tr_b16 v[18:19], v12 offset:30440
    v_mfma_f32_16x16x32_bf16 v[104:107], v[160:163], v[28:31], v[104:107]
    ds_read_b64_tr_b16 v[20:21], v12 offset:30296
    v_mfma_f32_16x16x32_bf16 v[108:111], v[164:167], v[28:31], v[108:111]
    ds_read_b64_tr_b16 v[22:23], v12 offset:30472
    s_waitcnt lgkmcnt(10)
    v_mfma_f32_16x16x32_bf16 v[112:115], v[160:163], v[32:35], v[112:115]
    ds_read_b64_tr_b16 v[24:25], v12 offset:30320
    ds_read_b64_tr_b16 v[26:27], v12 offset:30496
    v_mfma_f32_16x16x32_bf16 v[116:119], v[164:167], v[32:35], v[116:119]
    ds_read_b64_tr_b16 v[28:29], v12 offset:30352
    v_mfma_f32_16x16x32_bf16 v[120:123], v[160:163], v[36:39], v[120:123]
    ds_read_b64_tr_b16 v[30:31], v12 offset:30528
    v_mfma_f32_16x16x32_bf16 v[124:127], v[164:167], v[36:39], v[124:127]
    ds_read_b128 v[200:203], v79 offset:320
    v_mfma_f32_16x16x32_bf16 v[240:243], v[192:195], v[160:163], v[240:243]
    v_mfma_f32_16x16x32_bf16 v[244:247], v[192:195], v[164:167], v[244:247]
    v_lshlrev_b32 v2, 3, v1
    v_mov_b32 v76, 0
    v_mov_b32 v77, 0
    s_add_u32 s46, s45, 2048
    s_mov_b64 exec, 0xffff
    buffer_store_dwordx2 v[76:77], v2, s[28:31], s45 offen sc1
    s_mov_b64 exec, -1
    s_mov_b64 exec, 0xffff
    buffer_store_dwordx2 v[76:77], v2, s[28:31], s46 offen sc1
    s_mov_b64 exec, -1
    s_waitcnt lgkmcnt(9)
    s_barrier
    v_mfma_f32_16x16x32_bf16 v[80:83], v[168:171], v[40:43], v[80:83]
    ds_read_b128 v[176:179], v8 offset:49152
    ds_read_b128 v[180:183], v8 offset:51200
    v_mfma_f32_16x16x32_bf16 v[84:87], v[172:175], v[40:43], v[84:87]
    ds_read_b64_tr_b16 v[32:33], v12 offset:36864
    ds_read_b64_tr_b16 v[34:35], v12 offset:37040
    v_mfma_f32_16x16x32_bf16 v[88:91], v[168:171], v[44:47], v[88:91]
    ds_read_b64_tr_b16 v[36:37], v12 offset:36896
    v_mfma_f32_16x16x32_bf16 v[92:95], v[172:175], v[44:47], v[92:95]
    ds_read_b64_tr_b16 v[38:39], v12 offset:37072
    s_waitcnt lgkmcnt(11)
    v_mfma_f32_16x16x32_bf16 v[96:99], v[168:171], v[16:19], v[96:99]
    ds_read_b64_tr_b16 v[40:41], v12 offset:36920
    v_mfma_f32_16x16x32_bf16 v[100:103], v[172:175], v[16:19], v[100:103]
    ds_read_b64_tr_b16 v[42:43], v12 offset:37096
    v_mfma_f32_16x16x32_bf16 v[104:107], v[168:171], v[20:23], v[104:107]
    ds_read_b64_tr_b16 v[44:45], v12 offset:36952
    v_mfma_f32_16x16x32_bf16 v[108:111], v[172:175], v[20:23], v[108:111]
    ds_read_b64_tr_b16 v[46:47], v12 offset:37128
    s_waitcnt lgkmcnt(10)
    v_mfma_f32_16x16x32_bf16 v[112:115], v[168:171], v[24:27], v[112:115]
    ds_read_b64_tr_b16 v[16:17], v12 offset:36976
    ds_read_b64_tr_b16 v[18:19], v12 offset:37152
    v_mfma_f32_16x16x32_bf16 v[116:119], v[172:175], v[24:27], v[116:119]
    ds_read_b64_tr_b16 v[20:21], v12 offset:37008
    v_mfma_f32_16x16x32_bf16 v[120:123], v[168:171], v[28:31], v[120:123]
    ds_read_b64_tr_b16 v[22:23], v12 offset:37184
    v_mfma_f32_16x16x32_bf16 v[124:127], v[172:175], v[28:31], v[124:127]
    ds_read_b128 v[208:211], v79 offset:384
    v_mfma_f32_16x16x32_bf16 v[240:243], v[200:203], v[168:171], v[240:243]
    v_mfma_f32_16x16x32_bf16 v[244:247], v[200:203], v[172:175], v[244:247]
    s_waitcnt lgkmcnt(9)
    v_mfma_f32_16x16x32_bf16 v[80:83], v[176:179], v[32:35], v[80:83]
    ds_read_b128 v[184:187], v9 offset:49152
    ds_read_b128 v[188:191], v9 offset:51200
    v_mfma_f32_16x16x32_bf16 v[84:87], v[180:183], v[32:35], v[84:87]
    ds_read_b64_tr_b16 v[24:25], v12 offset:42496
    ds_read_b64_tr_b16 v[26:27], v12 offset:42672
    v_mfma_f32_16x16x32_bf16 v[88:91], v[176:179], v[36:39], v[88:91]
    ds_read_b64_tr_b16 v[28:29], v12 offset:42528
    v_mfma_f32_16x16x32_bf16 v[92:95], v[180:183], v[36:39], v[92:95]
    ds_read_b64_tr_b16 v[30:31], v12 offset:42704
    s_waitcnt lgkmcnt(11)
    v_mfma_f32_16x16x32_bf16 v[96:99], v[176:179], v[40:43], v[96:99]
    ds_read_b64_tr_b16 v[32:33], v12 offset:42552
    v_mfma_f32_16x16x32_bf16 v[100:103], v[180:183], v[40:43], v[100:103]
    ds_read_b64_tr_b16 v[34:35], v12 offset:42728
    v_mfma_f32_16x16x32_bf16 v[104:107], v[176:179], v[44:47], v[104:107]
    ds_read_b64_tr_b16 v[36:37], v12 offset:42584
    v_mfma_f32_16x16x32_bf16 v[108:111], v[180:183], v[44:47], v[108:111]
    ds_read_b64_tr_b16 v[38:39], v12 offset:42760
    s_waitcnt lgkmcnt(10)
    v_mfma_f32_16x16x32_bf16 v[112:115], v[176:179], v[16:19], v[112:115]
    ds_read_b64_tr_b16 v[40:41], v12 offset:42608
    ds_read_b64_tr_b16 v[42:43], v12 offset:42784
    v_mfma_f32_16x16x32_bf16 v[116:119], v[180:183], v[16:19], v[116:119]
    ds_read_b64_tr_b16 v[44:45], v12 offset:42640
    v_mfma_f32_16x16x32_bf16 v[120:123], v[176:179], v[20:23], v[120:123]
    ds_read_b64_tr_b16 v[46:47], v12 offset:42816
    v_mfma_f32_16x16x32_bf16 v[124:127], v[180:183], v[20:23], v[124:127]
    ds_read_b128 v[216:219], v79 offset:448
    v_mfma_f32_16x16x32_bf16 v[240:243], v[208:211], v[176:179], v[240:243]
    v_mfma_f32_16x16x32_bf16 v[244:247], v[208:211], v[180:183], v[244:247]
    s_waitcnt lgkmcnt(9)
    s_barrier
    v_mfma_f32_16x16x32_bf16 v[80:83], v[184:187], v[24:27], v[80:83]
    ds_read_b128 v[192:195], v8 offset:0
    ds_read_b128 v[196:199], v8 offset:2048
    v_mfma_f32_16x16x32_bf16 v[84:87], v[188:191], v[24:27], v[84:87]
    ds_read_b64_tr_b16 v[16:17], v12 offset:49152
    ds_read_b64_tr_b16 v[18:19], v12 offset:49328
    v_mfma_f32_16x16x32_bf16 v[88:91], v[184:187], v[28:31], v[88:91]
    ds_read_b64_tr_b16 v[20:21], v12 offset:49184
    v_mfma_f32_16x16x32_bf16 v[92:95], v[188:191], v[28:31], v[92:95]
    ds_read_b64_tr_b16 v[22:23], v12 offset:49360
    s_waitcnt lgkmcnt(11)
    v_mfma_f32_16x16x32_bf16 v[96:99], v[184:187], v[32:35], v[96:99]
    ds_read_b64_tr_b16 v[24:25], v12 offset:49208
    v_mfma_f32_16x16x32_bf16 v[100:103], v[188:191], v[32:35], v[100:103]
    ds_read_b64_tr_b16 v[26:27], v12 offset:49384
    v_mfma_f32_16x16x32_bf16 v[104:107], v[184:187], v[36:39], v[104:107]
    ds_read_b64_tr_b16 v[28:29], v12 offset:49240
    v_mfma_f32_16x16x32_bf16 v[108:111], v[188:191], v[36:39], v[108:111]
    ds_read_b64_tr_b16 v[30:31], v12 offset:49416
    buffer_load_dwordx2 v[76:77], off, s[96:99], 0 sc1
    s_waitcnt lgkmcnt(10)
    v_mfma_f32_16x16x32_bf16 v[112:115], v[184:187], v[40:43], v[112:115]
    ds_read_b64_tr_b16 v[32:33], v12 offset:49264
    ds_read_b64_tr_b16 v[34:35], v12 offset:49440
    v_mfma_f32_16x16x32_bf16 v[116:119], v[188:191], v[40:43], v[116:119]
    ds_read_b64_tr_b16 v[36:37], v12 offset:49296
    v_mfma_f32_16x16x32_bf16 v[120:123], v[184:187], v[44:47], v[120:123]
    ds_read_b64_tr_b16 v[38:39], v12 offset:49472
    v_mfma_f32_16x16x32_bf16 v[124:127], v[188:191], v[44:47], v[124:127]
    ds_read_b128 v[224:227], v79 offset:512
    v_mfma_f32_16x16x32_bf16 v[240:243], v[216:219], v[184:187], v[240:243]
    v_mfma_f32_16x16x32_bf16 v[244:247], v[216:219], v[188:191], v[244:247]
    s_waitcnt lgkmcnt(9)
    v_mfma_f32_16x16x32_bf16 v[80:83], v[192:195], v[16:19], v[80:83]
    ds_read_b128 v[200:203], v9 offset:0
    ds_read_b128 v[204:207], v9 offset:2048
    v_mfma_f32_16x16x32_bf16 v[84:87], v[196:199], v[16:19], v[84:87]
    ds_read_b64_tr_b16 v[40:41], v12 offset:54784
    ds_read_b64_tr_b16 v[42:43], v12 offset:54960
    v_mfma_f32_16x16x32_bf16 v[88:91], v[192:195], v[20:23], v[88:91]
    ds_read_b64_tr_b16 v[44:45], v12 offset:54816
    v_mfma_f32_16x16x32_bf16 v[92:95], v[196:199], v[20:23], v[92:95]
    ds_read_b64_tr_b16 v[46:47], v12 offset:54992
    s_waitcnt lgkmcnt(11)
    v_mfma_f32_16x16x32_bf16 v[96:99], v[192:195], v[24:27], v[96:99]
    ds_read_b64_tr_b16 v[16:17], v12 offset:54840
    v_mfma_f32_16x16x32_bf16 v[100:103], v[196:199], v[24:27], v[100:103]
    ds_read_b64_tr_b16 v[18:19], v12 offset:55016
    v_mfma_f32_16x16x32_bf16 v[104:107], v[192:195], v[28:31], v[104:107]
    ds_read_b64_tr_b16 v[20:21], v12 offset:54872
    v_mfma_f32_16x16x32_bf16 v[108:111], v[196:199], v[28:31], v[108:111]
    ds_read_b64_tr_b16 v[22:23], v12 offset:55048
    s_waitcnt lgkmcnt(10)
    v_mfma_f32_16x16x32_bf16 v[112:115], v[192:195], v[32:35], v[112:115]
    ds_read_b64_tr_b16 v[24:25], v12 offset:54896
    ds_read_b64_tr_b16 v[26:27], v12 offset:55072
    v_mfma_f32_16x16x32_bf16 v[116:119], v[196:199], v[32:35], v[116:119]
    ds_read_b64_tr_b16 v[28:29], v12 offset:54928
    v_mfma_f32_16x16x32_bf16 v[120:123], v[192:195], v[36:39], v[120:123]
    ds_read_b64_tr_b16 v[30:31], v12 offset:55104
    v_mfma_f32_16x16x32_bf16 v[124:127], v[196:199], v[36:39], v[124:127]
    ds_read_b128 v[232:235], v79 offset:576
    v_mfma_f32_16x16x32_bf16 v[240:243], v[224:227], v[192:195], v[240:243]
    v_mfma_f32_16x16x32_bf16 v[244:247], v[224:227], v[196:199], v[244:247]
    s_waitcnt lgkmcnt(9)
    s_barrier
    v_mfma_f32_16x16x32_bf16 v[80:83], v[200:203], v[40:43], v[80:83]
    ds_read_b128 v[208:211], v8 offset:16384
    ds_read_b128 v[212:215], v8 offset:18432
    v_mfma_f32_16x16x32_bf16 v[84:87], v[204:207], v[40:43], v[84:87]
    ds_read_b64_tr_b16 v[32:33], v12 offset:0
    ds_read_b64_tr_b16 v[34:35], v12 offset:176
    v_mfma_f32_16x16x32_bf16 v[88:91], v[200:203], v[44:47], v[88:91]
    ds_read_b64_tr_b16 v[36:37], v12 offset:32
    v_mfma_f32_16x16x32_bf16 v[92:95], v[204:207], v[44:47], v[92:95]
    ds_read_b64_tr_b16 v[38:39], v12 offset:208
    s_waitcnt lgkmcnt(11)
    v_mfma_f32_16x16x32_bf16 v[96:99], v[200:203], v[16:19], v[96:99]
    ds_read_b64_tr_b16 v[40:41], v12 offset:56
    v_mfma_f32_16x16x32_bf16 v[100:103], v[204:207], v[16:19], v[100:103]
    ds_read_b64_tr_b16 v[42:43], v12 offset:232
    v_mfma_f32_16x16x32_bf16 v[104:107], v[200:203], v[20:23], v[104:107]
    ds_read_b64_tr_b16 v[44:45], v12 offset:88
    v_mfma_f32_16x16x32_bf16 v[108:111], v[204:207], v[20:23], v[108:111]
    ds_read_b64_tr_b16 v[46:47], v12 offset:264
    s_waitcnt lgkmcnt(10)
    v_mfma_f32_16x16x32_bf16 v[112:115], v[200:203], v[24:27], v[112:115]
    ds_read_b64_tr_b16 v[16:17], v12 offset:112
    v_mfma_f32_16x16x32_bf16 v[116:119], v[204:207], v[24:27], v[116:119]
    ds_read_b64_tr_b16 v[18:19], v12 offset:288
    v_mfma_f32_16x16x32_bf16 v[120:123], v[200:203], v[28:31], v[120:123]
    ds_read_b64_tr_b16 v[20:21], v12 offset:144
    v_mfma_f32_16x16x32_bf16 v[124:127], v[204:207], v[28:31], v[124:127]
    ds_read_b64_tr_b16 v[22:23], v12 offset:320
    v_mfma_f32_16x16x32_bf16 v[240:243], v[232:235], v[200:203], v[240:243]
    v_mfma_f32_16x16x32_bf16 v[244:247], v[232:235], v[204:207], v[244:247]
    s_waitcnt lgkmcnt(8)
    v_mfma_f32_16x16x32_bf16 v[80:83], v[208:211], v[32:35], v[80:83]
    ds_read_b128 v[216:219], v9 offset:16384
    ds_read_b128 v[220:223], v9 offset:18432
    v_mfma_f32_16x16x32_bf16 v[84:87], v[212:215], v[32:35], v[84:87]
    ds_read_b64_tr_b16 v[24:25], v12 offset:5632
    ds_read_b64_tr_b16 v[26:27], v12 offset:5808
    v_mfma_f32_16x16x32_bf16 v[88:91], v[208:211], v[36:39], v[88:91]
    ds_read_b64_tr_b16 v[28:29], v12 offset:5664
    v_mfma_f32_16x16x32_bf16 v[92:95], v[212:215], v[36:39], v[92:95]
    ds_read_b64_tr_b16 v[30:31], v12 offset:5840
    s_waitcnt lgkmcnt(10)
    v_mfma_f32_16x16x32_bf16 v[96:99], v[208:211], v[40:43], v[96:99]
    ds_read_b64_tr_b16 v[32:33], v12 offset:5688
    v_mfma_f32_16x16x32_bf16 v[100:103], v[212:215], v[40:43], v[100:103]
    ds_read_b64_tr_b16 v[34:35], v12 offset:5864
    v_mfma_f32_16x16x32_bf16 v[104:107], v[208:211], v[44:47], v[104:107]
    ds_read_b64_tr_b16 v[36:37], v12 offset:5720
    v_mfma_f32_16x16x32_bf16 v[108:111], v[212:215], v[44:47], v[108:111]
    ds_read_b64_tr_b16 v[38:39], v12 offset:5896
    s_waitcnt lgkmcnt(10)
    v_mfma_f32_16x16x32_bf16 v[112:115], v[208:211], v[16:19], v[112:115]
    ds_read_b64_tr_b16 v[40:41], v12 offset:5744
    v_mfma_f32_16x16x32_bf16 v[116:119], v[212:215], v[16:19], v[116:119]
    ds_read_b64_tr_b16 v[42:43], v12 offset:5920
    v_mfma_f32_16x16x32_bf16 v[120:123], v[208:211], v[20:23], v[120:123]
    ds_read_b64_tr_b16 v[44:45], v12 offset:5776
    v_mfma_f32_16x16x32_bf16 v[124:127], v[212:215], v[20:23], v[124:127]
    ds_read_b64_tr_b16 v[46:47], v12 offset:5952
    s_waitcnt lgkmcnt(8)
    s_barrier
    v_mfma_f32_16x16x32_bf16 v[80:83], v[216:219], v[24:27], v[80:83]
    ds_read_b128 v[224:227], v8 offset:32768
    ds_read_b128 v[228:231], v8 offset:34816
    v_mfma_f32_16x16x32_bf16 v[84:87], v[220:223], v[24:27], v[84:87]
    ds_read_b64_tr_b16 v[16:17], v12 offset:12288
    ds_read_b64_tr_b16 v[18:19], v12 offset:12464
    v_mfma_f32_16x16x32_bf16 v[88:91], v[216:219], v[28:31], v[88:91]
    ds_read_b64_tr_b16 v[20:21], v12 offset:12320
    v_mfma_f32_16x16x32_bf16 v[92:95], v[220:223], v[28:31], v[92:95]
    ds_read_b64_tr_b16 v[22:23], v12 offset:12496
    s_waitcnt lgkmcnt(10)
    v_mfma_f32_16x16x32_bf16 v[96:99], v[216:219], v[32:35], v[96:99]
    ds_read_b64_tr_b16 v[24:25], v12 offset:12344
    v_mfma_f32_16x16x32_bf16 v[100:103], v[220:223], v[32:35], v[100:103]
    ds_read_b64_tr_b16 v[26:27], v12 offset:12520
    v_mfma_f32_16x16x32_bf16 v[104:107], v[216:219], v[36:39], v[104:107]
    ds_read_b64_tr_b16 v[28:29], v12 offset:12376
    v_mfma_f32_16x16x32_bf16 v[108:111], v[220:223], v[36:39], v[108:111]
    ds_read_b64_tr_b16 v[30:31], v12 offset:12552
    s_waitcnt lgkmcnt(10)
    v_mfma_f32_16x16x32_bf16 v[112:115], v[216:219], v[40:43], v[112:115]
    ds_read_b64_tr_b16 v[32:33], v12 offset:12400
    v_mfma_f32_16x16x32_bf16 v[116:119], v[220:223], v[40:43], v[116:119]
    ds_read_b64_tr_b16 v[34:35], v12 offset:12576
    v_mfma_f32_16x16x32_bf16 v[120:123], v[216:219], v[44:47], v[120:123]
    ds_read_b64_tr_b16 v[36:37], v12 offset:12432
    v_mfma_f32_16x16x32_bf16 v[124:127], v[220:223], v[44:47], v[124:127]
    ds_read_b64_tr_b16 v[38:39], v12 offset:12608
    s_waitcnt lgkmcnt(8)
    v_mfma_f32_16x16x32_bf16 v[80:83], v[224:227], v[16:19], v[80:83]
    ds_read_b128 v[232:235], v9 offset:32768
    ds_read_b128 v[236:239], v9 offset:34816
    v_mfma_f32_16x16x32_bf16 v[84:87], v[228:231], v[16:19], v[84:87]
    ds_read_b64_tr_b16 v[40:41], v12 offset:17920
    ds_read_b64_tr_b16 v[42:43], v12 offset:18096
    v_mfma_f32_16x16x32_bf16 v[88:91], v[224:227], v[20:23], v[88:91]
    ds_read_b64_tr_b16 v[44:45], v12 offset:17952
    v_mfma_f32_16x16x32_bf16 v[92:95], v[228:231], v[20:23], v[92:95]
    ds_read_b64_tr_b16 v[46:47], v12 offset:18128
    s_waitcnt lgkmcnt(10)
    v_mfma_f32_16x16x32_bf16 v[96:99], v[224:227], v[24:27], v[96:99]
    ds_read_b64_tr_b16 v[16:17], v12 offset:17976
    v_mfma_f32_16x16x32_bf16 v[100:103], v[228:231], v[24:27], v[100:103]
    ds_read_b64_tr_b16 v[18:19], v12 offset:18152
    v_mfma_f32_16x16x32_bf16 v[104:107], v[224:227], v[28:31], v[104:107]
    ds_read_b64_tr_b16 v[20:21], v12 offset:18008
    v_mfma_f32_16x16x32_bf16 v[108:111], v[228:231], v[28:31], v[108:111]
    ds_read_b64_tr_b16 v[22:23], v12 offset:18184
    s_waitcnt lgkmcnt(10)
    v_mfma_f32_16x16x32_bf16 v[112:115], v[224:227], v[32:35], v[112:115]
    ds_read_b64_tr_b16 v[24:25], v12 offset:18032
    v_mfma_f32_16x16x32_bf16 v[116:119], v[228:231], v[32:35], v[116:119]
    ds_read_b64_tr_b16 v[26:27], v12 offset:18208
    v_mfma_f32_16x16x32_bf16 v[120:123], v[224:227], v[36:39], v[120:123]
    ds_read_b64_tr_b16 v[28:29], v12 offset:18064
    v_mfma_f32_16x16x32_bf16 v[124:127], v[228:231], v[36:39], v[124:127]
    ds_read_b64_tr_b16 v[30:31], v12 offset:18240
    s_waitcnt lgkmcnt(8)
    v_mfma_f32_16x16x32_bf16 v[80:83], v[232:235], v[40:43], v[80:83]
    v_mfma_f32_16x16x32_bf16 v[84:87], v[236:239], v[40:43], v[84:87]
    v_mfma_f32_16x16x32_bf16 v[88:91], v[232:235], v[44:47], v[88:91]
    v_mfma_f32_16x16x32_bf16 v[92:95], v[236:239], v[44:47], v[92:95]
    s_waitcnt lgkmcnt(4)
    v_mfma_f32_16x16x32_bf16 v[96:99], v[232:235], v[16:19], v[96:99]
    v_mfma_f32_16x16x32_bf16 v[100:103], v[236:239], v[16:19], v[100:103]
    v_mfma_f32_16x16x32_bf16 v[104:107], v[232:235], v[20:23], v[104:107]
    v_mfma_f32_16x16x32_bf16 v[108:111], v[236:239], v[20:23], v[108:111]
    s_nop 1
    s_waitcnt lgkmcnt(0)
    v_mfma_f32_16x16x32_bf16 v[112:115], v[232:235], v[24:27], v[112:115]
    v_mfma_f32_16x16x32_bf16 v[116:119], v[236:239], v[24:27], v[116:119]
    v_mfma_f32_16x16x32_bf16 v[120:123], v[232:235], v[28:31], v[120:123]
    v_mfma_f32_16x16x32_bf16 v[124:127], v[236:239], v[28:31], v[124:127]
    ds_read_b128 v[32:35], v79 offset:640
    ds_read_b128 v[36:39], v79 offset:704
    ds_read_b128 v[40:43], v79 offset:768
    ds_read_b128 v[44:47], v79 offset:832
    v_cvt_pk_bf16_f32 v52, v80, v81
    v_cvt_pk_bf16_f32 v53, v82, v83
    v_cvt_pk_bf16_f32 v54, v84, v85
    v_cvt_pk_bf16_f32 v55, v86, v87
    s_mov_b32 exec_lo, 0x0fff0fff
    s_mov_b32 exec_hi, 0x0fff0fff
    v_cvt_pk_bf16_f32 v56, v88, v89
    v_cvt_pk_bf16_f32 v57, v90, v91
    v_cvt_pk_bf16_f32 v58, v92, v93
    v_cvt_pk_bf16_f32 v59, v94, v95
    s_mov_b64 exec, -1
    buffer_store_dwordx4 v[52:55], v14, s[28:31], s54 offen sc1
    buffer_store_dwordx4 v[56:59], v14, s[28:31], s54 offen offset:256 sc1
    v_cvt_pk_bf16_f32 v60, v96, v97
    v_cvt_pk_bf16_f32 v61, v98, v99
    v_cvt_pk_bf16_f32 v62, v100, v101
    v_cvt_pk_bf16_f32 v63, v102, v103
    s_mov_b32 exec_lo, 0x0fff0fff
    s_mov_b32 exec_hi, 0x0fff0fff
    v_cvt_pk_bf16_f32 v64, v104, v105
    v_cvt_pk_bf16_f32 v65, v106, v107
    v_cvt_pk_bf16_f32 v66, v108, v109
    v_cvt_pk_bf16_f32 v67, v110, v111
    s_mov_b64 exec, -1
    buffer_store_dwordx4 v[60:63], v14, s[28:31], s55 offen sc1
    buffer_store_dwordx4 v[64:67], v14, s[28:31], s55 offen offset:256 sc1
    v_cvt_pk_bf16_f32 v68, v112, v113
    v_cvt_pk_bf16_f32 v69, v114, v115
    v_cvt_pk_bf16_f32 v70, v116, v117
    v_cvt_pk_bf16_f32 v71, v118, v119
    s_mov_b32 exec_lo, 0x0fff0fff
    s_mov_b32 exec_hi, 0x0fff0fff
    v_cvt_pk_bf16_f32 v72, v120, v121
    v_cvt_pk_bf16_f32 v73, v122, v123
    v_cvt_pk_bf16_f32 v74, v124, v125
    v_cvt_pk_bf16_f32 v75, v126, v127
    s_mov_b64 exec, -1
    buffer_store_dwordx4 v[68:71], v14, s[28:31], s17 offen sc1
    buffer_store_dwordx4 v[72:75], v14, s[28:31], s17 offen offset:256 sc1
    s_waitcnt lgkmcnt(0)
    v_mfma_f32_16x16x32_bf16 v[240:243], v[32:35], v[208:211], v[240:243]
    v_mfma_f32_16x16x32_bf16 v[244:247], v[32:35], v[212:215], v[244:247]
    v_mfma_f32_16x16x32_bf16 v[240:243], v[36:39], v[216:219], v[240:243]
    v_mfma_f32_16x16x32_bf16 v[244:247], v[36:39], v[220:223], v[244:247]
    v_mfma_f32_16x16x32_bf16 v[240:243], v[40:43], v[224:227], v[240:243]
    v_mfma_f32_16x16x32_bf16 v[244:247], v[40:43], v[228:231], v[244:247]
    v_mfma_f32_16x16x32_bf16 v[240:243], v[44:47], v[232:235], v[240:243]
    v_mfma_f32_16x16x32_bf16 v[244:247], v[44:47], v[236:239], v[244:247]
    s_barrier
    ds_read_b64_tr_b16 v[16:17], v6 offset:0
    ds_read_b64_tr_b16 v[18:19], v6 offset:176
    ds_read_b64_tr_b16 v[20:21], v6 offset:32
    ds_read_b64_tr_b16 v[22:23], v6 offset:208
    ds_read_b64_tr_b16 v[24:25], v6 offset:56
    ds_read_b64_tr_b16 v[26:27], v6 offset:232
    ds_read_b64_tr_b16 v[28:29], v6 offset:88
    ds_read_b64_tr_b16 v[30:31], v6 offset:264
    ds_read_b64_tr_b16 v[32:33], v6 offset:112
    ds_read_b64_tr_b16 v[34:35], v6 offset:288
    ds_read_b64_tr_b16 v[36:37], v6 offset:144
    ds_read_b64_tr_b16 v[38:39], v6 offset:320
    s_waitcnt lgkmcnt(8)
    v_mfma_f32_16x16x32_bf16 v[80:83], v[128:131], v[16:19], 0
    ds_read_b64_tr_b16 v[40:41], v6 offset:5632
    v_mfma_f32_16x16x32_bf16 v[84:87], v[132:135], v[16:19], 0
    ds_read_b64_tr_b16 v[42:43], v6 offset:5808
    v_mfma_f32_16x16x32_bf16 v[88:91], v[128:131], v[20:23], 0
    ds_read_b64_tr_b16 v[44:45], v6 offset:5664
    v_mfma_f32_16x16x32_bf16 v[92:95], v[132:135], v[20:23], 0
    ds_read_b64_tr_b16 v[46:47], v6 offset:5840
    s_waitcnt lgkmcnt(8)
    v_mfma_f32_16x16x32_bf16 v[96:99], v[128:131], v[24:27], 0
    ds_read_b64_tr_b16 v[16:17], v6 offset:5688
    v_mfma_f32_16x16x32_bf16 v[100:103], v[132:135], v[24:27], 0
    ds_read_b64_tr_b16 v[18:19], v6 offset:5864
    v_mfma_f32_16x16x32_bf16 v[104:107], v[128:131], v[28:31], 0
    ds_read_b64_tr_b16 v[20:21], v6 offset:5720
    v_mfma_f32_16x16x32_bf16 v[108:111], v[132:135], v[28:31], 0
    ds_read_b64_tr_b16 v[22:23], v6 offset:5896
    s_waitcnt lgkmcnt(8)
    v_mfma_f32_16x16x32_bf16 v[112:115], v[128:131], v[32:35], 0
    ds_read_b64_tr_b16 v[24:25], v6 offset:5744
    v_mfma_f32_16x16x32_bf16 v[116:119], v[132:135], v[32:35], 0
    ds_read_b64_tr_b16 v[26:27], v6 offset:5920
    v_mfma_f32_16x16x32_bf16 v[120:123], v[128:131], v[36:39], 0
    ds_read_b64_tr_b16 v[28:29], v6 offset:5776
    v_mfma_f32_16x16x32_bf16 v[124:127], v[132:135], v[36:39], 0
    ds_read_b64_tr_b16 v[30:31], v6 offset:5952
    s_waitcnt lgkmcnt(8)
    v_mfma_f32_16x16x32_bf16 v[80:83], v[136:139], v[40:43], v[80:83]
    ds_read_b64_tr_b16 v[32:33], v6 offset:12288
    v_mfma_f32_16x16x32_bf16 v[84:87], v[140:143], v[40:43], v[84:87]
    ds_read_b64_tr_b16 v[34:35], v6 offset:12464
    v_mfma_f32_16x16x32_bf16 v[88:91], v[136:139], v[44:47], v[88:91]
    ds_read_b64_tr_b16 v[36:37], v6 offset:12320
    v_mfma_f32_16x16x32_bf16 v[92:95], v[140:143], v[44:47], v[92:95]
    ds_read_b64_tr_b16 v[38:39], v6 offset:12496
    s_waitcnt lgkmcnt(8)
    v_mfma_f32_16x16x32_bf16 v[96:99], v[136:139], v[16:19], v[96:99]
    ds_read_b64_tr_b16 v[40:41], v6 offset:12344
    v_mfma_f32_16x16x32_bf16 v[100:103], v[140:143], v[16:19], v[100:103]
    ds_read_b64_tr_b16 v[42:43], v6 offset:12520
    v_mfma_f32_16x16x32_bf16 v[104:107], v[136:139], v[20:23], v[104:107]
    ds_read_b64_tr_b16 v[44:45], v6 offset:12376
    v_mfma_f32_16x16x32_bf16 v[108:111], v[140:143], v[20:23], v[108:111]
    ds_read_b64_tr_b16 v[46:47], v6 offset:12552
    s_waitcnt lgkmcnt(8)
    v_mfma_f32_16x16x32_bf16 v[112:115], v[136:139], v[24:27], v[112:115]
    ds_read_b64_tr_b16 v[16:17], v6 offset:12400
    v_mfma_f32_16x16x32_bf16 v[116:119], v[140:143], v[24:27], v[116:119]
    ds_read_b64_tr_b16 v[18:19], v6 offset:12576
    v_mfma_f32_16x16x32_bf16 v[120:123], v[136:139], v[28:31], v[120:123]
    ds_read_b64_tr_b16 v[20:21], v6 offset:12432
    v_mfma_f32_16x16x32_bf16 v[124:127], v[140:143], v[28:31], v[124:127]
    ds_read_b64_tr_b16 v[22:23], v6 offset:12608
    s_waitcnt lgkmcnt(8)
    v_mfma_f32_16x16x32_bf16 v[80:83], v[144:147], v[32:35], v[80:83]
    ds_read_b64_tr_b16 v[24:25], v6 offset:17920
    v_mfma_f32_16x16x32_bf16 v[84:87], v[148:151], v[32:35], v[84:87]
    ds_read_b64_tr_b16 v[26:27], v6 offset:18096
    v_mfma_f32_16x16x32_bf16 v[88:91], v[144:147], v[36:39], v[88:91]
    ds_read_b64_tr_b16 v[28:29], v6 offset:17952
    v_mfma_f32_16x16x32_bf16 v[92:95], v[148:151], v[36:39], v[92:95]
    ds_read_b64_tr_b16 v[30:31], v6 offset:18128
    s_waitcnt lgkmcnt(8)
    v_mfma_f32_16x16x32_bf16 v[96:99], v[144:147], v[40:43], v[96:99]
    ds_read_b64_tr_b16 v[32:33], v6 offset:17976
    v_mfma_f32_16x16x32_bf16 v[100:103], v[148:151], v[40:43], v[100:103]
    ds_read_b64_tr_b16 v[34:35], v6 offset:18152
    v_mfma_f32_16x16x32_bf16 v[104:107], v[144:147], v[44:47], v[104:107]
    ds_read_b64_tr_b16 v[36:37], v6 offset:18008
    v_mfma_f32_16x16x32_bf16 v[108:111], v[148:151], v[44:47], v[108:111]
    ds_read_b64_tr_b16 v[38:39], v6 offset:18184
    s_waitcnt lgkmcnt(8)
    v_mfma_f32_16x16x32_bf16 v[112:115], v[144:147], v[16:19], v[112:115]
    ds_read_b64_tr_b16 v[40:41], v6 offset:18032
    v_mfma_f32_16x16x32_bf16 v[116:119], v[148:151], v[16:19], v[116:119]
    ds_read_b64_tr_b16 v[42:43], v6 offset:18208
    v_mfma_f32_16x16x32_bf16 v[120:123], v[144:147], v[20:23], v[120:123]
    ds_read_b64_tr_b16 v[44:45], v6 offset:18064
    v_mfma_f32_16x16x32_bf16 v[124:127], v[148:151], v[20:23], v[124:127]
    ds_read_b64_tr_b16 v[46:47], v6 offset:18240
    s_waitcnt vmcnt(0)
    s_mov_b32 s61, 65536
go_a_lp_69:
    v_cmp_eq_u32 vcc, 0, v76
    s_sub_u32 s61, s61, 1
    s_cselect_b64 vcc, 0, vcc
    s_cbranch_vccz go_a_ok_68
    s_sleep 8
    buffer_load_dwordx2 v[76:77], off, s[96:99], 0 sc1
    s_waitcnt vmcnt(0)
    s_branch go_a_lp_69
go_a_ok_68:
    v_readfirstlane_b32 s100, v76
    v_readfirstlane_b32 s101, v77
    s_nop 1
    v_lshlrev_b32 v2, 3, v1
    v_mov_b32 v76, s100
    v_mov_b32 v77, s101
    s_mov_b64 exec, 0xffff
    buffer_store_dwordx2 v[76:77], v2, s[28:31], s52 offen sc1
    s_mov_b64 exec, -1
    s_waitcnt lgkmcnt(8)
    v_mfma_f32_16x16x32_bf16 v[80:83], v[152:155], v[24:27], v[80:83]
    ds_read_b64_tr_b16 v[16:17], v13 offset:24576
    v_mfma_f32_16x16x32_bf16 v[84:87], v[156:159], v[24:27], v[84:87]
    ds_read_b64_tr_b16 v[18:19], v13 offset:24752
    v_mfma_f32_16x16x32_bf16 v[88:91], v[152:155], v[28:31], v[88:91]
    ds_read_b64_tr_b16 v[20:21], v13 offset:24608
    v_mfma_f32_16x16x32_bf16 v[92:95], v[156:159], v[28:31], v[92:95]
    ds_read_b64_tr_b16 v[22:23], v13 offset:24784
    s_waitcnt lgkmcnt(8)
    v_mfma_f32_16x16x32_bf16 v[96:99], v[152:155], v[32:35], v[96:99]
    ds_read_b64_tr_b16 v[24:25], v13 offset:24632
    v_mfma_f32_16x16x32_bf16 v[100:103], v[156:159], v[32:35], v[100:103]
    ds_read_b64_tr_b16 v[26:27], v13 offset:24808
    v_mfma_f32_16x16x32_bf16 v[104:107], v[152:155], v[36:39], v[104:107]
    ds_read_b64_tr_b16 v[28:29], v13 offset:24664
    v_mfma_f32_16x16x32_bf16 v[108:111], v[156:159], v[36:39], v[108:111]
    ds_read_b64_tr_b16 v[30:31], v13 offset:24840
    s_waitcnt lgkmcnt(8)
    v_mfma_f32_16x16x32_bf16 v[112:115], v[152:155], v[40:43], v[112:115]
    ds_read_b64_tr_b16 v[32:33], v13 offset:24688
    v_mfma_f32_16x16x32_bf16 v[116:119], v[156:159], v[40:43], v[116:119]
    ds_read_b64_tr_b16 v[34:35], v13 offset:24864
    v_mfma_f32_16x16x32_bf16 v[120:123], v[152:155], v[44:47], v[120:123]
    ds_read_b64_tr_b16 v[36:37], v13 offset:24720
    v_mfma_f32_16x16x32_bf16 v[124:127], v[156:159], v[44:47], v[124:127]
    ds_read_b64_tr_b16 v[38:39], v13 offset:24896
    s_waitcnt lgkmcnt(8)
    v_mfma_f32_16x16x32_bf16 v[80:83], v[160:163], v[16:19], v[80:83]
    ds_read_b64_tr_b16 v[40:41], v13 offset:30208
    v_mfma_f32_16x16x32_bf16 v[84:87], v[164:167], v[16:19], v[84:87]
    ds_read_b64_tr_b16 v[42:43], v13 offset:30384
    v_mfma_f32_16x16x32_bf16 v[88:91], v[160:163], v[20:23], v[88:91]
    ds_read_b64_tr_b16 v[44:45], v13 offset:30240
    v_mfma_f32_16x16x32_bf16 v[92:95], v[164:167], v[20:23], v[92:95]
    ds_read_b64_tr_b16 v[46:47], v13 offset:30416
    s_waitcnt lgkmcnt(8)
    v_mfma_f32_16x16x32_bf16 v[96:99], v[160:163], v[24:27], v[96:99]
    ds_read_b64_tr_b16 v[16:17], v13 offset:30264
    v_mfma_f32_16x16x32_bf16 v[100:103], v[164:167], v[24:27], v[100:103]
    ds_read_b64_tr_b16 v[18:19], v13 offset:30440
    v_mfma_f32_16x16x32_bf16 v[104:107], v[160:163], v[28:31], v[104:107]
    ds_read_b64_tr_b16 v[20:21], v13 offset:30296
    v_mfma_f32_16x16x32_bf16 v[108:111], v[164:167], v[28:31], v[108:111]
    ds_read_b64_tr_b16 v[22:23], v13 offset:30472
    s_waitcnt lgkmcnt(8)
    v_mfma_f32_16x16x32_bf16 v[112:115], v[160:163], v[32:35], v[112:115]
    ds_read_b64_tr_b16 v[24:25], v13 offset:30320
    v_mfma_f32_16x16x32_bf16 v[116:119], v[164:167], v[32:35], v[116:119]
    ds_read_b64_tr_b16 v[26:27], v13 offset:30496
    v_mfma_f32_16x16x32_bf16 v[120:123], v[160:163], v[36:39], v[120:123]
    ds_read_b64_tr_b16 v[28:29], v13 offset:30352
    v_mfma_f32_16x16x32_bf16 v[124:127], v[164:167], v[36:39], v[124:127]
    ds_read_b64_tr_b16 v[30:31], v13 offset:30528
    s_waitcnt lgkmcnt(8)
    s_barrier
    v_mfma_f32_16x16x32_bf16 v[80:83], v[168:171], v[40:43], v[80:83]
    ds_read_b64_tr_b16 v[32:33], v5 offset:0
    v_mfma_f32_16x16x32_bf16 v[84:87], v[172:175], v[40:43], v[84:87]
    ds_read_b64_tr_b16 v[34:35], v5 offset:176
    v_mfma_f32_16x16x32_bf16 v[88:91], v[168:171], v[44:47], v[88:91]
    ds_read_b64_tr_b16 v[36:37], v5 offset:32
    v_mfma_f32_16x16x32_bf16 v[92:95], v[172:175], v[44:47], v[92:95]
    ds_read_b64_tr_b16 v[38:39], v5 offset:208
    s_waitcnt lgkmcnt(8)
    v_mfma_f32_16x16x32_bf16 v[96:99], v[168:171], v[16:19], v[96:99]
    ds_read_b64_tr_b16 v[40:41], v5 offset:56
    v_mfma_f32_16x16x32_bf16 v[100:103], v[172:175], v[16:19], v[100:103]
    ds_read_b64_tr_b16 v[42:43], v5 offset:232
    v_mfma_f32_16x16x32_bf16 v[104:107], v[168:171], v[20:23], v[104:107]
    ds_read_b64_tr_b16 v[44:45], v5 offset:88
    v_mfma_f32_16x16x32_bf16 v[108:111], v[172:175], v[20:23], v[108:111]
    ds_read_b64_tr_b16 v[46:47], v5 offset:264
    s_waitcnt lgkmcnt(8)
    v_mfma_f32_16x16x32_bf16 v[112:115], v[168:171], v[24:27], v[112:115]
    ds_read_b64_tr_b16 v[16:17], v5 offset:112
    v_mfma_f32_16x16x32_bf16 v[116:119], v[172:175], v[24:27], v[116:119]
    ds_read_b64_tr_b16 v[18:19], v5 offset:288
    v_mfma_f32_16x16x32_bf16 v[120:123], v[168:171], v[28:31], v[120:123]
    ds_read_b64_tr_b16 v[20:21], v5 offset:144
    v_mfma_f32_16x16x32_bf16 v[124:127], v[172:175], v[28:31], v[124:127]
    ds_read_b64_tr_b16 v[22:23], v5 offset:320
    s_waitcnt lgkmcnt(8)
    v_mfma_f32_16x16x32_bf16 v[80:83], v[176:179], v[32:35], v[80:83]
    ds_read_b64_tr_b16 v[24:25], v5 offset:5632
    v_mfma_f32_16x16x32_bf16 v[84:87], v[180:183], v[32:35], v[84:87]
    ds_read_b64_tr_b16 v[26:27], v5 offset:5808
    v_mfma_f32_16x16x32_bf16 v[88:91], v[176:179], v[36:39], v[88:91]
    ds_read_b64_tr_b16 v[28:29], v5 offset:5664
    v_mfma_f32_16x16x32_bf16 v[92:95], v[180:183], v[36:39], v[92:95]
    ds_read_b64_tr_b16 v[30:31], v5 offset:5840
    s_waitcnt lgkmcnt(8)
    v_mfma_f32_16x16x32_bf16 v[96:99], v[176:179], v[40:43], v[96:99]
    ds_read_b64_tr_b16 v[32:33], v5 offset:5688
    v_mfma_f32_16x16x32_bf16 v[100:103], v[180:183], v[40:43], v[100:103]
    ds_read_b64_tr_b16 v[34:35], v5 offset:5864
    v_mfma_f32_16x16x32_bf16 v[104:107], v[176:179], v[44:47], v[104:107]
    ds_read_b64_tr_b16 v[36:37], v5 offset:5720
    v_mfma_f32_16x16x32_bf16 v[108:111], v[180:183], v[44:47], v[108:111]
    ds_read_b64_tr_b16 v[38:39], v5 offset:5896
    s_waitcnt lgkmcnt(8)
    v_mfma_f32_16x16x32_bf16 v[112:115], v[176:179], v[16:19], v[112:115]
    ds_read_b64_tr_b16 v[40:41], v5 offset:5744
    v_mfma_f32_16x16x32_bf16 v[116:119], v[180:183], v[16:19], v[116:119]
    ds_read_b64_tr_b16 v[42:43], v5 offset:5920
    v_mfma_f32_16x16x32_bf16 v[120:123], v[176:179], v[20:23], v[120:123]
    ds_read_b64_tr_b16 v[44:45], v5 offset:5776
    v_mfma_f32_16x16x32_bf16 v[124:127], v[180:183], v[20:23], v[124:127]
    ds_read_b64_tr_b16 v[46:47], v5 offset:5952
    s_waitcnt lgkmcnt(8)
    v_mfma_f32_16x16x32_bf16 v[80:83], v[184:187], v[24:27], v[80:83]
    ds_read_b64_tr_b16 v[16:17], v13 offset:36864
    v_mfma_f32_16x16x32_bf16 v[84:87], v[188:191], v[24:27], v[84:87]
    ds_read_b64_tr_b16 v[18:19], v13 offset:37040
    v_mfma_f32_16x16x32_bf16 v[88:91], v[184:187], v[28:31], v[88:91]
    ds_read_b64_tr_b16 v[20:21], v13 offset:36896
    v_mfma_f32_16x16x32_bf16 v[92:95], v[188:191], v[28:31], v[92:95]
    ds_read_b64_tr_b16 v[22:23], v13 offset:37072
    s_waitcnt lgkmcnt(8)
    v_mfma_f32_16x16x32_bf16 v[96:99], v[184:187], v[32:35], v[96:99]
    ds_read_b64_tr_b16 v[24:25], v13 offset:36920
    v_mfma_f32_16x16x32_bf16 v[100:103], v[188:191], v[32:35], v[100:103]
    ds_read_b64_tr_b16 v[26:27], v13 offset:37096
    v_mfma_f32_16x16x32_bf16 v[104:107], v[184:187], v[36:39], v[104:107]
    ds_read_b64_tr_b16 v[28:29], v13 offset:36952
    v_mfma_f32_16x16x32_bf16 v[108:111], v[188:191], v[36:39], v[108:111]
    ds_read_b64_tr_b16 v[30:31], v13 offset:37128
    s_waitcnt lgkmcnt(8)
    v_mfma_f32_16x16x32_bf16 v[112:115], v[184:187], v[40:43], v[112:115]
    ds_read_b64_tr_b16 v[32:33], v13 offset:36976
    v_mfma_f32_16x16x32_bf16 v[116:119], v[188:191], v[40:43], v[116:119]
    ds_read_b64_tr_b16 v[34:35], v13 offset:37152
    v_mfma_f32_16x16x32_bf16 v[120:123], v[184:187], v[44:47], v[120:123]
    ds_read_b64_tr_b16 v[36:37], v13 offset:37008
    v_mfma_f32_16x16x32_bf16 v[124:127], v[188:191], v[44:47], v[124:127]
    ds_read_b64_tr_b16 v[38:39], v13 offset:37184
    s_waitcnt lgkmcnt(8)
    v_mfma_f32_16x16x32_bf16 v[80:83], v[192:195], v[16:19], v[80:83]
    ds_read_b64_tr_b16 v[40:41], v13 offset:42496
    v_mfma_f32_16x16x32_bf16 v[84:87], v[196:199], v[16:19], v[84:87]
    ds_read_b64_tr_b16 v[42:43], v13 offset:42672
    v_mfma_f32_16x16x32_bf16 v[88:91], v[192:195], v[20:23], v[88:91]
    ds_read_b64_tr_b16 v[44:45], v13 offset:42528
    v_mfma_f32_16x16x32_bf16 v[92:95], v[196:199], v[20:23], v[92:95]
    ds_read_b64_tr_b16 v[46:47], v13 offset:42704
    s_waitcnt lgkmcnt(8)
    v_mfma_f32_16x16x32_bf16 v[96:99], v[192:195], v[24:27], v[96:99]
    ds_read_b64_tr_b16 v[16:17], v13 offset:42552
    v_mfma_f32_16x16x32_bf16 v[100:103], v[196:199], v[24:27], v[100:103]
    ds_read_b64_tr_b16 v[18:19], v13 offset:42728
    v_mfma_f32_16x16x32_bf16 v[104:107], v[192:195], v[28:31], v[104:107]
    ds_read_b64_tr_b16 v[20:21], v13 offset:42584
    v_mfma_f32_16x16x32_bf16 v[108:111], v[196:199], v[28:31], v[108:111]
    ds_read_b64_tr_b16 v[22:23], v13 offset:42760
    s_waitcnt lgkmcnt(8)
    v_mfma_f32_16x16x32_bf16 v[112:115], v[192:195], v[32:35], v[112:115]
    ds_read_b64_tr_b16 v[24:25], v13 offset:42608
    v_mfma_f32_16x16x32_bf16 v[116:119], v[196:199], v[32:35], v[116:119]
    ds_read_b64_tr_b16 v[26:27], v13 offset:42784
    v_mfma_f32_16x16x32_bf16 v[120:123], v[192:195], v[36:39], v[120:123]
    ds_read_b64_tr_b16 v[28:29], v13 offset:42640
    v_mfma_f32_16x16x32_bf16 v[124:127], v[196:199], v[36:39], v[124:127]
    ds_read_b64_tr_b16 v[30:31], v13 offset:42816
    s_waitcnt lgkmcnt(8)
    s_barrier
    v_mfma_f32_16x16x32_bf16 v[80:83], v[200:203], v[40:43], v[80:83]
    ds_read_b64_tr_b16 v[32:33], v5 offset:32768
    v_mfma_f32_16x16x32_bf16 v[84:87], v[204:207], v[40:43], v[84:87]
    ds_read_b64_tr_b16 v[34:35], v5 offset:32944
    v_mfma_f32_16x16x32_bf16 v[88:91], v[200:203], v[44:47], v[88:91]
    ds_read_b64_tr_b16 v[36:37], v5 offset:32800
    v_mfma_f32_16x16x32_bf16 v[92:95], v[204:207], v[44:47], v[92:95]
    ds_read_b64_tr_b16 v[38:39], v5 offset:32976
    s_waitcnt lgkmcnt(8)
    v_mfma_f32_16x16x32_bf16 v[96:99], v[200:203], v[16:19], v[96:99]
    ds_read_b64_tr_b16 v[40:41], v5 offset:32824
    v_mfma_f32_16x16x32_bf16 v[100:103], v[204:207], v[16:19], v[100:103]
    ds_read_b64_tr_b16 v[42:43], v5 offset:33000
    v_mfma_f32_16x16x32_bf16 v[104:107], v[200:203], v[20:23], v[104:107]
    ds_read_b64_tr_b16 v[44:45], v5 offset:32856
    v_mfma_f32_16x16x32_bf16 v[108:111], v[204:207], v[20:23], v[108:111]
    ds_read_b64_tr_b16 v[46:47], v5 offset:33032
    s_waitcnt lgkmcnt(8)
    v_mfma_f32_16x16x32_bf16 v[112:115], v[200:203], v[24:27], v[112:115]
    ds_read_b64_tr_b16 v[16:17], v5 offset:32880
    v_mfma_f32_16x16x32_bf16 v[116:119], v[204:207], v[24:27], v[116:119]
    ds_read_b64_tr_b16 v[18:19], v5 offset:33056
    v_mfma_f32_16x16x32_bf16 v[120:123], v[200:203], v[28:31], v[120:123]
    ds_read_b64_tr_b16 v[20:21], v5 offset:32912
    v_mfma_f32_16x16x32_bf16 v[124:127], v[204:207], v[28:31], v[124:127]
    ds_read_b64_tr_b16 v[22:23], v5 offset:33088
    s_waitcnt lgkmcnt(8)
    v_mfma_f32_16x16x32_bf16 v[80:83], v[208:211], v[32:35], v[80:83]
    ds_read_b64_tr_b16 v[24:25], v5 offset:38400
    v_mfma_f32_16x16x32_bf16 v[84:87], v[212:215], v[32:35], v[84:87]
    ds_read_b64_tr_b16 v[26:27], v5 offset:38576
    v_mfma_f32_16x16x32_bf16 v[88:91], v[208:211], v[36:39], v[88:91]
    ds_read_b64_tr_b16 v[28:29], v5 offset:38432
    v_mfma_f32_16x16x32_bf16 v[92:95], v[212:215], v[36:39], v[92:95]
    ds_read_b64_tr_b16 v[30:31], v5 offset:38608
    s_waitcnt lgkmcnt(8)
    v_mfma_f32_16x16x32_bf16 v[96:99], v[208:211], v[40:43], v[96:99]
    ds_read_b64_tr_b16 v[32:33], v5 offset:38456
    v_mfma_f32_16x16x32_bf16 v[100:103], v[212:215], v[40:43], v[100:103]
    ds_read_b64_tr_b16 v[34:35], v5 offset:38632
    v_mfma_f32_16x16x32_bf16 v[104:107], v[208:211], v[44:47], v[104:107]
    ds_read_b64_tr_b16 v[36:37], v5 offset:38488
    v_mfma_f32_16x16x32_bf16 v[108:111], v[212:215], v[44:47], v[108:111]
    ds_read_b64_tr_b16 v[38:39], v5 offset:38664
    s_waitcnt lgkmcnt(8)
    v_mfma_f32_16x16x32_bf16 v[112:115], v[208:211], v[16:19], v[112:115]
    ds_read_b64_tr_b16 v[40:41], v5 offset:38512
    v_mfma_f32_16x16x32_bf16 v[116:119], v[212:215], v[16:19], v[116:119]
    ds_read_b64_tr_b16 v[42:43], v5 offset:38688
    v_mfma_f32_16x16x32_bf16 v[120:123], v[208:211], v[20:23], v[120:123]
    ds_read_b64_tr_b16 v[44:45], v5 offset:38544
    v_mfma_f32_16x16x32_bf16 v[124:127], v[212:215], v[20:23], v[124:127]
    ds_read_b64_tr_b16 v[46:47], v5 offset:38720
    s_waitcnt lgkmcnt(8)
    v_mfma_f32_16x16x32_bf16 v[80:83], v[216:219], v[24:27], v[80:83]
    ds_read_b64_tr_b16 v[16:17], v13 offset:49152
    v_mfma_f32_16x16x32_bf16 v[84:87], v[220:223], v[24:27], v[84:87]
    ds_read_b64_tr_b16 v[18:19], v13 offset:49328
    v_mfma_f32_16x16x32_bf16 v[88:91], v[216:219], v[28:31], v[88:91]
    ds_read_b64_tr_b16 v[20:21], v13 offset:49184
    v_mfma_f32_16x16x32_bf16 v[92:95], v[220:223], v[28:31], v[92:95]
    ds_read_b64_tr_b16 v[22:23], v13 offset:49360
    s_waitcnt lgkmcnt(8)
    v_mfma_f32_16x16x32_bf16 v[96:99], v[216:219], v[32:35], v[96:99]
    ds_read_b64_tr_b16 v[24:25], v13 offset:49208
    v_mfma_f32_16x16x32_bf16 v[100:103], v[220:223], v[32:35], v[100:103]
    ds_read_b64_tr_b16 v[26:27], v13 offset:49384
    v_mfma_f32_16x16x32_bf16 v[104:107], v[216:219], v[36:39], v[104:107]
    ds_read_b64_tr_b16 v[28:29], v13 offset:49240
    v_mfma_f32_16x16x32_bf16 v[108:111], v[220:223], v[36:39], v[108:111]
    ds_read_b64_tr_b16 v[30:31], v13 offset:49416
    s_waitcnt lgkmcnt(8)
    v_mfma_f32_16x16x32_bf16 v[112:115], v[216:219], v[40:43], v[112:115]
    ds_read_b64_tr_b16 v[32:33], v13 offset:49264
    v_mfma_f32_16x16x32_bf16 v[116:119], v[220:223], v[40:43], v[116:119]
    ds_read_b64_tr_b16 v[34:35], v13 offset:49440
    v_mfma_f32_16x16x32_bf16 v[120:123], v[216:219], v[44:47], v[120:123]
    ds_read_b64_tr_b16 v[36:37], v13 offset:49296
    v_mfma_f32_16x16x32_bf16 v[124:127], v[220:223], v[44:47], v[124:127]
    ds_read_b64_tr_b16 v[38:39], v13 offset:49472
    s_waitcnt lgkmcnt(8)
    v_mfma_f32_16x16x32_bf16 v[80:83], v[224:227], v[16:19], v[80:83]
    ds_read_b64_tr_b16 v[40:41], v13 offset:54784
    v_mfma_f32_16x16x32_bf16 v[84:87], v[228:231], v[16:19], v[84:87]
    ds_read_b64_tr_b16 v[42:43], v13 offset:54960
    v_mfma_f32_16x16x32_bf16 v[88:91], v[224:227], v[20:23], v[88:91]
    ds_read_b64_tr_b16 v[44:45], v13 offset:54816
    v_mfma_f32_16x16x32_bf16 v[92:95], v[228:231], v[20:23], v[92:95]
    ds_read_b64_tr_b16 v[46:47], v13 offset:54992
    s_waitcnt lgkmcnt(8)
    v_mfma_f32_16x16x32_bf16 v[96:99], v[224:227], v[24:27], v[96:99]
    ds_read_b64_tr_b16 v[16:17], v13 offset:54840
    v_mfma_f32_16x16x32_bf16 v[100:103], v[228:231], v[24:27], v[100:103]
    ds_read_b64_tr_b16 v[18:19], v13 offset:55016
    v_mfma_f32_16x16x32_bf16 v[104:107], v[224:227], v[28:31], v[104:107]
    ds_read_b64_tr_b16 v[20:21], v13 offset:54872
    v_mfma_f32_16x16x32_bf16 v[108:111], v[228:231], v[28:31], v[108:111]
    ds_read_b64_tr_b16 v[22:23], v13 offset:55048
    v_mov_b32 v196, v7
    v_mov_b32 v197, v7
    v_mov_b32 v198, v7
    v_mov_b32 v199, v7
    v_mov_b32 v204, v7
    v_mov_b32 v205, v7
    v_mov_b32 v206, v7
    v_mov_b32 v207, v7
    v_mov_b32 v212, v7
    v_mov_b32 v213, v7
    v_mov_b32 v214, v7
    v_mov_b32 v215, v7
    s_waitcnt lgkmcnt(8)
    v_mfma_f32_16x16x32_bf16 v[112:115], v[224:227], v[32:35], v[112:115]
    ds_read_b64_tr_b16 v[24:25], v13 offset:54896
    v_mfma_f32_16x16x32_bf16 v[116:119], v[228:231], v[32:35], v[116:119]
    ds_read_b64_tr_b16 v[26:27], v13 offset:55072
    v_mfma_f32_16x16x32_bf16 v[120:123], v[224:227], v[36:39], v[120:123]
    ds_read_b64_tr_b16 v[28:29], v13 offset:54928
    v_mfma_f32_16x16x32_bf16 v[124:127], v[228:231], v[36:39], v[124:127]
    ds_read_b64_tr_b16 v[30:31], v13 offset:55104
    s_waitcnt lgkmcnt(8)
    v_mfma_f32_16x16x32_bf16 v[80:83], v[232:235], v[40:43], v[80:83]
    v_mfma_f32_16x16x32_bf16 v[84:87], v[236:239], v[40:43], v[84:87]
    v_mfma_f32_16x16x32_bf16 v[88:91], v[232:235], v[44:47], v[88:91]
    v_mfma_f32_16x16x32_bf16 v[92:95], v[236:239], v[44:47], v[92:95]
    s_waitcnt lgkmcnt(4)
    v_mfma_f32_16x16x32_bf16 v[96:99], v[232:235], v[16:19], v[96:99]
    v_mfma_f32_16x16x32_bf16 v[100:103], v[236:239], v[16:19], v[100:103]
    v_mfma_f32_16x16x32_bf16 v[104:107], v[232:235], v[20:23], v[104:107]
    v_mfma_f32_16x16x32_bf16 v[108:111], v[236:239], v[20:23], v[108:111]
    s_nop 1
    s_waitcnt lgkmcnt(0)
    v_mfma_f32_16x16x32_bf16 v[112:115], v[232:235], v[24:27], v[112:115]
    v_mfma_f32_16x16x32_bf16 v[116:119], v[236:239], v[24:27], v[116:119]
    v_mfma_f32_16x16x32_bf16 v[120:123], v[232:235], v[28:31], v[120:123]
    v_mfma_f32_16x16x32_bf16 v[124:127], v[236:239], v[28:31], v[124:127]
    v_cvt_pk_bf16_f32 v192, v80, v81
    v_cvt_pk_bf16_f32 v193, v82, v83
    v_cvt_pk_bf16_f32 v194, v84, v85
    v_cvt_pk_bf16_f32 v195, v86, v87
    s_mov_b32 exec_lo, 0x0fff0fff
    s_mov_b32 exec_hi, 0x0fff0fff
    v_cvt_pk_bf16_f32 v196, v88, v89
    v_cvt_pk_bf16_f32 v197, v90, v91
    v_cvt_pk_bf16_f32 v198, v92, v93
    v_cvt_pk_bf16_f32 v199, v94, v95
    s_mov_b64 exec, -1
    v_cvt_pk_bf16_f32 v200, v96, v97
    v_cvt_pk_bf16_f32 v201, v98, v99
    v_cvt_pk_bf16_f32 v202, v100, v101
    v_cvt_pk_bf16_f32 v203, v102, v103
    s_mov_b32 exec_lo, 0x0fff0fff
    s_mov_b32 exec_hi, 0x0fff0fff
    v_cvt_pk_bf16_f32 v204, v104, v105
    v_cvt_pk_bf16_f32 v205, v106, v107
    v_cvt_pk_bf16_f32 v206, v108, v109
    v_cvt_pk_bf16_f32 v207, v110, v111
    s_mov_b64 exec, -1
    v_cvt_pk_bf16_f32 v208, v112, v113
    v_cvt_pk_bf16_f32 v209, v114, v115
    v_cvt_pk_bf16_f32 v210, v116, v117
    v_cvt_pk_bf16_f32 v211, v118, v119
    s_mov_b32 exec_lo, 0x0fff0fff
    s_mov_b32 exec_hi, 0x0fff0fff
    v_cvt_pk_bf16_f32 v212, v120, v121
    v_cvt_pk_bf16_f32 v213, v122, v123
    v_cvt_pk_bf16_f32 v214, v124, v125
    v_cvt_pk_bf16_f32 v215, v126, v127
    s_mov_b64 exec, -1
    v_mov_b32 v216, v14
    s_branch L_a_attn
L_a_attn:
    v_and_b32 v3, 31, v1
    s_lshl_b32 s46, s35, 7
    s_add_u32 s46, s46, 161792
    v_lshl_add_u32 v3, v3, 2, s46
    s_mov_b64 exec, 0xffff
    ds_write2_b32 v3, v240, v244 offset1:16
    s_mov_b64 exec, -1
    ds_read_b32 v14, v3
    s_min_u32 s62, s39, 10240
    v_lshlrev_b32 v8, 4, v1
    v_mov_b32 v13, 0xdddddddd
    v_add_u32 v12, s39, v8
    v_mov_b32 v237, 0
    v_mov_b32 v227, 1
    v_and_b32 v2, 0x23, v1
    v_bfe_u32 v3, v1, 2, 1
    v_lshl_add_u32 v2, v3, 4, v2
    v_bfe_u32 v3, v1, 3, 2
    v_lshl_add_u32 v2, v3, 2, v2
    v_lshlrev_b32 v248, 4, v2
    s_and_b32 s46, s35, 1
    s_lshl_b32 s46, s46, 13
    s_and_b32 s46, s46, 0x2000
    v_add_u32 v10, s46, v8
    v_add_u32 v250, s46, v248
    s_mov_b32 s63, 0
    s_add_u32 s45, s45, 2048
L_a_restart:
    v_and_b32 v2, 31, v1
    v_mov_b32 v3, 162304
    v_lshl_add_u32 v2, v2, 2, v3
    ds_write_b32 v2, v237
    v_mov_b64 v[32:33], 0
    v_mov_b64 v[34:35], 0
    v_mov_b64 v[36:37], 0
    v_mov_b64 v[38:39], 0
    v_mov_b64 v[40:41], 0
    v_mov_b64 v[42:43], 0
    v_mov_b64 v[44:45], 0
    v_mov_b64 v[46:47], 0
    v_mov_b64 v[48:49], 0
    v_mov_b64 v[50:51], 0
    v_mov_b64 v[52:53], 0
    v_mov_b64 v[54:55], 0
    v_mov_b64 v[56:57], 0
    v_mov_b64 v[58:59], 0
    v_mov_b64 v[60:61], 0
    v_mov_b64 v[62:63], 0
    v_xor_b32 v2, 4096, v12
    s_waitcnt lgkmcnt(0)
    s_barrier
    ds_read_b128 v[24:27], v2 offset:49152
    ds_read_b128 v[28:31], v2 offset:50176
    ds_read_b128 v[16:19], v12 offset:49152
    ds_read_b128 v[20:23], v12 offset:50176
    ds_read_b128 v[128:131], v250 offset:0
    ds_read_b128 v[132:135], v250 offset:1024
    ds_read_b128 v[136:139], v250 offset:4096
    ds_read_b128 v[140:143], v250 offset:5120
    ds_read_b128 v[160:163], v10 offset:2048
    ds_read_b128 v[164:167], v10 offset:3072
    s_waitcnt lgkmcnt(4)
    v_mfma_f32_32x32x16_bf16 v[64:79], v[128:131], v[24:27], 0
    v_mfma_f32_32x32x16_bf16 v[64:79], v[132:135], v[28:31], v[64:79]
    s_nop 5
    s_nop 2
    v_mfma_f32_32x32x16_bf16 v[80:95], v[128:131], v[16:19], 0
    s_setprio 0
    s_add_u32 m0, s39, 32768
    s_nop 3
    v_exp_f32 v64, v64
    v_exp_f32 v65, v65
    v_exp_f32 v66, v66
    v_exp_f32 v67, v67
    v_mfma_f32_32x32x16_bf16 v[80:95], v[132:135], v[20:23], v[80:95]
    s_mov_b32 s48, 32768
    v_exp_f32 v68, v68
    v_exp_f32 v69, v69
    v_exp_f32 v70, v70
    v_exp_f32 v71, v71
    s_waitcnt lgkmcnt(0)
    ds_read_b128 v[168:171], v10 offset:6144
    v_exp_f32 v72, v72
    v_exp_f32 v73, v73
    v_exp_f32 v74, v74
    v_exp_f32 v75, v75
    v_smfmac_f32_32x32x32_bf16 v[48:63], v[160:163], v[64:71], v13
    ds_read_b128 v[172:175], v10 offset:7168
    buffer_load_dwordx4 v12, s[68:71], s48 offen offset:0 sc1 lds
    buffer_load_dwordx4 v12, s[68:71], s48 offen offset:1024 sc1 lds
    v_exp_f32 v76, v76
    v_exp_f32 v77, v77
    v_exp_f32 v78, v78
    v_exp_f32 v79, v79
    s_barrier
    v_mfma_f32_32x32x16_bf16 v[96:111], v[136:139], v[24:27], 0
    s_setprio 3
    v_exp_f32 v80, v80
    v_exp_f32 v81, v81
    v_exp_f32 v82, v82
    v_exp_f32 v83, v83
    v_mfma_f32_32x32x16_bf16 v[96:111], v[140:143], v[28:31], v[96:111]
    v_exp_f32 v84, v84
    v_exp_f32 v85, v85
    v_exp_f32 v86, v86
    v_exp_f32 v87, v87
    v_smfmac_f32_32x32x32_bf16 v[48:63], v[164:167], v[72:79], v13
    ds_read_b128 v[144:147], v250 offset:16384
    v_exp_f32 v88, v88
    v_exp_f32 v89, v89
    v_exp_f32 v90, v90
    v_exp_f32 v91, v91
    v_smfmac_f32_32x32x32_bf16 v[32:47], v[160:163], v[80:87], v13
    ds_read_b128 v[148:151], v250 offset:17408
    buffer_load_dwordx4 v12, s[68:71], s48 offen offset:2048 sc1 lds
    buffer_load_dwordx4 v12, s[68:71], s48 offen offset:3072 sc1 lds
    v_exp_f32 v92, v92
    v_exp_f32 v93, v93
    v_exp_f32 v94, v94
    v_exp_f32 v95, v95
    v_mfma_f32_32x32x16_bf16 v[112:127], v[136:139], v[16:19], 0
    s_setprio 2
    s_add_u32 m0, s39, 49152
    v_exp_f32 v96, v96
    v_exp_f32 v97, v97
    v_exp_f32 v98, v98
    v_exp_f32 v99, v99
    v_mfma_f32_32x32x16_bf16 v[112:127], v[140:143], v[20:23], v[112:127]
    s_mov_b32 s48, 49152
    v_exp_f32 v100, v100
    v_exp_f32 v101, v101
    v_exp_f32 v102, v102
    v_exp_f32 v103, v103
    v_smfmac_f32_32x32x32_bf16 v[32:47], v[164:167], v[88:95], v13
    s_waitcnt lgkmcnt(0)
    ds_read_b128 v[176:179], v10 offset:18432
    v_exp_f32 v104, v104
    v_exp_f32 v105, v105
    v_exp_f32 v106, v106
    v_exp_f32 v107, v107
    v_smfmac_f32_32x32x32_bf16 v[48:63], v[168:171], v[96:103], v13
    ds_read_b128 v[180:183], v10 offset:19456
    buffer_load_dwordx4 v12, s[68:71], s48 offen offset:0 sc1 lds
    buffer_load_dwordx4 v12, s[68:71], s48 offen offset:1024 sc1 lds
    v_exp_f32 v108, v108
    v_exp_f32 v109, v109
    v_exp_f32 v110, v110
    v_exp_f32 v111, v111
    v_mfma_f32_32x32x16_bf16 v[64:79], v[144:147], v[24:27], 0
    s_setprio 1
    v_exp_f32 v112, v112
    v_exp_f32 v113, v113
    v_exp_f32 v114, v114
    v_exp_f32 v115, v115
    v_mfma_f32_32x32x16_bf16 v[64:79], v[148:151], v[28:31], v[64:79]
    v_exp_f32 v116, v116
    v_exp_f32 v117, v117
    v_exp_f32 v118, v118
    v_exp_f32 v119, v119
    v_smfmac_f32_32x32x32_bf16 v[48:63], v[172:175], v[104:111], v13
    ds_read_b128 v[152:155], v250 offset:20480
    v_exp_f32 v120, v120
    v_exp_f32 v121, v121
    v_exp_f32 v122, v122
    v_exp_f32 v123, v123
    v_smfmac_f32_32x32x32_bf16 v[32:47], v[168:171], v[112:119], v13
    ds_read_b128 v[156:159], v250 offset:21504
    buffer_store_dwordx4 v[192:195], v216, s[28:31], s47 offen sc1
    buffer_store_dwordx4 v[196:199], v216, s[28:31], s47 offen offset:256 sc1
    buffer_load_dwordx4 v12, s[68:71], s48 offen offset:2048 sc1 lds
    v_exp_f32 v124, v124
    v_exp_f32 v125, v125
    v_exp_f32 v126, v126
    v_exp_f32 v127, v127
    v_mfma_f32_32x32x16_bf16 v[80:95], v[144:147], v[16:19], 0
    s_setprio 0
    v_exp_f32 v64, v64
    v_exp_f32 v65, v65
    v_exp_f32 v66, v66
    v_exp_f32 v67, v67
    v_mfma_f32_32x32x16_bf16 v[80:95], v[148:151], v[20:23], v[80:95]
    v_exp_f32 v68, v68
    v_exp_f32 v69, v69
    v_exp_f32 v70, v70
    v_exp_f32 v71, v71
    v_smfmac_f32_32x32x32_bf16 v[32:47], v[172:175], v[120:127], v13
    s_waitcnt lgkmcnt(0)
    ds_read_b128 v[184:187], v10 offset:22528
    v_exp_f32 v72, v72
    v_exp_f32 v73, v73
    v_exp_f32 v74, v74
    v_exp_f32 v75, v75
    v_smfmac_f32_32x32x32_bf16 v[48:63], v[176:179], v[64:71], v13
    ds_read_b128 v[188:191], v10 offset:23552
    buffer_store_dwordx4 v[200:203], v216, s[28:31], s59 offen sc1
    buffer_store_dwordx4 v[204:207], v216, s[28:31], s59 offen offset:256 sc1
    buffer_load_dwordx4 v12, s[68:71], s48 offen offset:3072 sc1 lds
    v_exp_f32 v76, v76
    v_exp_f32 v77, v77
    v_exp_f32 v78, v78
    v_exp_f32 v79, v79
    s_waitcnt vmcnt(8)
    s_barrier
    v_mfma_f32_32x32x16_bf16 v[96:111], v[152:155], v[24:27], 0
    s_setprio 3
    v_exp_f32 v80, v80
    v_exp_f32 v81, v81
    v_exp_f32 v82, v82
    v_exp_f32 v83, v83
    v_mfma_f32_32x32x16_bf16 v[96:111], v[156:159], v[28:31], v[96:111]
    v_exp_f32 v84, v84
    v_exp_f32 v85, v85
    v_exp_f32 v86, v86
    v_exp_f32 v87, v87
    v_smfmac_f32_32x32x32_bf16 v[48:63], v[180:183], v[72:79], v13
    ds_read_b128 v[128:131], v250 offset:32768
    v_exp_f32 v88, v88
    v_exp_f32 v89, v89
    v_exp_f32 v90, v90
    v_exp_f32 v91, v91
    v_smfmac_f32_32x32x32_bf16 v[32:47], v[176:179], v[80:87], v13
    ds_read_b128 v[132:135], v250 offset:33792
    buffer_store_dwordx4 v[208:211], v216, s[28:31], s16 offen sc1
    buffer_store_dwordx4 v[212:215], v216, s[28:31], s16 offen offset:256 sc1
    s_add_u32 m0, s39, 0
    s_mov_b32 s48, 65536
    buffer_load_dwordx4 v12, s[68:71], s48 offen offset:0 sc1 lds
    v_exp_f32 v92, v92
    v_exp_f32 v93, v93
    v_exp_f32 v94, v94
    v_exp_f32 v95, v95
    v_mfma_f32_32x32x16_bf16 v[112:127], v[152:155], v[16:19], 0
    s_setprio 2
    v_exp_f32 v96, v96
    v_exp_f32 v97, v97
    v_exp_f32 v98, v98
    v_exp_f32 v99, v99
    v_mfma_f32_32x32x16_bf16 v[112:127], v[156:159], v[20:23], v[112:127]
    v_exp_f32 v100, v100
    v_exp_f32 v101, v101
    v_exp_f32 v102, v102
    v_exp_f32 v103, v103
    v_smfmac_f32_32x32x32_bf16 v[32:47], v[180:183], v[88:95], v13
    s_waitcnt lgkmcnt(0)
    ds_read_b128 v[160:163], v10 offset:34816
    v_exp_f32 v104, v104
    v_exp_f32 v105, v105
    v_exp_f32 v106, v106
    v_exp_f32 v107, v107
    v_smfmac_f32_32x32x32_bf16 v[48:63], v[184:187], v[96:103], v13
    ds_read_b128 v[164:167], v10 offset:35840
    buffer_load_dwordx4 v12, s[68:71], s48 offen offset:1024 sc1 lds
    v_exp_f32 v108, v108
    v_exp_f32 v109, v109
    v_exp_f32 v110, v110
    v_exp_f32 v111, v111
    v_mfma_f32_32x32x16_bf16 v[64:79], v[128:131], v[24:27], 0
    s_setprio 1
    v_exp_f32 v112, v112
    v_exp_f32 v113, v113
    v_exp_f32 v114, v114
    v_exp_f32 v115, v115
    v_mfma_f32_32x32x16_bf16 v[64:79], v[132:135], v[28:31], v[64:79]
    v_exp_f32 v116, v116
    v_exp_f32 v117, v117
    v_exp_f32 v118, v118
    v_exp_f32 v119, v119
    v_smfmac_f32_32x32x32_bf16 v[48:63], v[188:191], v[104:111], v13
    ds_read_b128 v[136:139], v250 offset:36864
    v_exp_f32 v120, v120
    v_exp_f32 v121, v121
    v_exp_f32 v122, v122
    v_exp_f32 v123, v123
    v_smfmac_f32_32x32x32_bf16 v[32:47], v[184:187], v[112:119], v13
    ds_read_b128 v[140:143], v250 offset:37888
    buffer_load_dwordx4 v12, s[68:71], s48 offen offset:2048 sc1 lds
    v_exp_f32 v124, v124
    v_exp_f32 v125, v125
    v_exp_f32 v126, v126
    v_exp_f32 v127, v127
    v_mfma_f32_32x32x16_bf16 v[80:95], v[128:131], v[16:19], 0
    s_setprio 0
    v_exp_f32 v64, v64
    v_exp_f32 v65, v65
    v_exp_f32 v66, v66
    v_exp_f32 v67, v67
    v_mfma_f32_32x32x16_bf16 v[80:95], v[132:135], v[20:23], v[80:95]
    v_exp_f32 v68, v68
    v_exp_f32 v69, v69
    v_exp_f32 v70, v70
    v_exp_f32 v71, v71
    v_smfmac_f32_32x32x32_bf16 v[32:47], v[188:191], v[120:127], v13
    s_waitcnt lgkmcnt(0)
    ds_read_b128 v[168:171], v10 offset:38912
    v_exp_f32 v72, v72
    v_exp_f32 v73, v73
    v_exp_f32 v74, v74
    v_exp_f32 v75, v75
    v_smfmac_f32_32x32x32_bf16 v[48:63], v[160:163], v[64:71], v13
    ds_read_b128 v[172:175], v10 offset:39936
    buffer_load_dwordx4 v12, s[68:71], s48 offen offset:3072 sc1 lds
    v_exp_f32 v76, v76
    v_exp_f32 v77, v77
    v_exp_f32 v78, v78
    v_exp_f32 v79, v79
    s_waitcnt vmcnt(6)
    s_barrier
    v_mfma_f32_32x32x16_bf16 v[96:111], v[136:139], v[24:27], 0
    s_setprio 3
    s_add_u32 m0, s39, 16384
    v_exp_f32 v80, v80
    v_exp_f32 v81, v81
    v_exp_f32 v82, v82
    v_exp_f32 v83, v83
    v_mfma_f32_32x32x16_bf16 v[96:111], v[140:143], v[28:31], v[96:111]
    s_mov_b32 s48, 81920
    v_exp_f32 v84, v84
    v_exp_f32 v85, v85
    v_exp_f32 v86, v86
    v_exp_f32 v87, v87
    v_smfmac_f32_32x32x32_bf16 v[48:63], v[164:167], v[72:79], v13
    ds_read_b128 v[144:147], v250 offset:49152
    v_exp_f32 v88, v88
    v_exp_f32 v89, v89
    v_exp_f32 v90, v90
    v_exp_f32 v91, v91
    v_smfmac_f32_32x32x32_bf16 v[32:47], v[160:163], v[80:87], v13
    ds_read_b128 v[148:151], v250 offset:50176
    buffer_load_dwordx4 v12, s[68:71], s48 offen offset:0 sc1 lds
    v_exp_f32 v92, v92
    v_exp_f32 v93, v93
    v_exp_f32 v94, v94
    v_exp_f32 v95, v95
    s_waitcnt vmcnt(5)
    v_lshlrev_b32 v2, 3, v1
    v_mov_b32 v4, s100
    v_mov_b32 v5, s101
    s_mov_b64 exec, 0xffff
    buffer_store_dwordx2 v[4:5], v2, s[28:31], s3 offen sc1
    s_mov_b64 exec, -1
    v_mfma_f32_32x32x16_bf16 v[112:127], v[136:139], v[16:19], 0
    s_setprio 2
    v_exp_f32 v96, v96
    v_exp_f32 v97, v97
    v_exp_f32 v98, v98
    v_exp_f32 v99, v99
    v_mfma_f32_32x32x16_bf16 v[112:127], v[140:143], v[20:23], v[112:127]
    v_exp_f32 v100, v100
    v_exp_f32 v101, v101
    v_exp_f32 v102, v102
    v_exp_f32 v103, v103
    v_smfmac_f32_32x32x32_bf16 v[32:47], v[164:167], v[88:95], v13
    s_waitcnt lgkmcnt(0)
    ds_read_b128 v[176:179], v10 offset:51200
    v_exp_f32 v104, v104
    v_exp_f32 v105, v105
    v_exp_f32 v106, v106
    v_exp_f32 v107, v107
    v_smfmac_f32_32x32x32_bf16 v[48:63], v[168:171], v[96:103], v13
    ds_read_b128 v[180:183], v10 offset:52224
    buffer_load_dwordx4 v12, s[68:71], s48 offen offset:1024 sc1 lds
    v_exp_f32 v108, v108
    v_exp_f32 v109, v109
    v_exp_f32 v110, v110
    v_exp_f32 v111, v111
    v_mfma_f32_32x32x16_bf16 v[64:79], v[144:147], v[24:27], 0
    s_setprio 1
    v_exp_f32 v112, v112
    v_exp_f32 v113, v113
    v_exp_f32 v114, v114
    v_exp_f32 v115, v115
    v_mfma_f32_32x32x16_bf16 v[64:79], v[148:151], v[28:31], v[64:79]
    v_exp_f32 v116, v116
    v_exp_f32 v117, v117
    v_exp_f32 v118, v118
    v_exp_f32 v119, v119
    v_smfmac_f32_32x32x32_bf16 v[48:63], v[172:175], v[104:111], v13
    ds_read_b128 v[152:155], v250 offset:53248
    v_exp_f32 v120, v120
    v_exp_f32 v121, v121
    v_exp_f32 v122, v122
    v_exp_f32 v123, v123
    v_smfmac_f32_32x32x32_bf16 v[32:47], v[168:171], v[112:119], v13
    ds_read_b128 v[156:159], v250 offset:54272
    buffer_load_dwordx4 v12, s[68:71], s48 offen offset:2048 sc1 lds
    v_exp_f32 v124, v124
    v_exp_f32 v125, v125
    v_exp_f32 v126, v126
    v_exp_f32 v127, v127
    v_mfma_f32_32x32x16_bf16 v[80:95], v[144:147], v[16:19], 0
    s_setprio 0
    v_exp_f32 v64, v64
    v_exp_f32 v65, v65
    v_exp_f32 v66, v66
    v_exp_f32 v67, v67
    v_mfma_f32_32x32x16_bf16 v[80:95], v[148:151], v[20:23], v[80:95]
    v_exp_f32 v68, v68
    v_exp_f32 v69, v69
    v_exp_f32 v70, v70
    v_exp_f32 v71, v71
    v_smfmac_f32_32x32x32_bf16 v[32:47], v[172:175], v[120:127], v13
    s_waitcnt lgkmcnt(0)
    ds_read_b128 v[184:187], v10 offset:55296
    v_exp_f32 v72, v72
    v_exp_f32 v73, v73
    v_exp_f32 v74, v74
    v_exp_f32 v75, v75
    v_smfmac_f32_32x32x32_bf16 v[48:63], v[176:179], v[64:71], v13
    ds_read_b128 v[188:191], v10 offset:56320
    buffer_load_dwordx4 v12, s[68:71], s48 offen offset:3072 sc1 lds
    v_exp_f32 v76, v76
    v_exp_f32 v77, v77
    v_exp_f32 v78, v78
    v_exp_f32 v79, v79
    s_waitcnt vmcnt(5)
    s_barrier
    v_mfma_f32_32x32x16_bf16 v[96:111], v[152:155], v[24:27], 0
    s_setprio 3
    s_add_u32 m0, s39, 32768
    v_exp_f32 v80, v80
    v_exp_f32 v81, v81
    v_exp_f32 v82, v82
    v_exp_f32 v83, v83
    v_mfma_f32_32x32x16_bf16 v[96:111], v[156:159], v[28:31], v[96:111]
    s_mov_b32 s48, 98304
    v_exp_f32 v84, v84
    v_exp_f32 v85, v85
    v_exp_f32 v86, v86
    v_exp_f32 v87, v87
    v_smfmac_f32_32x32x32_bf16 v[48:63], v[180:183], v[72:79], v13
    ds_read_b128 v[128:131], v250 offset:0
    v_exp_f32 v88, v88
    v_exp_f32 v89, v89
    v_exp_f32 v90, v90
    v_exp_f32 v91, v91
    v_smfmac_f32_32x32x32_bf16 v[32:47], v[176:179], v[80:87], v13
    ds_read_b128 v[132:135], v250 offset:1024
    buffer_load_dwordx4 v12, s[68:71], s48 offen offset:0 sc1 lds
    v_exp_f32 v92, v92
    v_exp_f32 v93, v93
    v_exp_f32 v94, v94
    v_exp_f32 v95, v95
    v_mfma_f32_32x32x16_bf16 v[112:127], v[152:155], v[16:19], 0
    s_setprio 2
    v_exp_f32 v96, v96
    v_exp_f32 v97, v97
    v_exp_f32 v98, v98
    v_exp_f32 v99, v99
    v_mfma_f32_32x32x16_bf16 v[112:127], v[156:159], v[20:23], v[112:127]
    v_exp_f32 v100, v100
    v_exp_f32 v101, v101
    v_exp_f32 v102, v102
    v_exp_f32 v103, v103
    v_smfmac_f32_32x32x32_bf16 v[32:47], v[180:183], v[88:95], v13
    s_waitcnt lgkmcnt(0)
    ds_read_b128 v[160:163], v10 offset:2048
    v_exp_f32 v104, v104
    v_exp_f32 v105, v105
    v_exp_f32 v106, v106
    v_exp_f32 v107, v107
    v_smfmac_f32_32x32x32_bf16 v[48:63], v[184:187], v[96:103], v13
    ds_read_b128 v[164:167], v10 offset:3072
    buffer_load_dwordx4 v12, s[68:71], s48 offen offset:1024 sc1 lds
    v_exp_f32 v108, v108
    v_exp_f32 v109, v109
    v_exp_f32 v110, v110
    v_exp_f32 v111, v111
    v_mfma_f32_32x32x16_bf16 v[64:79], v[128:131], v[24:27], 0
    s_setprio 1
    v_exp_f32 v112, v112
    v_exp_f32 v113, v113
    v_exp_f32 v114, v114
    v_exp_f32 v115, v115
    v_mfma_f32_32x32x16_bf16 v[64:79], v[132:135], v[28:31], v[64:79]
    v_exp_f32 v116, v116
    v_exp_f32 v117, v117
    v_exp_f32 v118, v118
    v_exp_f32 v119, v119
    v_smfmac_f32_32x32x32_bf16 v[48:63], v[188:191], v[104:111], v13
    ds_read_b128 v[136:139], v250 offset:4096
    v_exp_f32 v120, v120
    v_exp_f32 v121, v121
    v_exp_f32 v122, v122
    v_exp_f32 v123, v123
    v_smfmac_f32_32x32x32_bf16 v[32:47], v[184:187], v[112:119], v13
    ds_read_b128 v[140:143], v250 offset:5120
    buffer_load_dwordx4 v12, s[68:71], s48 offen offset:2048 sc1 lds
    v_exp_f32 v124, v124
    v_exp_f32 v125, v125
    v_exp_f32 v126, v126
    v_exp_f32 v127, v127
    v_mfma_f32_32x32x16_bf16 v[80:95], v[128:131], v[16:19], 0
    s_setprio 0
    v_exp_f32 v64, v64
    v_exp_f32 v65, v65
    v_exp_f32 v66, v66
    v_exp_f32 v67, v67
    v_mfma_f32_32x32x16_bf16 v[80:95], v[132:135], v[20:23], v[80:95]
    v_exp_f32 v68, v68
    v_exp_f32 v69, v69
    v_exp_f32 v70, v70
    v_exp_f32 v71, v71
    v_smfmac_f32_32x32x32_bf16 v[32:47], v[188:191], v[120:127], v13
    s_waitcnt lgkmcnt(0)
    ds_read_b128 v[168:171], v10 offset:6144
    v_exp_f32 v72, v72
    v_exp_f32 v73, v73
    v_exp_f32 v74, v74
    v_exp_f32 v75, v75
    v_smfmac_f32_32x32x32_bf16 v[48:63], v[160:163], v[64:71], v13
    ds_read_b128 v[172:175], v10 offset:7168
    buffer_load_dwordx4 v12, s[68:71], s48 offen offset:3072 sc1 lds
    v_exp_f32 v76, v76
    v_exp_f32 v77, v77
    v_exp_f32 v78, v78
    v_exp_f32 v79, v79
    s_waitcnt vmcnt(4)
    s_barrier
    v_mfma_f32_32x32x16_bf16 v[96:111], v[136:139], v[24:27], 0
    s_setprio 3
    s_add_u32 m0, s39, 49152
    v_exp_f32 v80, v80
    v_exp_f32 v81, v81
    v_exp_f32 v82, v82
    v_exp_f32 v83, v83
    v_mfma_f32_32x32x16_bf16 v[96:111], v[140:143], v[28:31], v[96:111]
    s_mov_b32 s48, 114688
    v_exp_f32 v84, v84
    v_exp_f32 v85, v85
    v_exp_f32 v86, v86
    v_exp_f32 v87, v87
    v_smfmac_f32_32x32x32_bf16 v[48:63], v[164:167], v[72:79], v13
    ds_read_b128 v[144:147], v250 offset:16384
    v_exp_f32 v88, v88
    v_exp_f32 v89, v89
    v_exp_f32 v90, v90
    v_exp_f32 v91, v91
    v_smfmac_f32_32x32x32_bf16 v[32:47], v[160:163], v[80:87], v13
    ds_read_b128 v[148:151], v250 offset:17408
    buffer_load_dwordx4 v12, s[68:71], s48 offen offset:0 sc1 lds
    v_exp_f32 v92, v92
    v_exp_f32 v93, v93
    v_exp_f32 v94, v94
    v_exp_f32 v95, v95
    v_mfma_f32_32x32x16_bf16 v[112:127], v[136:139], v[16:19], 0
    s_setprio 2
    v_exp_f32 v96, v96
    v_exp_f32 v97, v97
    v_exp_f32 v98, v98
    v_exp_f32 v99, v99
    v_mfma_f32_32x32x16_bf16 v[112:127], v[140:143], v[20:23], v[112:127]
    v_exp_f32 v100, v100
    v_exp_f32 v101, v101
    v_exp_f32 v102, v102
    v_exp_f32 v103, v103
    v_smfmac_f32_32x32x32_bf16 v[32:47], v[164:167], v[88:95], v13
    s_waitcnt lgkmcnt(0)
    ds_read_b128 v[176:179], v10 offset:18432
    v_exp_f32 v104, v104
    v_exp_f32 v105, v105
    v_exp_f32 v106, v106
    v_exp_f32 v107, v107
    v_smfmac_f32_32x32x32_bf16 v[48:63], v[168:171], v[96:103], v13
    ds_read_b128 v[180:183], v10 offset:19456
    buffer_load_dwordx4 v12, s[68:71], s48 offen offset:1024 sc1 lds
    v_exp_f32 v108, v108
    v_exp_f32 v109, v109
    v_exp_f32 v110, v110
    v_exp_f32 v111, v111
    v_mfma_f32_32x32x16_bf16 v[64:79], v[144:147], v[24:27], 0
    s_setprio 1
    v_exp_f32 v112, v112
    v_exp_f32 v113, v113
    v_exp_f32 v114, v114
    v_exp_f32 v115, v115
    v_mfma_f32_32x32x16_bf16 v[64:79], v[148:151], v[28:31], v[64:79]
    v_exp_f32 v116, v116
    v_exp_f32 v117, v117
    v_exp_f32 v118, v118
    v_exp_f32 v119, v119
    v_smfmac_f32_32x32x32_bf16 v[48:63], v[172:175], v[104:111], v13
    ds_read_b128 v[152:155], v250 offset:20480
    v_exp_f32 v120, v120
    v_exp_f32 v121, v121
    v_exp_f32 v122, v122
    v_exp_f32 v123, v123
    v_smfmac_f32_32x32x32_bf16 v[32:47], v[168:171], v[112:119], v13
    ds_read_b128 v[156:159], v250 offset:21504
    buffer_load_dwordx4 v12, s[68:71], s48 offen offset:2048 sc1 lds
    v_exp_f32 v124, v124
    v_exp_f32 v125, v125
    v_exp_f32 v126, v126
    v_exp_f32 v127, v127
    v_mfma_f32_32x32x16_bf16 v[80:95], v[144:147], v[16:19], 0
    s_setprio 0
    v_exp_f32 v64, v64
    v_exp_f32 v65, v65
    v_exp_f32 v66, v66
    v_exp_f32 v67, v67
    v_mfma_f32_32x32x16_bf16 v[80:95], v[148:151], v[20:23], v[80:95]
    v_exp_f32 v68, v68
    v_exp_f32 v69, v69
    v_exp_f32 v70, v70
    v_exp_f32 v71, v71
    v_smfmac_f32_32x32x32_bf16 v[32:47], v[172:175], v[120:127], v13
    s_waitcnt lgkmcnt(0)
    ds_read_b128 v[184:187], v10 offset:22528
    v_exp_f32 v72, v72
    v_exp_f32 v73, v73
    v_exp_f32 v74, v74
    v_exp_f32 v75, v75
    v_smfmac_f32_32x32x32_bf16 v[48:63], v[176:179], v[64:71], v13
    ds_read_b128 v[188:191], v10 offset:23552
    buffer_load_dwordx4 v12, s[68:71], s48 offen offset:3072 sc1 lds
    v_exp_f32 v76, v76
    v_exp_f32 v77, v77
    v_exp_f32 v78, v78
    v_exp_f32 v79, v79
    v_lshrrev_b32 v3, 3, v1
    s_lshl_b32 s46, s35, 5
    v_add_u32 v3, s46, v3
    v_mul_u32_u24 v3, 896, v3
    v_and_b32 v4, 7, v1
    v_bfe_u32 v5, v1, 4, 1
    v_lshlrev_b32 v5, 2, v5
    v_xor_b32 v4, v4, v5
    v_lshl_add_u32 v3, v4, 4, v3
    s_lshl_b32 s46, s37, 7
    v_add_u32 v15, s46, v3
    s_waitcnt vmcnt(4)
    s_barrier
    v_mfma_f32_32x32x16_bf16 v[96:111], v[152:155], v[24:27], 0
    s_setprio 3
    s_add_u32 m0, s39, 0
    v_exp_f32 v80, v80
    v_exp_f32 v81, v81
    v_exp_f32 v82, v82
    v_exp_f32 v83, v83
    v_mfma_f32_32x32x16_bf16 v[96:111], v[156:159], v[28:31], v[96:111]
    s_mov_b32 s48, 131072
    v_exp_f32 v84, v84
    v_exp_f32 v85, v85
    v_exp_f32 v86, v86
    v_exp_f32 v87, v87
    v_smfmac_f32_32x32x32_bf16 v[48:63], v[180:183], v[72:79], v13
    ds_read_b128 v[128:131], v250 offset:32768
    v_exp_f32 v88, v88
    v_exp_f32 v89, v89
    v_exp_f32 v90, v90
    v_exp_f32 v91, v91
    v_smfmac_f32_32x32x32_bf16 v[32:47], v[176:179], v[80:87], v13
    ds_read_b128 v[132:135], v250 offset:33792
    buffer_load_dwordx4 v12, s[68:71], s48 offen offset:0 sc1 lds
    v_exp_f32 v92, v92
    v_exp_f32 v93, v93
    v_exp_f32 v94, v94
    v_exp_f32 v95, v95
    v_mfma_f32_32x32x16_bf16 v[112:127], v[152:155], v[16:19], 0
    s_setprio 2
    v_exp_f32 v96, v96
    v_exp_f32 v97, v97
    v_exp_f32 v98, v98
    v_exp_f32 v99, v99
    v_mfma_f32_32x32x16_bf16 v[112:127], v[156:159], v[20:23], v[112:127]
    v_exp_f32 v100, v100
    v_exp_f32 v101, v101
    v_exp_f32 v102, v102
    v_exp_f32 v103, v103
    v_smfmac_f32_32x32x32_bf16 v[32:47], v[180:183], v[88:95], v13
    s_waitcnt lgkmcnt(0)
    ds_read_b128 v[160:163], v10 offset:34816
    v_exp_f32 v104, v104
    v_exp_f32 v105, v105
    v_exp_f32 v106, v106
    v_exp_f32 v107, v107
    v_smfmac_f32_32x32x32_bf16 v[48:63], v[184:187], v[96:103], v13
    ds_read_b128 v[164:167], v10 offset:35840
    buffer_load_dwordx4 v12, s[68:71], s48 offen offset:1024 sc1 lds
    v_exp_f32 v108, v108
    v_exp_f32 v109, v109
    v_exp_f32 v110, v110
    v_exp_f32 v111, v111
    v_mfma_f32_32x32x16_bf16 v[64:79], v[128:131], v[24:27], 0
    s_setprio 1
    v_exp_f32 v112, v112
    v_exp_f32 v113, v113
    v_exp_f32 v114, v114
    v_exp_f32 v115, v115
    v_mfma_f32_32x32x16_bf16 v[64:79], v[132:135], v[28:31], v[64:79]
    v_exp_f32 v116, v116
    v_exp_f32 v117, v117
    v_exp_f32 v118, v118
    v_exp_f32 v119, v119
    v_smfmac_f32_32x32x32_bf16 v[48:63], v[188:191], v[104:111], v13
    ds_read_b128 v[136:139], v250 offset:36864
    v_exp_f32 v120, v120
    v_exp_f32 v121, v121
    v_exp_f32 v122, v122
    v_exp_f32 v123, v123
    v_smfmac_f32_32x32x32_bf16 v[32:47], v[184:187], v[112:119], v13
    ds_read_b128 v[140:143], v250 offset:37888
    buffer_load_dwordx4 v12, s[68:71], s48 offen offset:2048 sc1 lds
    v_exp_f32 v124, v124
    v_exp_f32 v125, v125
    v_exp_f32 v126, v126
    v_exp_f32 v127, v127
    v_mfma_f32_32x32x16_bf16 v[80:95], v[128:131], v[16:19], 0
    s_setprio 0
    v_exp_f32 v64, v64
    v_exp_f32 v65, v65
    v_exp_f32 v66, v66
    v_exp_f32 v67, v67
    v_mfma_f32_32x32x16_bf16 v[80:95], v[132:135], v[20:23], v[80:95]
    v_exp_f32 v68, v68
    v_exp_f32 v69, v69
    v_exp_f32 v70, v70
    v_exp_f32 v71, v71
    v_smfmac_f32_32x32x32_bf16 v[32:47], v[188:191], v[120:127], v13
    s_waitcnt lgkmcnt(0)
    ds_read_b128 v[168:171], v10 offset:38912
    ds_read_b128 v[172:175], v10 offset:39936
    v_exp_f32 v72, v72
    v_exp_f32 v73, v73
    v_exp_f32 v74, v74
    v_exp_f32 v75, v75
    v_smfmac_f32_32x32x32_bf16 v[48:63], v[160:163], v[64:71], v13
    buffer_load_dwordx4 v12, s[68:71], s48 offen offset:3072 sc1 lds
    v_exp_f32 v76, v76
    v_exp_f32 v77, v77
    v_exp_f32 v78, v78
    v_exp_f32 v79, v79
    s_waitcnt vmcnt(4) lgkmcnt(0)
    s_barrier
    s_mov_b32 s96, s8
    s_and_b32 s97, s9, 0xffff
    s_mov_b32 s98, 401408
    s_mov_b32 s99, 0x20000
    s_and_b32 s46, s36, 3
    s_lshl_b32 s46, s46, 2
    s_add_u32 s46, s46, s35
    s_mul_i32 s46, s46, 14
    s_add_u32 s46, s46, 224
    v_min_u32 v3, 13, v1
    v_add_u32 v3, s46, v3
    v_mul_u32_u24 v3, 896, v3
    s_lshl_b32 s46, s37, 7
    buffer_load_dword v232, v3, s[96:99], s46 offen
    v_mfma_f32_32x32x16_bf16 v[96:111], v[136:139], v[24:27], 0
    s_setprio 3
    s_add_u32 m0, s39, 16384
    v_exp_f32 v80, v80
    v_exp_f32 v81, v81
    v_exp_f32 v82, v82
    v_exp_f32 v83, v83
    v_mfma_f32_32x32x16_bf16 v[96:111], v[140:143], v[28:31], v[96:111]
    s_mov_b32 s48, 100352
    v_exp_f32 v84, v84
    v_exp_f32 v85, v85
    v_exp_f32 v86, v86
    v_exp_f32 v87, v87
    v_smfmac_f32_32x32x32_bf16 v[48:63], v[164:167], v[72:79], v13
    ds_read_b128 v[144:147], v250 offset:49152
    v_exp_f32 v88, v88
    v_exp_f32 v89, v89
    v_exp_f32 v90, v90
    v_exp_f32 v91, v91
    v_smfmac_f32_32x32x32_bf16 v[32:47], v[160:163], v[80:87], v13
    ds_read_b128 v[148:151], v250 offset:50176
    buffer_load_dwordx4 v15, s[24:27], s48 offen lds
    s_add_u32 m0, s39, 17408
    s_mov_b32 s48, 107520
    buffer_load_dwordx4 v15, s[24:27], s48 offen lds
    v_exp_f32 v92, v92
    v_exp_f32 v93, v93
    v_exp_f32 v94, v94
    v_exp_f32 v95, v95
    v_mfma_f32_32x32x16_bf16 v[112:127], v[136:139], v[16:19], 0
    s_setprio 2
    s_add_u32 m0, s62, 18432
    v_exp_f32 v96, v96
    v_exp_f32 v97, v97
    v_exp_f32 v98, v98
    v_exp_f32 v99, v99
    v_mfma_f32_32x32x16_bf16 v[112:127], v[140:143], v[20:23], v[112:127]
    s_add_u32 s48, s49, 114688
    v_exp_f32 v100, v100
    v_exp_f32 v101, v101
    v_exp_f32 v102, v102
    v_exp_f32 v103, v103
    v_smfmac_f32_32x32x32_bf16 v[32:47], v[164:167], v[88:95], v13
    s_waitcnt lgkmcnt(0)
    ds_read_b128 v[176:179], v10 offset:51200
    v_exp_f32 v104, v104
    v_exp_f32 v105, v105
    v_exp_f32 v106, v106
    v_exp_f32 v107, v107
    v_smfmac_f32_32x32x32_bf16 v[48:63], v[168:171], v[96:103], v13
    ds_read_b128 v[180:183], v10 offset:52224
    buffer_load_dwordx4 v15, s[24:27], s48 offen lds
    s_add_u32 m0, s62, 19456
    s_add_u32 s48, s49, 121856
    buffer_load_dwordx4 v15, s[24:27], s48 offen lds
    v_exp_f32 v108, v108
    v_exp_f32 v109, v109
    v_exp_f32 v110, v110
    v_exp_f32 v111, v111
    v_mfma_f32_32x32x16_bf16 v[64:79], v[144:147], v[24:27], 0
    s_setprio 1
    s_add_u32 m0, s39, 32768
    v_exp_f32 v112, v112
    v_exp_f32 v113, v113
    v_exp_f32 v114, v114
    v_exp_f32 v115, v115
    v_mfma_f32_32x32x16_bf16 v[64:79], v[148:151], v[28:31], v[64:79]
    s_mov_b32 s48, 200704
    v_exp_f32 v116, v116
    v_exp_f32 v117, v117
    v_exp_f32 v118, v118
    v_exp_f32 v119, v119
    v_smfmac_f32_32x32x32_bf16 v[48:63], v[172:175], v[104:111], v13
    ds_read_b128 v[152:155], v250 offset:53248
    v_exp_f32 v120, v120
    v_exp_f32 v121, v121
    v_exp_f32 v122, v122
    v_exp_f32 v123, v123
    v_smfmac_f32_32x32x32_bf16 v[32:47], v[168:171], v[112:119], v13
    ds_read_b128 v[156:159], v250 offset:54272
    buffer_load_dwordx4 v15, s[24:27], s48 offen lds
    s_add_u32 m0, s39, 33792
    s_mov_b32 s48, 207872
    buffer_load_dwordx4 v15, s[24:27], s48 offen lds
    v_exp_f32 v124, v124
    v_exp_f32 v125, v125
    v_exp_f32 v126, v126
    v_exp_f32 v127, v127
    v_mfma_f32_32x32x16_bf16 v[80:95], v[144:147], v[16:19], 0
    s_setprio 0
    s_add_u32 m0, s62, 34816
    v_exp_f32 v64, v64
    v_exp_f32 v65, v65
    v_exp_f32 v66, v66
    v_exp_f32 v67, v67
    v_mfma_f32_32x32x16_bf16 v[80:95], v[148:151], v[20:23], v[80:95]
    s_add_u32 s48, s49, 215040
    v_exp_f32 v68, v68
    v_exp_f32 v69, v69
    v_exp_f32 v70, v70
    v_exp_f32 v71, v71
    v_smfmac_f32_32x32x32_bf16 v[32:47], v[172:175], v[120:127], v13
    s_waitcnt lgkmcnt(0)
    ds_read_b128 v[184:187], v10 offset:55296
    ds_read_b128 v[188:191], v10 offset:56320
    v_exp_f32 v72, v72
    v_exp_f32 v73, v73
    v_exp_f32 v74, v74
    v_exp_f32 v75, v75
    v_smfmac_f32_32x32x32_bf16 v[48:63], v[176:179], v[64:71], v13
    buffer_load_dwordx4 v15, s[24:27], s48 offen lds
    s_add_u32 m0, s62, 35840
    s_add_u32 s48, s49, 222208
    buffer_load_dwordx4 v15, s[24:27], s48 offen lds
    v_exp_f32 v76, v76
    v_exp_f32 v77, v77
    v_exp_f32 v78, v78
    v_exp_f32 v79, v79
    v_mul_f32 v234, 1069066811, v14
    v_exp_f32 v234, v234
    v_mov_b32 v246, 0
    v_mov_b32 v247, 0
    v_add_f32 v234, 1.0, v234
    s_waitcnt vmcnt(9) lgkmcnt(0)
    s_barrier
    v_mfma_f32_32x32x16_bf16 v[96:111], v[152:155], v[24:27], 0
    s_setprio 0
    ds_read_b128 v[128:131], v248 offset:0
    s_add_u32 m0, s39, 49152
    v_exp_f32 v80, v80
    v_exp_f32 v81, v81
    v_exp_f32 v82, v82
    v_exp_f32 v83, v83
    v_mfma_f32_32x32x16_bf16 v[96:111], v[156:159], v[28:31], v[96:111]
    ds_read_b128 v[132:135], v248 offset:1024
    s_mov_b32 s48, 100352
    v_exp_f32 v84, v84
    v_exp_f32 v85, v85
    v_exp_f32 v86, v86
    v_exp_f32 v87, v87
    v_smfmac_f32_32x32x32_bf16 v[48:63], v[180:183], v[72:79], v13
    ds_read_b128 v[160:163], v8 offset:2048
    v_exp_f32 v88, v88
    v_exp_f32 v89, v89
    v_exp_f32 v90, v90
    v_exp_f32 v91, v91
    v_smfmac_f32_32x32x32_bf16 v[32:47], v[176:179], v[80:87], v13
    ds_read_b128 v[164:167], v8 offset:3072
    buffer_load_dwordx4 v15, s[96:99], s48 offen lds
    s_add_u32 m0, s39, 50176
    s_mov_b32 s48, 107520
    buffer_load_dwordx4 v15, s[96:99], s48 offen lds
    v_exp_f32 v92, v92
    v_exp_f32 v93, v93
    v_exp_f32 v94, v94
    v_exp_f32 v95, v95
    v_mfma_f32_32x32x16_bf16 v[112:127], v[152:155], v[16:19], 0
    ds_read_b128 v[136:139], v248 offset:4096
    s_add_u32 m0, s62, 51200
    v_exp_f32 v96, v96
    v_exp_f32 v97, v97
    v_exp_f32 v98, v98
    v_exp_f32 v99, v99
    v_mfma_f32_32x32x16_bf16 v[112:127], v[156:159], v[20:23], v[112:127]
    ds_read_b128 v[140:143], v248 offset:5120
    s_add_u32 s48, s49, 114688
    v_exp_f32 v100, v100
    v_exp_f32 v101, v101
    v_exp_f32 v102, v102
    v_exp_f32 v103, v103
    v_smfmac_f32_32x32x32_bf16 v[32:47], v[180:183], v[88:95], v13
    s_waitcnt lgkmcnt(4)
    ds_read_b128 v[168:171], v8 offset:6144
    v_exp_f32 v104, v104
    v_exp_f32 v105, v105
    v_exp_f32 v106, v106
    v_exp_f32 v107, v107
    v_smfmac_f32_32x32x32_bf16 v[48:63], v[184:187], v[96:103], v13
    ds_read_b128 v[172:175], v8 offset:7168
    buffer_load_dwordx4 v15, s[96:99], s48 offen lds
    s_add_u32 m0, s62, 52224
    s_add_u32 s48, s49, 121856
    buffer_load_dwordx4 v15, s[96:99], s48 offen lds
    v_exp_f32 v108, v108
    v_exp_f32 v109, v109
    v_exp_f32 v110, v110
    v_exp_f32 v111, v111
    v_mfma_f32_32x32x16_bf16 v[64:79], v[128:131], v[16:19], 0
    ds_read_b128 v[144:147], v248 offset:8192
    s_add_u32 m0, s39, 98304
    v_exp_f32 v112, v112
    v_exp_f32 v113, v113
    v_exp_f32 v114, v114
    v_exp_f32 v115, v115
    v_mfma_f32_32x32x16_bf16 v[64:79], v[132:135], v[20:23], v[64:79]
    ds_read_b128 v[148:151], v248 offset:9216
    s_mov_b32 s48, 0
    v_exp_f32 v116, v116
    v_exp_f32 v117, v117
    v_exp_f32 v118, v118
    v_exp_f32 v119, v119
    v_smfmac_f32_32x32x32_bf16 v[48:63], v[188:191], v[104:111], v13
    s_waitcnt lgkmcnt(4)
    ds_read_b128 v[176:179], v8 offset:10240
    v_exp_f32 v120, v120
    v_exp_f32 v121, v121
    v_exp_f32 v122, v122
    v_exp_f32 v123, v123
    v_smfmac_f32_32x32x32_bf16 v[32:47], v[184:187], v[112:119], v13
    ds_read_b128 v[180:183], v8 offset:11264
    buffer_load_dwordx4 v15, s[96:99], s48 offen lds
    s_add_u32 m0, s39, 99328
    s_mov_b32 s48, 7168
    buffer_load_dwordx4 v15, s[96:99], s48 offen lds
    v_exp_f32 v124, v124
    v_exp_f32 v125, v125
    v_exp_f32 v126, v126
    v_exp_f32 v127, v127
    v_add_u32 v222, 65536, v12
    v_xor_b32 v7, 4096, v222
    s_xor_b32 s46, s35, 1
    s_lshl2_add_u32 s46, s46, 162352
    v_mov_b32 v221, s46
    ds_read_b32 v220, v221
    ds_read_b128 v[192:195], v7 offset:0
    ds_read_b128 v[196:199], v7 offset:1024
    ds_read_b128 v[200:203], v7 offset:2048
    ds_read_b128 v[204:207], v7 offset:3072
    v_mfma_f32_32x32x16_bf16 v[80:95], v[136:139], v[16:19], 0
    ds_read_b128 v[152:155], v248 offset:12288
    s_add_u32 m0, s62, 100352
    v_exp_f32 v64, v64
    v_exp_f32 v65, v65
    v_exp_f32 v66, v66
    v_exp_f32 v67, v67
    v_mfma_f32_32x32x16_bf16 v[80:95], v[140:143], v[20:23], v[80:95]
    ds_read_b128 v[156:159], v248 offset:13312
    s_add_u32 s48, s49, 14336
    v_exp_f32 v68, v68
    v_exp_f32 v69, v69
    v_exp_f32 v70, v70
    v_exp_f32 v71, v71
    v_smfmac_f32_32x32x32_bf16 v[32:47], v[188:191], v[120:127], v13
    s_waitcnt lgkmcnt(4)
    ds_read_b128 v[184:187], v8 offset:14336
    v_exp_f32 v72, v72
    v_exp_f32 v73, v73
    v_exp_f32 v74, v74
    v_exp_f32 v75, v75
    v_smfmac_f32_32x32x32_bf16 v[32:47], v[160:163], v[64:71], v13
    ds_read_b128 v[188:191], v8 offset:15360
    buffer_load_dwordx4 v15, s[96:99], s48 offen lds
    s_add_u32 m0, s62, 101376
    s_add_u32 s48, s49, 21504
    buffer_load_dwordx4 v15, s[96:99], s48 offen lds
    v_exp_f32 v76, v76
    v_exp_f32 v77, v77
    v_exp_f32 v78, v78
    v_exp_f32 v79, v79
    v_mfma_f32_32x32x16_bf16 v[96:111], v[144:147], v[16:19], 0
    v_exp_f32 v80, v80
    v_exp_f32 v81, v81
    v_exp_f32 v82, v82
    v_exp_f32 v83, v83
    v_mfma_f32_32x32x16_bf16 v[96:111], v[148:151], v[20:23], v[96:111]
    v_exp_f32 v84, v84
    v_exp_f32 v85, v85
    v_exp_f32 v86, v86
    v_exp_f32 v87, v87
    v_smfmac_f32_32x32x32_bf16 v[32:47], v[164:167], v[72:79], v13
    s_waitcnt lgkmcnt(2)
    v_exp_f32 v88, v88
    v_exp_f32 v89, v89
    v_exp_f32 v90, v90
    v_exp_f32 v91, v91
    v_smfmac_f32_32x32x32_bf16 v[32:47], v[168:171], v[80:87], v13
    v_exp_f32 v92, v92
    v_exp_f32 v93, v93
    v_exp_f32 v94, v94
    v_exp_f32 v95, v95
L_comb_chk:
    v_cmp_ne_u32 vcc, 0, v220
    s_cbranch_vccnz L_comb_ok
    ds_read_b32 v220, v221
    ds_read_b128 v[192:195], v7 offset:0
    ds_read_b128 v[196:199], v7 offset:1024
    ds_read_b128 v[200:203], v7 offset:2048
    ds_read_b128 v[204:207], v7 offset:3072
    s_waitcnt lgkmcnt(0)
    s_branch L_comb_chk
L_comb_ok:
    v_add_f32 v48, v48, v192
    v_add_f32 v49, v49, v193
    v_add_f32 v50, v50, v194
    v_add_f32 v51, v51, v195
    v_add_f32 v52, v52, v196
    v_add_f32 v53, v53, v197
    v_add_f32 v54, v54, v198
    v_add_f32 v55, v55, v199
    v_add_f32 v56, v56, v200
    v_add_f32 v57, v57, v201
    v_add_f32 v58, v58, v202
    v_add_f32 v59, v59, v203
    v_add_f32 v60, v60, v204
    v_add_f32 v61, v61, v205
    v_add_f32 v62, v62, v206
    v_add_f32 v63, v63, v207
    v_lshrrev_b32 v3, 5, v1
    v_bfe_u32 v4, v1, 2, 2
    v_bfe_u32 v5, v1, 4, 1
    v_and_b32 v6, 3, v1
    v_lshlrev_b32 v6, 3, v6
    v_lshl_add_u32 v6, v5, 5, v6
    v_lshl_add_u32 v6, v4, 7, v6
    v_lshrrev_b32 v4, 1, v4
    v_lshl_add_u32 v6, v4, 6, v6
    s_bitcmp1_b32 s5, 0
    s_mov_b32 s12, 147456
    s_cselect_b32 s12, 32768, s12
    s_mov_b32 s13, 4294836224
    s_cselect_b32 s13, 49152, s13
    v_add_u32 v11, s12, v6
    v_xor_b32 v12, 64, v11
    v_lshl_add_u32 v9, v3, 9, v11
    v_xor_b32 v10, 64, v9
    v_mfma_f32_32x32x16_bf16 v[112:127], v[152:155], v[16:19], 0
    ds_write_b128 v7, v[48:51] offset:0
    v_exp_f32 v96, v96
    v_exp_f32 v97, v97
    v_exp_f32 v98, v98
    v_exp_f32 v99, v99
    v_mfma_f32_32x32x16_bf16 v[112:127], v[156:159], v[20:23], v[112:127]
    ds_write_b128 v7, v[52:55] offset:1024
    v_exp_f32 v100, v100
    v_exp_f32 v101, v101
    v_exp_f32 v102, v102
    v_exp_f32 v103, v103
    v_smfmac_f32_32x32x32_bf16 v[32:47], v[172:175], v[88:95], v13
    s_waitcnt lgkmcnt(0)
    ds_write_b128 v7, v[56:59] offset:2048
    v_exp_f32 v104, v104
    v_exp_f32 v105, v105
    v_exp_f32 v106, v106
    v_exp_f32 v107, v107
    v_smfmac_f32_32x32x32_bf16 v[32:47], v[176:179], v[96:103], v13
    ds_write_b128 v7, v[60:63] offset:3072
    v_exp_f32 v108, v108
    v_exp_f32 v109, v109
    v_exp_f32 v110, v110
    v_exp_f32 v111, v111
    v_exp_f32 v112, v112
    v_exp_f32 v113, v113
    v_exp_f32 v114, v114
    v_exp_f32 v115, v115
    v_exp_f32 v116, v116
    v_exp_f32 v117, v117
    v_exp_f32 v118, v118
    v_exp_f32 v119, v119
    v_smfmac_f32_32x32x32_bf16 v[32:47], v[180:183], v[104:111], v13
    v_exp_f32 v120, v120
    v_exp_f32 v121, v121
    v_exp_f32 v122, v122
    v_exp_f32 v123, v123
    v_smfmac_f32_32x32x32_bf16 v[32:47], v[184:187], v[112:119], v13
    v_exp_f32 v124, v124
    v_exp_f32 v125, v125
    v_exp_f32 v126, v126
    v_exp_f32 v127, v127
    s_nop 1
    v_smfmac_f32_32x32x32_bf16 v[32:47], v[188:191], v[120:127], v13
    s_waitcnt vmcnt(0) lgkmcnt(0)
    s_barrier
    s_setprio 3
    ds_read_b128 v[192:195], v222 offset:0
    ds_read_b128 v[196:199], v222 offset:1024
    ds_read_b128 v[200:203], v222 offset:2048
    ds_read_b128 v[204:207], v222 offset:3072
    v_lshlrev_b32 v0, 3, v1
    v_mov_b32 v24, s100
    v_mov_b32 v25, s101
    s_nop 3
    s_waitcnt lgkmcnt(0)
    v_add_f32 v32, v32, v192
    v_add_f32 v33, v33, v193
    v_add_f32 v34, v34, v194
    v_add_f32 v35, v35, v195
    v_add_f32 v36, v36, v196
    v_add_f32 v37, v37, v197
    v_add_f32 v38, v38, v198
    v_add_f32 v39, v39, v199
    v_add_f32 v40, v40, v200
    v_add_f32 v41, v41, v201
    v_add_f32 v42, v42, v202
    v_add_f32 v43, v43, v203
    v_add_f32 v44, v44, v204
    v_add_f32 v45, v45, v205
    v_add_f32 v46, v46, v206
    v_add_f32 v47, v47, v207
    v_mul_f32 v2, v44, v234
    v_cmp_nle_f32 s[52:53], v44, s56
    v_rcp_f32 v2, v2
    v_cmp_nge_f32 s[54:55], v44, s57
    v_mov_b32 v4, v2
    s_or_b32 s58, s53, s55
    s_cmp_lg_u32 s60, 0
    v_permlane32_swap_b32 v2, v4
    s_cselect_b32 s58, 0, s58
    s_or_b32 s46, s58, s63
    v_mul_f32 v32, v32, v4
    v_mul_f32 v33, v33, v4
    v_mul_f32 v34, v34, v4
    v_mul_f32 v35, v35, v4
    v_mul_f32 v36, v36, v4
    v_mul_f32 v37, v37, v4
    v_mul_f32 v38, v38, v4
    v_mul_f32 v39, v39, v4
    s_cselect_b32 s50, 0x40000000, s44
    s_cselect_b32 s51, 0x40000000, s45
    s_cselect_b32 s63, s63, 1
    v_cvt_pk_bf16_f32 v240, v32, v33
    v_cvt_pk_bf16_f32 v241, v34, v35
    v_cvt_pk_bf16_f32 v242, v36, v37
    v_cvt_pk_bf16_f32 v243, v38, v39
    buffer_store_dwordx4 v[240:243], v8, s[28:31], s50 offen offset:0 sc1
    v_mul_f32 v40, v40, v4
    v_mul_f32 v41, v41, v4
    v_mul_f32 v42, v42, v4
    v_mul_f32 v43, v43, v4
    v_mul_f32 v44, v44, v4
    v_mul_f32 v45, v45, v4
    v_mul_f32 v46, v46, v4
    v_mul_f32 v47, v47, v4
    v_cvt_pk_bf16_f32 v244, v40, v41
    v_cvt_pk_bf16_f32 v245, v42, v43
    s_mov_b32 exec_hi, 0
    v_cvt_pk_bf16_f32 v246, v44, v45
    v_cvt_pk_bf16_f32 v247, v46, v47
    s_mov_b32 exec_hi, -1
    buffer_store_dwordx4 v[244:247], v8, s[28:31], s50 offen offset:1024 sc1
    s_cmp_eq_u32 s58, 0
    s_cbranch_scc1 noflag_70
    v_mov_b32 v2, 162304
    ds_write_b32 v2, v227
noflag_70:
    s_add_u32 m0, s39, 0
    s_mov_b32 s48, 200704
    buffer_load_dwordx4 v15, s[96:99], s48 offen lds
    s_add_u32 m0, s39, 1024
    s_mov_b32 s48, 207872
    buffer_load_dwordx4 v15, s[96:99], s48 offen lds
    s_add_u32 m0, s62, 2048
    s_add_u32 s48, s49, 215040
    buffer_load_dwordx4 v15, s[96:99], s48 offen lds
    s_add_u32 m0, s62, 3072
    s_add_u32 s48, s49, 222208
    buffer_load_dwordx4 v15, s[96:99], s48 offen lds
    s_add_u32 m0, s39, 65536
    s_mov_b32 s48, 301056
    buffer_load_dwordx4 v15, s[96:99], s48 offen lds
    s_add_u32 m0, s39, 66560
    s_mov_b32 s48, 308224
    buffer_load_dwordx4 v15, s[96:99], s48 offen lds
    s_add_u32 m0, s62, 67584
    s_add_u32 s48, s49, 315392
    buffer_load_dwordx4 v15, s[96:99], s48 offen lds
    s_add_u32 m0, s62, 68608
    s_add_u32 s48, s49, 322560
    buffer_load_dwordx4 v15, s[96:99], s48 offen lds
    s_add_u32 s52, s6, 0
    s_add_u32 s53, s6, 4096
    s_add_u32 s54, s6, 8192
    s_add_u32 s55, s6, 12288
    s_add_u32 s10, s22, s7
    s_addc_u32 s11, s23, 0
    s_lshl_b32 s46, s4, 12
    s_lshl_b32 s47, s5, 10
    s_add_u32 s47, s47, s46
    s_add_u32 s47, s47, 114560
    v_add_u32 v3, s47, v8
    v_lshrrev_b32 v5, 3, v1
    s_lshl_b32 s47, s5, 3
    v_add_u32 v5, s47, v5
    v_bfe_u32 v6, v1, 1, 2
    v_mul_u32_u24 v4, 8224, v6
    v_lshl_add_u32 v4, v5, 4, v4
    v_and_b32 v6, 1, v1
    v_lshl_add_u32 v4, v6, 3, v4
    s_add_u32 s47, s46, 114560
    v_add_u32 v4, s47, v4
    s_lshl1_add_u32 s46, s36, s4
    s_lshl_b32 s46, s46, 5
    v_add_u32 v5, s46, v5
    v_mul_u32_u24 v5, 896, v5
    v_and_b32 v6, 7, v1
    v_lshl_add_u32 v5, v6, 4, v5
    s_lshl_b32 s50, s37, 7
    v_mov_b32 v13, 162304
    s_waitcnt vmcnt(8)
    s_mov_b64 exec, 0xffff
    buffer_store_dwordx2 v[24:25], v0, s[28:31], s51 offen sc1
    s_mov_b64 exec, -1
    s_load_dwordx2 s[64:65], s[10:11], 0 glc
    s_load_dwordx2 s[66:67], s[10:11], 128 glc
    s_load_dwordx2 s[68:69], s[10:11], 256 glc
    s_load_dwordx2 s[70:71], s[10:11], 384 glc
    v_lshrrev_b32 v190, 5, v1
    v_mul_u32_u24 v184, 9728, v190
    v_add_u32 v184, v184, v11
    v_xor_b32 v185, 64, v184
    v_mul_u32_u24 v186, 7168, v190
    v_add_u32 v186, v186, v11
    v_xor_b32 v187, 64, v186
    v_mul_u32_u24 v188, 3072, v190
    v_add_u32 v188, v188, v11
    v_xor_b32 v189, 64, v188
    s_waitcnt lgkmcnt(11)
    ds_read_b64_tr_b16 v[128:129], v9 offset:0
    ds_read_b64_tr_b16 v[130:131], v9 offset:1024
    ds_read_b64_tr_b16 v[132:133], v10 offset:0
    ds_read_b64_tr_b16 v[134:135], v10 offset:1024
    s_waitcnt lgkmcnt(11)
    ds_read_b64_tr_b16 v[136:137], v9 offset:3584
    ds_read_b64_tr_b16 v[138:139], v9 offset:4608
    ds_read_b64_tr_b16 v[140:141], v10 offset:3584
    ds_read_b64_tr_b16 v[142:143], v10 offset:4608
    s_waitcnt lgkmcnt(11)
    ds_read_b64_tr_b16 v[144:145], v9 offset:7168
    ds_read_b64_tr_b16 v[146:147], v9 offset:8192
    ds_read_b64_tr_b16 v[148:149], v10 offset:7168
    ds_read_b64_tr_b16 v[150:151], v10 offset:8192
    s_waitcnt lgkmcnt(11)
    ds_read_b64_tr_b16 v[152:153], v9 offset:10752
    ds_read_b64_tr_b16 v[154:155], v9 offset:11776
    ds_read_b64_tr_b16 v[156:157], v10 offset:10752
    ds_read_b64_tr_b16 v[158:159], v10 offset:11776
    s_waitcnt lgkmcnt(11)
    ds_read_b64_tr_b16 v[160:161], v9 offset:2048
    ds_read_b64_tr_b16 v[162:163], v184 offset:3072
    ds_read_b64_tr_b16 v[164:165], v10 offset:2048
    ds_read_b64_tr_b16 v[166:167], v185 offset:3072
    s_waitcnt lgkmcnt(11)
    ds_read_b64_tr_b16 v[168:169], v9 offset:5632
    ds_read_b64_tr_b16 v[170:171], v186 offset:6656
    ds_read_b64_tr_b16 v[172:173], v10 offset:5632
    ds_read_b64_tr_b16 v[174:175], v187 offset:6656
    s_waitcnt lgkmcnt(11)
    ds_read_b64_tr_b16 v[176:177], v9 offset:9216
    ds_read_b64_tr_b16 v[178:179], v188 offset:10240
    ds_read_b64_tr_b16 v[180:181], v10 offset:9216
    ds_read_b64_tr_b16 v[182:183], v189 offset:10240
    s_waitcnt vmcnt(1) lgkmcnt(6)
    s_lshl_b32 s46, s35, 2
    s_add_u32 s46, s46, 162320
    v_mov_b32 v2, s46
    v_mov_b32 v7, 1
    ds_write_b32 v2, v7
    s_branch L_p3
L_a_fallback:
    s_mov_b32 s47, 0x40000000
    s_mov_b32 s59, 0x40000000
    s_mov_b32 s16, 0x40000000
    s_mov_b32 s3, 0x40000000
    v_mov_b32 v216, 0
    v_mov_b32 v217, 0
    v_mov_b32 v218, 0
    s_barrier
    s_branch L_a_restart
L_exit:
L_done:
    s_endpgm
.section .rodata,"a"
.p2align 6
.amdhsa_kernel gated_mix__sliding_block__softmax_full_mha__prompt_kernel
  .amdhsa_next_free_vgpr 256
  .amdhsa_next_free_sgpr 102
  .amdhsa_accum_offset 256
  .amdhsa_group_segment_fixed_size 0
  .amdhsa_kernarg_size 80
  .amdhsa_user_sgpr_count 2
  .amdhsa_user_sgpr_kernarg_segment_ptr 1
  .amdhsa_system_sgpr_workgroup_id_x 1
.end_amdhsa_kernel
```
